```python
import torch

def _softmax(x, axis=-1):
    return torch.softmax(x, dim=axis)
def _gelu(x):
    return torch.nn.functional.gelu(x, approximate="tanh")
def _silu(x):
    return torch.nn.functional.silu(x)
def _sigmoid(x):
    return torch.sigmoid(x)
def _layernorm(x, axis=-1, eps=1e-5):
    m = x.mean(dim=axis, keepdim=True)
    v = x.var(dim=axis, keepdim=True, unbiased=False)
    return (x - m) / torch.sqrt(v + eps)
def _scatter_add(tgt, idx, src, axis=0):
    return tgt.clone().index_add_(axis, idx, src)
def _segment_sum(src, seg, n):
    out = torch.zeros((n,) + src.shape[1:], dtype=src.dtype)
    return out.index_add_(0, seg, src)
def _pad(x, pw):
    flat = tuple(v for pair in reversed(pw) for v in pair)
    return torch.nn.functional.pad(x, flat)

kernel_name = 'concat_heads__mha_block_cached__compressed_kv_cla__decode'

def setup_inputs():

    _w = (lambda a: (lambda t: t.to(torch.bfloat16) if t.is_floating_point() else t)(torch.as_tensor(a)))
    def _A_setup():
        B, Sq, D = 2, 1, 512
        H, Sk, Dh = 32, 4096, 128
        return {
            "x": _w((lambda *s: torch.randn(*s, dtype=torch.bfloat16) * 1.6)(B, Sq, D)),
            "k_cache": _w((lambda *s: torch.randn(*s, dtype=torch.bfloat16) * 1.6)(B, H, Sk, Dh)),
            "v_cache": _w((lambda *s: torch.randn(*s, dtype=torch.bfloat16) * 0.05)(B, H, Sk, Dh)),
            "wq": _w((lambda *s: torch.randn(*s, dtype=torch.bfloat16) * 1.6)(D, H * Dh) * (D ** -0.5)),
            "wo": _w((lambda *s: torch.randn(*s, dtype=torch.bfloat16) * 0.05)(H * Dh, D) * ((H * Dh) ** -0.5)),
        }
    _A_in = _A_setup()

    def _B_setup():
        B, H, Sq, Sk, D, M = 2, 32, 1, 4096, 128, 512
        Dc = 4 * D
        return {
            "x": _w((lambda *s: torch.randn(*s, dtype=torch.bfloat16) * 3.2)(B, Sq, M)),
            "c_kv": _w((lambda *s: torch.randn(*s, dtype=torch.bfloat16) * 0.1)(B, Sk, Dc)),
            "w_q": _w((lambda *s: torch.randn(*s, dtype=torch.bfloat16) * 6.4)(M, H, D) * (M ** -0.5)),
            "w_uk": _w((lambda *s: torch.randn(*s, dtype=torch.bfloat16) * 6.4)(Dc, H, D) * (Dc ** -0.5)),
            "w_uv": _w((lambda *s: torch.randn(*s, dtype=torch.bfloat16) * 0.1)(Dc, H, D) * (Dc ** -0.5)),
            "w_o": _w((lambda *s: torch.randn(*s, dtype=torch.bfloat16) * 0.1)(H, D, M) * ((H * D) ** -0.5)),
        }
    _B_in = _B_setup()

    return {
        "A_x": _A_in["x"],
        "A_k_cache": _A_in["k_cache"],
        "A_v_cache": _A_in["v_cache"],
        "A_wq": _A_in["wq"],
        "A_wo": _A_in["wo"],
        "B_x": _B_in["x"],
        "B_c_kv": _B_in["c_kv"],
        "B_w_q": _B_in["w_q"],
        "B_w_uk": _B_in["w_uk"],
        "B_w_uv": _B_in["w_uv"],
        "B_w_o": _B_in["w_o"],
    }

def reference(A_x, A_k_cache, A_v_cache, A_wq, A_wo, B_x, B_c_kv, B_w_q, B_w_uk, B_w_uv, B_w_o):
    def _A_ref(x, k_cache, v_cache, wq, wo):
        B, Sq, D = x.shape
        H, Dh = 32, 128
        q = (lambda x, *d: x.permute(*d))((x @ wq).reshape(B, Sq, H, Dh), 0, 2, 1, 3)
        scores = torch.einsum("bhqd,bhkd->bhqk", q, k_cache) * (Dh ** -0.5)
        p = _softmax(scores, axis=-1)
        o = torch.einsum("bhqk,bhkd->bhqd", p, v_cache)
        return (lambda x, *d: x.permute(*d))(o, 0, 2, 1, 3).reshape(B, Sq, H * Dh) @ wo

    def _B_ref(x, c_kv, w_q, w_uk, w_uv, w_o):
        B, Sq, M = x.shape[0], x.shape[1], x.shape[2]
        Sk = c_kv.shape[1]
        H, D = w_q.shape[1], w_q.shape[2]
        q = torch.einsum("bqm,mhd->bhqd", x, w_q)
        k = torch.einsum("bkc,chd->bhkd", c_kv, w_uk)
        v = torch.einsum("bkc,chd->bhkd", c_kv, w_uv)
        scores = torch.einsum("bhqd,bhkd->bhqk", q, k) * (D ** -0.5)
        off = Sk - Sq
        qi = torch.arange(Sq)[:, None]
        kj = torch.arange(Sk)[None, :]
        cmask = kj <= (qi + off)
        scores = torch.where(cmask[None, None], scores, -1e9)
        p = _softmax(scores, axis=-1)
        ctx = torch.einsum("bhqk,bhkd->bhqd", p, v)
        return torch.einsum("bhqd,hdm->bqm", ctx, w_o)

    a = _A_ref(A_x, A_k_cache, A_v_cache, A_wq, A_wo)
    b = _B_ref(B_x, B_c_kv, B_w_q, B_w_uk, B_w_uv, B_w_o)
    return torch.concatenate([a, b], axis=-1)
```

```asm
; @launch kernel=concat_heads__mha_block_cached__compressed_kv_cla__decode_kernel grid=(256,1,1) block=(256,1,1) lds=155648
.amdgcn_target "amdgcn-amd-amdhsa--gfx950"
.text
.globl concat_heads__mha_block_cached__compressed_kv_cla__decode_kernel
.p2align 8
.type concat_heads__mha_block_cached__compressed_kv_cla__decode_kernel,@function
concat_heads__mha_block_cached__compressed_kv_cla__decode_kernel:

    s_cmp_ge_u32 s2, 256
    s_cbranch_scc1 MAIN_exit
    s_load_dwordx16 s[16:31], s[0:1], 0
    s_load_dwordx8 s[32:39], s[0:1], 64
    s_load_dwordx4 s[40:43], s[0:1], 96
    s_waitcnt lgkmcnt(0)
    s_cmp_lt_u32 s2, 64
    s_cbranch_scc1 ROLE_B
    s_sub_u32 s3, s2, 64
    s_and_b32 s11, s3, 7
    s_lshr_b32 s12, s3, 3
    s_mul_i32 s13, s12, 43
    s_lshr_b32 s13, s13, 8
    s_lshl_b32 s11, s11, 2
    s_add_u32 s4, s11, s13
    s_mul_i32 s13, s13, 6
    s_sub_u32 s12, s12, s13
    s_cmp_ge_u32 s12, 3
    s_cselect_b32 s5, 1, 0
    s_mul_i32 s13, s5, 3
    s_sub_u32 s6, s12, s13
    v_and_b32 v1, 63, v0
    v_lshrrev_b32 v2, 4, v1
    v_and_b32 v3, 15, v1
    v_lshlrev_b32 v4, 4, v1
    v_readfirstlane_b32 s7, v0
    s_nop 3
    s_lshr_b32 s7, s7, 6
    s_mov_b32 s68, 0x3db504f3
    s_mov_b32 s69, 0x3fb8aa3b
    s_mov_b32 s70, 0xbfb8aa3b
    s_mov_b32 s71, 0x05040100
    s_mov_b32 s72, 0x07060302
    s_mov_b32 s44, s18
    s_and_b32 s45, s19, 0xffff
    s_mov_b32 s46, 0x4000000
    s_mov_b32 s47, 0x00020000
    s_mov_b32 s48, s20
    s_and_b32 s49, s21, 0xffff
    s_mov_b32 s50, 0x4000000
    s_mov_b32 s51, 0x00020000
    s_mov_b32 s52, s22
    s_and_b32 s53, s23, 0xffff
    s_mov_b32 s54, 0x400000
    s_mov_b32 s55, 0x00020000
    s_mov_b32 s56, s24
    s_and_b32 s57, s25, 0xffff
    s_mov_b32 s58, 0x400000
    s_mov_b32 s59, 0x00020000
    s_mov_b32 s60, s16
    s_and_b32 s61, s17, 0xffff
    s_mov_b32 s62, 0x800
    s_mov_b32 s63, 0x00020000
    s_mov_b32 s64, s42
    s_and_b32 s65, s43, 0xffff
    s_mov_b32 s66, 0x10000000
    s_mov_b32 s67, 0x00020000
    s_lshl_b32 s11, s5, 5
    s_add_u32 s11, s11, s4
    s_lshl_b32 s11, s11, 20
    s_lshl_b32 s12, s6, 2
    s_add_u32 s12, s12, s7
    s_lshl_b32 s12, s12, 12
    s_add_u32 s8, s11, s12
    s_cmp_eq_u32 s6, 0
    s_cselect_b32 s73, 0, 0x40000000
    s_lshl_b32 s11, s7, 20
    s_lshl_b32 s12, s4, 8
    s_add_u32 s9, s11, s12
    s_lshl_b32 s11, s4, 17
    s_lshl_b32 s12, s7, 15
    s_add_u32 s10, s11, s12
    s_lshl_b32 s11, s5, 10
    s_lshl_b32 s12, s7, 8
    s_add_u32 s13, s11, s12
    v_lshlrev_b32 v5, 18, v2
    v_lshl_add_u32 v5, v3, 4, v5
    v_lshlrev_b32 v6, 6, v2
    buffer_load_dwordx4 v[40:43], v6, s[60:63], s13 offen offset:0
    buffer_load_dwordx4 v[44:47], v6, s[60:63], s13 offen offset:16
    buffer_load_dwordx4 v[48:51], v6, s[60:63], s13 offen offset:32
    buffer_load_dwordx4 v[52:55], v6, s[60:63], s13 offen offset:48
    v_mov_b32 v8, 0
    v_mov_b32 v9, 0
    v_mov_b32 v10, 0
    v_mov_b32 v11, 0
    v_mov_b32 v12, 0
    v_mov_b32 v13, 0
    v_mov_b32 v14, 0
    v_mov_b32 v15, 0
    buffer_load_dwordx4 v[64:67], v5, s[52:55], s9 offen
    s_add_u32 s9, s9, 8192
    buffer_load_dwordx4 v[68:71], v5, s[52:55], s9 offen
    s_add_u32 s9, s9, 8192
    buffer_load_dwordx4 v[72:75], v5, s[52:55], s9 offen
    s_add_u32 s9, s9, 8192
    buffer_load_dwordx4 v[76:79], v5, s[52:55], s9 offen
    s_add_u32 s9, s9, 8192
    buffer_load_dwordx4 v[80:83], v5, s[52:55], s9 offen
    s_add_u32 s9, s9, 8192
    buffer_load_dwordx4 v[84:87], v5, s[52:55], s9 offen
    s_add_u32 s9, s9, 8192
    buffer_load_dwordx4 v[88:91], v5, s[52:55], s9 offen
    s_add_u32 s9, s9, 8192
    buffer_load_dwordx4 v[92:95], v5, s[52:55], s9 offen
    s_add_u32 s9, s9, 8192
    buffer_load_dwordx4 v[96:99], v5, s[52:55], s9 offen
    s_add_u32 s9, s9, 8192
    buffer_load_dwordx4 v[100:103], v5, s[52:55], s9 offen
    s_add_u32 s9, s9, 8192
    buffer_load_dwordx4 v[104:107], v5, s[52:55], s9 offen
    s_add_u32 s9, s9, 8192
    buffer_load_dwordx4 v[108:111], v5, s[52:55], s9 offen
    s_add_u32 s9, s9, 8192
    buffer_load_dwordx4 v[112:115], v5, s[52:55], s9 offen
    s_add_u32 s9, s9, 8192
    buffer_load_dwordx4 v[116:119], v5, s[52:55], s9 offen
    s_add_u32 s9, s9, 8192
    buffer_load_dwordx4 v[120:123], v5, s[52:55], s9 offen
    s_add_u32 s9, s9, 8192
    buffer_load_dwordx4 v[124:127], v5, s[52:55], s9 offen
    s_add_u32 s9, s9, 8192
    s_waitcnt vmcnt(16)
    s_waitcnt vmcnt(8)
    v_perm_b32 v26, v68, v64, s71
    v_perm_b32 v27, v68, v64, s72
    v_dot2_f32_bf16 v8, v26, v40, v8
    v_dot2_f32_bf16 v9, v27, v40, v9
    v_perm_b32 v26, v69, v65, s71
    v_perm_b32 v27, v69, v65, s72
    v_dot2_f32_bf16 v10, v26, v40, v10
    v_dot2_f32_bf16 v11, v27, v40, v11
    v_perm_b32 v26, v70, v66, s71
    v_perm_b32 v27, v70, v66, s72
    v_dot2_f32_bf16 v12, v26, v40, v12
    v_dot2_f32_bf16 v13, v27, v40, v13
    v_perm_b32 v26, v71, v67, s71
    v_perm_b32 v27, v71, v67, s72
    v_dot2_f32_bf16 v14, v26, v40, v14
    v_dot2_f32_bf16 v15, v27, v40, v15
    v_perm_b32 v26, v76, v72, s71
    v_perm_b32 v27, v76, v72, s72
    v_dot2_f32_bf16 v8, v26, v41, v8
    v_dot2_f32_bf16 v9, v27, v41, v9
    v_perm_b32 v26, v77, v73, s71
    v_perm_b32 v27, v77, v73, s72
    v_dot2_f32_bf16 v10, v26, v41, v10
    v_dot2_f32_bf16 v11, v27, v41, v11
    v_perm_b32 v26, v78, v74, s71
    v_perm_b32 v27, v78, v74, s72
    v_dot2_f32_bf16 v12, v26, v41, v12
    v_dot2_f32_bf16 v13, v27, v41, v13
    v_perm_b32 v26, v79, v75, s71
    v_perm_b32 v27, v79, v75, s72
    v_dot2_f32_bf16 v14, v26, v41, v14
    v_dot2_f32_bf16 v15, v27, v41, v15
    v_perm_b32 v26, v84, v80, s71
    v_perm_b32 v27, v84, v80, s72
    v_dot2_f32_bf16 v8, v26, v42, v8
    v_dot2_f32_bf16 v9, v27, v42, v9
    v_perm_b32 v26, v85, v81, s71
    v_perm_b32 v27, v85, v81, s72
    v_dot2_f32_bf16 v10, v26, v42, v10
    v_dot2_f32_bf16 v11, v27, v42, v11
    v_perm_b32 v26, v86, v82, s71
    v_perm_b32 v27, v86, v82, s72
    v_dot2_f32_bf16 v12, v26, v42, v12
    v_dot2_f32_bf16 v13, v27, v42, v13
    v_perm_b32 v26, v87, v83, s71
    v_perm_b32 v27, v87, v83, s72
    v_dot2_f32_bf16 v14, v26, v42, v14
    v_dot2_f32_bf16 v15, v27, v42, v15
    v_perm_b32 v26, v92, v88, s71
    v_perm_b32 v27, v92, v88, s72
    v_dot2_f32_bf16 v8, v26, v43, v8
    v_dot2_f32_bf16 v9, v27, v43, v9
    v_perm_b32 v26, v93, v89, s71
    v_perm_b32 v27, v93, v89, s72
    v_dot2_f32_bf16 v10, v26, v43, v10
    v_dot2_f32_bf16 v11, v27, v43, v11
    v_perm_b32 v26, v94, v90, s71
    v_perm_b32 v27, v94, v90, s72
    v_dot2_f32_bf16 v12, v26, v43, v12
    v_dot2_f32_bf16 v13, v27, v43, v13
    v_perm_b32 v26, v95, v91, s71
    v_perm_b32 v27, v95, v91, s72
    v_dot2_f32_bf16 v14, v26, v43, v14
    v_dot2_f32_bf16 v15, v27, v43, v15
    buffer_load_dwordx4 v[64:67], v5, s[52:55], s9 offen
    s_add_u32 s9, s9, 8192
    buffer_load_dwordx4 v[68:71], v5, s[52:55], s9 offen
    s_add_u32 s9, s9, 8192
    buffer_load_dwordx4 v[72:75], v5, s[52:55], s9 offen
    s_add_u32 s9, s9, 8192
    buffer_load_dwordx4 v[76:79], v5, s[52:55], s9 offen
    s_add_u32 s9, s9, 8192
    buffer_load_dwordx4 v[80:83], v5, s[52:55], s9 offen
    s_add_u32 s9, s9, 8192
    buffer_load_dwordx4 v[84:87], v5, s[52:55], s9 offen
    s_add_u32 s9, s9, 8192
    buffer_load_dwordx4 v[88:91], v5, s[52:55], s9 offen
    s_add_u32 s9, s9, 8192
    buffer_load_dwordx4 v[92:95], v5, s[52:55], s9 offen
    s_add_u32 s9, s9, 8192
    s_waitcnt vmcnt(8)
    v_perm_b32 v26, v100, v96, s71
    v_perm_b32 v27, v100, v96, s72
    v_dot2_f32_bf16 v8, v26, v44, v8
    v_dot2_f32_bf16 v9, v27, v44, v9
    v_perm_b32 v26, v101, v97, s71
    v_perm_b32 v27, v101, v97, s72
    v_dot2_f32_bf16 v10, v26, v44, v10
    v_dot2_f32_bf16 v11, v27, v44, v11
    v_perm_b32 v26, v102, v98, s71
    v_perm_b32 v27, v102, v98, s72
    v_dot2_f32_bf16 v12, v26, v44, v12
    v_dot2_f32_bf16 v13, v27, v44, v13
    v_perm_b32 v26, v103, v99, s71
    v_perm_b32 v27, v103, v99, s72
    v_dot2_f32_bf16 v14, v26, v44, v14
    v_dot2_f32_bf16 v15, v27, v44, v15
    v_perm_b32 v26, v108, v104, s71
    v_perm_b32 v27, v108, v104, s72
    v_dot2_f32_bf16 v8, v26, v45, v8
    v_dot2_f32_bf16 v9, v27, v45, v9
    v_perm_b32 v26, v109, v105, s71
    v_perm_b32 v27, v109, v105, s72
    v_dot2_f32_bf16 v10, v26, v45, v10
    v_dot2_f32_bf16 v11, v27, v45, v11
    v_perm_b32 v26, v110, v106, s71
    v_perm_b32 v27, v110, v106, s72
    v_dot2_f32_bf16 v12, v26, v45, v12
    v_dot2_f32_bf16 v13, v27, v45, v13
    v_perm_b32 v26, v111, v107, s71
    v_perm_b32 v27, v111, v107, s72
    v_dot2_f32_bf16 v14, v26, v45, v14
    v_dot2_f32_bf16 v15, v27, v45, v15
    v_perm_b32 v26, v116, v112, s71
    v_perm_b32 v27, v116, v112, s72
    v_dot2_f32_bf16 v8, v26, v46, v8
    v_dot2_f32_bf16 v9, v27, v46, v9
    v_perm_b32 v26, v117, v113, s71
    v_perm_b32 v27, v117, v113, s72
    v_dot2_f32_bf16 v10, v26, v46, v10
    v_dot2_f32_bf16 v11, v27, v46, v11
    v_perm_b32 v26, v118, v114, s71
    v_perm_b32 v27, v118, v114, s72
    v_dot2_f32_bf16 v12, v26, v46, v12
    v_dot2_f32_bf16 v13, v27, v46, v13
    v_perm_b32 v26, v119, v115, s71
    v_perm_b32 v27, v119, v115, s72
    v_dot2_f32_bf16 v14, v26, v46, v14
    v_dot2_f32_bf16 v15, v27, v46, v15
    v_perm_b32 v26, v124, v120, s71
    v_perm_b32 v27, v124, v120, s72
    v_dot2_f32_bf16 v8, v26, v47, v8
    v_dot2_f32_bf16 v9, v27, v47, v9
    v_perm_b32 v26, v125, v121, s71
    v_perm_b32 v27, v125, v121, s72
    v_dot2_f32_bf16 v10, v26, v47, v10
    v_dot2_f32_bf16 v11, v27, v47, v11
    v_perm_b32 v26, v126, v122, s71
    v_perm_b32 v27, v126, v122, s72
    v_dot2_f32_bf16 v12, v26, v47, v12
    v_dot2_f32_bf16 v13, v27, v47, v13
    v_perm_b32 v26, v127, v123, s71
    v_perm_b32 v27, v127, v123, s72
    v_dot2_f32_bf16 v14, v26, v47, v14
    v_dot2_f32_bf16 v15, v27, v47, v15
    buffer_load_dwordx4 v[96:99], v5, s[52:55], s9 offen
    s_add_u32 s9, s9, 8192
    buffer_load_dwordx4 v[100:103], v5, s[52:55], s9 offen
    s_add_u32 s9, s9, 8192
    buffer_load_dwordx4 v[104:107], v5, s[52:55], s9 offen
    s_add_u32 s9, s9, 8192
    buffer_load_dwordx4 v[108:111], v5, s[52:55], s9 offen
    s_add_u32 s9, s9, 8192
    buffer_load_dwordx4 v[112:115], v5, s[52:55], s9 offen
    s_add_u32 s9, s9, 8192
    buffer_load_dwordx4 v[116:119], v5, s[52:55], s9 offen
    s_add_u32 s9, s9, 8192
    buffer_load_dwordx4 v[120:123], v5, s[52:55], s9 offen
    s_add_u32 s9, s9, 8192
    buffer_load_dwordx4 v[124:127], v5, s[52:55], s9 offen
    s_add_u32 s9, s9, 8192
    s_waitcnt vmcnt(8)
    v_perm_b32 v26, v68, v64, s71
    v_perm_b32 v27, v68, v64, s72
    v_dot2_f32_bf16 v8, v26, v48, v8
    v_dot2_f32_bf16 v9, v27, v48, v9
    v_perm_b32 v26, v69, v65, s71
    v_perm_b32 v27, v69, v65, s72
    v_dot2_f32_bf16 v10, v26, v48, v10
    v_dot2_f32_bf16 v11, v27, v48, v11
    v_perm_b32 v26, v70, v66, s71
    v_perm_b32 v27, v70, v66, s72
    v_dot2_f32_bf16 v12, v26, v48, v12
    v_dot2_f32_bf16 v13, v27, v48, v13
    v_perm_b32 v26, v71, v67, s71
    v_perm_b32 v27, v71, v67, s72
    v_dot2_f32_bf16 v14, v26, v48, v14
    v_dot2_f32_bf16 v15, v27, v48, v15
    v_perm_b32 v26, v76, v72, s71
    v_perm_b32 v27, v76, v72, s72
    v_dot2_f32_bf16 v8, v26, v49, v8
    v_dot2_f32_bf16 v9, v27, v49, v9
    v_perm_b32 v26, v77, v73, s71
    v_perm_b32 v27, v77, v73, s72
    v_dot2_f32_bf16 v10, v26, v49, v10
    v_dot2_f32_bf16 v11, v27, v49, v11
    v_perm_b32 v26, v78, v74, s71
    v_perm_b32 v27, v78, v74, s72
    v_dot2_f32_bf16 v12, v26, v49, v12
    v_dot2_f32_bf16 v13, v27, v49, v13
    v_perm_b32 v26, v79, v75, s71
    v_perm_b32 v27, v79, v75, s72
    v_dot2_f32_bf16 v14, v26, v49, v14
    v_dot2_f32_bf16 v15, v27, v49, v15
    v_perm_b32 v26, v84, v80, s71
    v_perm_b32 v27, v84, v80, s72
    v_dot2_f32_bf16 v8, v26, v50, v8
    v_dot2_f32_bf16 v9, v27, v50, v9
    v_perm_b32 v26, v85, v81, s71
    v_perm_b32 v27, v85, v81, s72
    v_dot2_f32_bf16 v10, v26, v50, v10
    v_dot2_f32_bf16 v11, v27, v50, v11
    v_perm_b32 v26, v86, v82, s71
    v_perm_b32 v27, v86, v82, s72
    v_dot2_f32_bf16 v12, v26, v50, v12
    v_dot2_f32_bf16 v13, v27, v50, v13
    v_perm_b32 v26, v87, v83, s71
    v_perm_b32 v27, v87, v83, s72
    v_dot2_f32_bf16 v14, v26, v50, v14
    v_dot2_f32_bf16 v15, v27, v50, v15
    v_perm_b32 v26, v92, v88, s71
    v_perm_b32 v27, v92, v88, s72
    v_dot2_f32_bf16 v8, v26, v51, v8
    v_dot2_f32_bf16 v9, v27, v51, v9
    v_perm_b32 v26, v93, v89, s71
    v_perm_b32 v27, v93, v89, s72
    v_dot2_f32_bf16 v10, v26, v51, v10
    v_dot2_f32_bf16 v11, v27, v51, v11
    v_perm_b32 v26, v94, v90, s71
    v_perm_b32 v27, v94, v90, s72
    v_dot2_f32_bf16 v12, v26, v51, v12
    v_dot2_f32_bf16 v13, v27, v51, v13
    v_perm_b32 v26, v95, v91, s71
    v_perm_b32 v27, v95, v91, s72
    v_dot2_f32_bf16 v14, v26, v51, v14
    v_dot2_f32_bf16 v15, v27, v51, v15
    buffer_load_dwordx4 v[64:67], v4, s[44:47], s8 offen offset:0 nt
    buffer_load_dwordx4 v[68:71], v4, s[44:47], s8 offen offset:1024 nt
    buffer_load_dwordx4 v[72:75], v4, s[44:47], s8 offen offset:2048 nt
    buffer_load_dwordx4 v[76:79], v4, s[44:47], s8 offen offset:3072 nt
    buffer_load_dwordx4 v[80:83], v4, s[48:51], s8 offen offset:0 nt
    buffer_load_dwordx4 v[84:87], v4, s[48:51], s8 offen offset:1024 nt
    buffer_load_dwordx4 v[88:91], v4, s[48:51], s8 offen offset:2048 nt
    buffer_load_dwordx4 v[92:95], v4, s[48:51], s8 offen offset:3072 nt
    s_add_u32 s8, s8, 49152
    s_waitcnt vmcnt(8)
    v_perm_b32 v26, v100, v96, s71
    v_perm_b32 v27, v100, v96, s72
    v_dot2_f32_bf16 v8, v26, v52, v8
    v_dot2_f32_bf16 v9, v27, v52, v9
    v_perm_b32 v26, v101, v97, s71
    v_perm_b32 v27, v101, v97, s72
    v_dot2_f32_bf16 v10, v26, v52, v10
    v_dot2_f32_bf16 v11, v27, v52, v11
    v_perm_b32 v26, v102, v98, s71
    v_perm_b32 v27, v102, v98, s72
    v_dot2_f32_bf16 v12, v26, v52, v12
    v_dot2_f32_bf16 v13, v27, v52, v13
    v_perm_b32 v26, v103, v99, s71
    v_perm_b32 v27, v103, v99, s72
    v_dot2_f32_bf16 v14, v26, v52, v14
    v_dot2_f32_bf16 v15, v27, v52, v15
    v_perm_b32 v26, v108, v104, s71
    v_perm_b32 v27, v108, v104, s72
    v_dot2_f32_bf16 v8, v26, v53, v8
    v_dot2_f32_bf16 v9, v27, v53, v9
    v_perm_b32 v26, v109, v105, s71
    v_perm_b32 v27, v109, v105, s72
    v_dot2_f32_bf16 v10, v26, v53, v10
    v_dot2_f32_bf16 v11, v27, v53, v11
    v_perm_b32 v26, v110, v106, s71
    v_perm_b32 v27, v110, v106, s72
    v_dot2_f32_bf16 v12, v26, v53, v12
    v_dot2_f32_bf16 v13, v27, v53, v13
    v_perm_b32 v26, v111, v107, s71
    v_perm_b32 v27, v111, v107, s72
    v_dot2_f32_bf16 v14, v26, v53, v14
    v_dot2_f32_bf16 v15, v27, v53, v15
    v_perm_b32 v26, v116, v112, s71
    v_perm_b32 v27, v116, v112, s72
    v_dot2_f32_bf16 v8, v26, v54, v8
    v_dot2_f32_bf16 v9, v27, v54, v9
    v_perm_b32 v26, v117, v113, s71
    v_perm_b32 v27, v117, v113, s72
    v_dot2_f32_bf16 v10, v26, v54, v10
    v_dot2_f32_bf16 v11, v27, v54, v11
    v_perm_b32 v26, v118, v114, s71
    v_perm_b32 v27, v118, v114, s72
    v_dot2_f32_bf16 v12, v26, v54, v12
    v_dot2_f32_bf16 v13, v27, v54, v13
    v_perm_b32 v26, v119, v115, s71
    v_perm_b32 v27, v119, v115, s72
    v_dot2_f32_bf16 v14, v26, v54, v14
    v_dot2_f32_bf16 v15, v27, v54, v15
    v_perm_b32 v26, v124, v120, s71
    v_perm_b32 v27, v124, v120, s72
    v_dot2_f32_bf16 v8, v26, v55, v8
    v_dot2_f32_bf16 v9, v27, v55, v9
    v_perm_b32 v26, v125, v121, s71
    v_perm_b32 v27, v125, v121, s72
    v_dot2_f32_bf16 v10, v26, v55, v10
    v_dot2_f32_bf16 v11, v27, v55, v11
    v_perm_b32 v26, v126, v122, s71
    v_perm_b32 v27, v126, v122, s72
    v_dot2_f32_bf16 v12, v26, v55, v12
    v_dot2_f32_bf16 v13, v27, v55, v13
    v_perm_b32 v26, v127, v123, s71
    v_perm_b32 v27, v127, v123, s72
    v_dot2_f32_bf16 v14, v26, v55, v14
    v_dot2_f32_bf16 v15, v27, v55, v15
    buffer_load_dwordx4 v[96:99], v4, s[44:47], s8 offen offset:0 nt
    buffer_load_dwordx4 v[100:103], v4, s[44:47], s8 offen offset:1024 nt
    buffer_load_dwordx4 v[104:107], v4, s[44:47], s8 offen offset:2048 nt
    buffer_load_dwordx4 v[108:111], v4, s[44:47], s8 offen offset:3072 nt
    buffer_load_dwordx4 v[112:115], v4, s[48:51], s8 offen offset:0 nt
    buffer_load_dwordx4 v[116:119], v4, s[48:51], s8 offen offset:1024 nt
    buffer_load_dwordx4 v[120:123], v4, s[48:51], s8 offen offset:2048 nt
    buffer_load_dwordx4 v[124:127], v4, s[48:51], s8 offen offset:3072 nt
    s_add_u32 s8, s8, 49152
    s_nop 3
    v_lshlrev_b32 v7, 2, v2
    s_lshl_b32 s11, s7, 4
    v_add_u32 v7, s11, v7
    v_lshlrev_b32 v26, 7, v7
    v_lshl_add_u32 v26, v3, 5, v26
    ds_write_b128 v26, v[8:11] offset:0
    ds_write_b128 v26, v[12:15] offset:16
    s_waitcnt lgkmcnt(0)
    s_barrier
    v_and_b32 v26, 127, v0
    v_lshlrev_b32 v26, 2, v26
    ds_read_b32 v40, v26 offset:0
    ds_read_b32 v41, v26 offset:512
    ds_read_b32 v42, v26 offset:1024
    ds_read_b32 v43, v26 offset:1536
    ds_read_b32 v44, v26 offset:2048
    ds_read_b32 v45, v26 offset:2560
    ds_read_b32 v46, v26 offset:3072
    ds_read_b32 v47, v26 offset:3584
    ds_read_b32 v48, v26 offset:4096
    ds_read_b32 v49, v26 offset:4608
    ds_read_b32 v50, v26 offset:5120
    ds_read_b32 v51, v26 offset:5632
    ds_read_b32 v52, v26 offset:6144
    ds_read_b32 v53, v26 offset:6656
    ds_read_b32 v54, v26 offset:7168
    ds_read_b32 v55, v26 offset:7680
    s_waitcnt lgkmcnt(0)
    v_add_f32 v27, v40, v41
    v_add_f32 v27, v27, v42
    v_add_f32 v27, v27, v43
    v_add_f32 v27, v27, v44
    v_add_f32 v27, v27, v45
    v_add_f32 v27, v27, v46
    v_add_f32 v27, v27, v47
    v_add_f32 v27, v27, v48
    v_add_f32 v27, v27, v49
    v_add_f32 v27, v27, v50
    v_add_f32 v27, v27, v51
    v_add_f32 v27, v27, v52
    v_add_f32 v27, v27, v53
    v_add_f32 v27, v27, v54
    v_add_f32 v27, v27, v55
    v_cvt_pk_bf16_f32 v27, v27, v27
    v_lshrrev_b32 v26, 1, v26
    ds_write_b16 v26, v27 offset:8192
    s_waitcnt lgkmcnt(0)
    s_barrier
    v_lshlrev_b32 v26, 4, v3
    ds_read_b128 v[16:19], v26 offset:8192
    v_mov_b32 v20, 0xff800000
    v_mov_b32 v21, 0
    v_mov_b32 v8, 0
    v_mov_b32 v9, 0
    v_mov_b32 v10, 0
    v_mov_b32 v11, 0
    v_mov_b32 v12, 0
    v_mov_b32 v13, 0
    v_mov_b32 v14, 0
    v_mov_b32 v15, 0
    s_waitcnt lgkmcnt(0)
    s_waitcnt vmcnt(12)
    v_dot2_f32_bf16 v22, v64, v16, 0
    v_dot2_f32_bf16 v23, v68, v16, 0
    v_dot2_f32_bf16 v24, v72, v16, 0
    v_dot2_f32_bf16 v25, v76, v16, 0
    v_dot2_f32_bf16 v22, v65, v17, v22
    v_dot2_f32_bf16 v23, v69, v17, v23
    v_dot2_f32_bf16 v24, v73, v17, v24
    v_dot2_f32_bf16 v25, v77, v17, v25
    v_dot2_f32_bf16 v22, v66, v18, v22
    v_dot2_f32_bf16 v23, v70, v18, v23
    v_dot2_f32_bf16 v24, v74, v18, v24
    v_dot2_f32_bf16 v25, v78, v18, v25
    v_dot2_f32_bf16 v22, v67, v19, v22
    v_dot2_f32_bf16 v23, v71, v19, v23
    v_dot2_f32_bf16 v24, v75, v19, v24
    v_dot2_f32_bf16 v25, v79, v19, v25
    v_add_f32_dpp v22, v22, v22 row_ror:8 row_mask:0xf bank_mask:0xf
    v_add_f32_dpp v23, v23, v23 row_ror:8 row_mask:0xf bank_mask:0xf
    v_add_f32_dpp v24, v24, v24 row_ror:8 row_mask:0xf bank_mask:0xf
    v_add_f32_dpp v25, v25, v25 row_ror:8 row_mask:0xf bank_mask:0xf
    v_add_f32_dpp v22, v22, v22 row_ror:4 row_mask:0xf bank_mask:0xf
    v_add_f32_dpp v23, v23, v23 row_ror:4 row_mask:0xf bank_mask:0xf
    v_add_f32_dpp v24, v24, v24 row_ror:4 row_mask:0xf bank_mask:0xf
    v_add_f32_dpp v25, v25, v25 row_ror:4 row_mask:0xf bank_mask:0xf
    v_add_f32_dpp v22, v22, v22 row_ror:2 row_mask:0xf bank_mask:0xf
    v_add_f32_dpp v23, v23, v23 row_ror:2 row_mask:0xf bank_mask:0xf
    v_add_f32_dpp v24, v24, v24 row_ror:2 row_mask:0xf bank_mask:0xf
    v_add_f32_dpp v25, v25, v25 row_ror:2 row_mask:0xf bank_mask:0xf
    v_add_f32_dpp v22, v22, v22 row_ror:1 row_mask:0xf bank_mask:0xf
    v_add_f32_dpp v23, v23, v23 row_ror:1 row_mask:0xf bank_mask:0xf
    v_add_f32_dpp v24, v24, v24 row_ror:1 row_mask:0xf bank_mask:0xf
    v_add_f32_dpp v25, v25, v25 row_ror:1 row_mask:0xf bank_mask:0xf
    buffer_load_dwordx4 v[64:67], v4, s[44:47], s8 offen offset:0 nt
    buffer_load_dwordx4 v[68:71], v4, s[44:47], s8 offen offset:1024 nt
    buffer_load_dwordx4 v[72:75], v4, s[44:47], s8 offen offset:2048 nt
    buffer_load_dwordx4 v[76:79], v4, s[44:47], s8 offen offset:3072 nt
    v_cvt_pk_bf16_f32 v26, v22, v23
    v_cvt_pk_bf16_f32 v27, v24, v25
    v_lshlrev_b32 v34, 16, v26
    v_and_b32 v35, 0xffff0000, v26
    v_lshlrev_b32 v36, 16, v27
    v_and_b32 v37, 0xffff0000, v27
    v_mul_f32 v34, s68, v34
    v_mul_f32 v35, s68, v35
    v_mul_f32 v36, s68, v36
    v_mul_f32 v37, s68, v37
    v_cvt_pk_bf16_f32 v26, v34, v35
    v_cvt_pk_bf16_f32 v27, v36, v37
    v_lshlrev_b32 v34, 16, v26
    v_and_b32 v35, 0xffff0000, v26
    v_lshlrev_b32 v36, 16, v27
    v_and_b32 v37, 0xffff0000, v27
    v_max3_f32 v26, v34, v35, v36
    v_max3_f32 v26, v26, v37, v20
    v_sub_f32 v27, v20, v26
    v_mul_f32 v39, s70, v26
    v_mul_f32 v27, s69, v27
    v_mov_b32 v20, v26
    v_fma_f32 v34, v34, s69, v39
    v_fma_f32 v35, v35, s69, v39
    v_fma_f32 v36, v36, s69, v39
    v_fma_f32 v37, v37, s69, v39
    v_exp_f32 v38, v27
    v_exp_f32 v34, v34
    v_exp_f32 v35, v35
    v_exp_f32 v36, v36
    v_exp_f32 v37, v37
    s_nop 0
    v_fma_f32 v21, v21, v38, v34
    v_mul_f32 v8, v38, v8
    v_mul_f32 v9, v38, v9
    v_mul_f32 v10, v38, v10
    v_mul_f32 v11, v38, v11
    v_mul_f32 v12, v38, v12
    v_mul_f32 v13, v38, v13
    v_mul_f32 v14, v38, v14
    v_mul_f32 v15, v38, v15
    v_add_f32 v26, v35, v36
    v_add_f32 v26, v26, v37
    v_add_f32 v21, v21, v26
    s_waitcnt vmcnt(12)
    v_lshlrev_b32 v26, 16, v80
    v_and_b32 v30, 0xffff0000, v80
    v_lshlrev_b32 v27, 16, v81
    v_and_b32 v31, 0xffff0000, v81
    v_lshlrev_b32 v28, 16, v82
    v_and_b32 v32, 0xffff0000, v82
    v_lshlrev_b32 v29, 16, v83
    v_and_b32 v33, 0xffff0000, v83
    v_fmac_f32 v8, v34, v26
    v_fmac_f32 v9, v34, v30
    v_fmac_f32 v10, v34, v27
    v_fmac_f32 v11, v34, v31
    v_fmac_f32 v12, v34, v28
    v_fmac_f32 v13, v34, v32
    v_fmac_f32 v14, v34, v29
    v_fmac_f32 v15, v34, v33
    v_lshlrev_b32 v26, 16, v84
    v_and_b32 v30, 0xffff0000, v84
    v_lshlrev_b32 v27, 16, v85
    v_and_b32 v31, 0xffff0000, v85
    v_lshlrev_b32 v28, 16, v86
    v_and_b32 v32, 0xffff0000, v86
    v_lshlrev_b32 v29, 16, v87
    v_and_b32 v33, 0xffff0000, v87
    v_fmac_f32 v8, v35, v26
    v_fmac_f32 v9, v35, v30
    v_fmac_f32 v10, v35, v27
    v_fmac_f32 v11, v35, v31
    v_fmac_f32 v12, v35, v28
    v_fmac_f32 v13, v35, v32
    v_fmac_f32 v14, v35, v29
    v_fmac_f32 v15, v35, v33
    v_lshlrev_b32 v26, 16, v88
    v_and_b32 v30, 0xffff0000, v88
    v_lshlrev_b32 v27, 16, v89
    v_and_b32 v31, 0xffff0000, v89
    v_lshlrev_b32 v28, 16, v90
    v_and_b32 v32, 0xffff0000, v90
    v_lshlrev_b32 v29, 16, v91
    v_and_b32 v33, 0xffff0000, v91
    v_fmac_f32 v8, v36, v26
    v_fmac_f32 v9, v36, v30
    v_fmac_f32 v10, v36, v27
    v_fmac_f32 v11, v36, v31
    v_fmac_f32 v12, v36, v28
    v_fmac_f32 v13, v36, v32
    v_fmac_f32 v14, v36, v29
    v_fmac_f32 v15, v36, v33
    v_lshlrev_b32 v26, 16, v92
    v_and_b32 v30, 0xffff0000, v92
    v_lshlrev_b32 v27, 16, v93
    v_and_b32 v31, 0xffff0000, v93
    v_lshlrev_b32 v28, 16, v94
    v_and_b32 v32, 0xffff0000, v94
    v_lshlrev_b32 v29, 16, v95
    v_and_b32 v33, 0xffff0000, v95
    v_fmac_f32 v8, v37, v26
    v_fmac_f32 v9, v37, v30
    v_fmac_f32 v10, v37, v27
    v_fmac_f32 v11, v37, v31
    v_fmac_f32 v12, v37, v28
    v_fmac_f32 v13, v37, v32
    v_fmac_f32 v14, v37, v29
    v_fmac_f32 v15, v37, v33
    buffer_load_dwordx4 v[80:83], v4, s[48:51], s8 offen offset:0 nt
    buffer_load_dwordx4 v[84:87], v4, s[48:51], s8 offen offset:1024 nt
    buffer_load_dwordx4 v[88:91], v4, s[48:51], s8 offen offset:2048 nt
    buffer_load_dwordx4 v[92:95], v4, s[48:51], s8 offen offset:3072 nt
    s_add_u32 s8, s8, 49152
    s_waitcnt vmcnt(12)
    v_dot2_f32_bf16 v22, v96, v16, 0
    v_dot2_f32_bf16 v23, v100, v16, 0
    v_dot2_f32_bf16 v24, v104, v16, 0
    v_dot2_f32_bf16 v25, v108, v16, 0
    v_dot2_f32_bf16 v22, v97, v17, v22
    v_dot2_f32_bf16 v23, v101, v17, v23
    v_dot2_f32_bf16 v24, v105, v17, v24
    v_dot2_f32_bf16 v25, v109, v17, v25
    v_dot2_f32_bf16 v22, v98, v18, v22
    v_dot2_f32_bf16 v23, v102, v18, v23
    v_dot2_f32_bf16 v24, v106, v18, v24
    v_dot2_f32_bf16 v25, v110, v18, v25
    v_dot2_f32_bf16 v22, v99, v19, v22
    v_dot2_f32_bf16 v23, v103, v19, v23
    v_dot2_f32_bf16 v24, v107, v19, v24
    v_dot2_f32_bf16 v25, v111, v19, v25
    v_add_f32_dpp v22, v22, v22 row_ror:8 row_mask:0xf bank_mask:0xf
    v_add_f32_dpp v23, v23, v23 row_ror:8 row_mask:0xf bank_mask:0xf
    v_add_f32_dpp v24, v24, v24 row_ror:8 row_mask:0xf bank_mask:0xf
    v_add_f32_dpp v25, v25, v25 row_ror:8 row_mask:0xf bank_mask:0xf
    v_add_f32_dpp v22, v22, v22 row_ror:4 row_mask:0xf bank_mask:0xf
    v_add_f32_dpp v23, v23, v23 row_ror:4 row_mask:0xf bank_mask:0xf
    v_add_f32_dpp v24, v24, v24 row_ror:4 row_mask:0xf bank_mask:0xf
    v_add_f32_dpp v25, v25, v25 row_ror:4 row_mask:0xf bank_mask:0xf
    v_add_f32_dpp v22, v22, v22 row_ror:2 row_mask:0xf bank_mask:0xf
    v_add_f32_dpp v23, v23, v23 row_ror:2 row_mask:0xf bank_mask:0xf
    v_add_f32_dpp v24, v24, v24 row_ror:2 row_mask:0xf bank_mask:0xf
    v_add_f32_dpp v25, v25, v25 row_ror:2 row_mask:0xf bank_mask:0xf
    v_add_f32_dpp v22, v22, v22 row_ror:1 row_mask:0xf bank_mask:0xf
    v_add_f32_dpp v23, v23, v23 row_ror:1 row_mask:0xf bank_mask:0xf
    v_add_f32_dpp v24, v24, v24 row_ror:1 row_mask:0xf bank_mask:0xf
    v_add_f32_dpp v25, v25, v25 row_ror:1 row_mask:0xf bank_mask:0xf
    buffer_load_dwordx4 v[96:99], v4, s[44:47], s8 offen offset:0 nt
    buffer_load_dwordx4 v[100:103], v4, s[44:47], s8 offen offset:1024 nt
    buffer_load_dwordx4 v[104:107], v4, s[44:47], s8 offen offset:2048 nt
    buffer_load_dwordx4 v[108:111], v4, s[44:47], s8 offen offset:3072 nt
    v_cvt_pk_bf16_f32 v26, v22, v23
    v_cvt_pk_bf16_f32 v27, v24, v25
    v_lshlrev_b32 v34, 16, v26
    v_and_b32 v35, 0xffff0000, v26
    v_lshlrev_b32 v36, 16, v27
    v_and_b32 v37, 0xffff0000, v27
    v_mul_f32 v34, s68, v34
    v_mul_f32 v35, s68, v35
    v_mul_f32 v36, s68, v36
    v_mul_f32 v37, s68, v37
    v_cvt_pk_bf16_f32 v26, v34, v35
    v_cvt_pk_bf16_f32 v27, v36, v37
    v_lshlrev_b32 v34, 16, v26
    v_and_b32 v35, 0xffff0000, v26
    v_lshlrev_b32 v36, 16, v27
    v_and_b32 v37, 0xffff0000, v27
    v_max3_f32 v26, v34, v35, v36
    v_max3_f32 v26, v26, v37, v20
    v_sub_f32 v27, v20, v26
    v_mul_f32 v39, s70, v26
    v_mul_f32 v27, s69, v27
    v_mov_b32 v20, v26
    v_fma_f32 v34, v34, s69, v39
    v_fma_f32 v35, v35, s69, v39
    v_fma_f32 v36, v36, s69, v39
    v_fma_f32 v37, v37, s69, v39
    v_exp_f32 v38, v27
    v_exp_f32 v34, v34
    v_exp_f32 v35, v35
    v_exp_f32 v36, v36
    v_exp_f32 v37, v37
    s_nop 0
    v_fma_f32 v21, v21, v38, v34
    v_mul_f32 v8, v38, v8
    v_mul_f32 v9, v38, v9
    v_mul_f32 v10, v38, v10
    v_mul_f32 v11, v38, v11
    v_mul_f32 v12, v38, v12
    v_mul_f32 v13, v38, v13
    v_mul_f32 v14, v38, v14
    v_mul_f32 v15, v38, v15
    v_add_f32 v26, v35, v36
    v_add_f32 v26, v26, v37
    v_add_f32 v21, v21, v26
    s_waitcnt vmcnt(12)
    v_lshlrev_b32 v26, 16, v112
    v_and_b32 v30, 0xffff0000, v112
    v_lshlrev_b32 v27, 16, v113
    v_and_b32 v31, 0xffff0000, v113
    v_lshlrev_b32 v28, 16, v114
    v_and_b32 v32, 0xffff0000, v114
    v_lshlrev_b32 v29, 16, v115
    v_and_b32 v33, 0xffff0000, v115
    v_fmac_f32 v8, v34, v26
    v_fmac_f32 v9, v34, v30
    v_fmac_f32 v10, v34, v27
    v_fmac_f32 v11, v34, v31
    v_fmac_f32 v12, v34, v28
    v_fmac_f32 v13, v34, v32
    v_fmac_f32 v14, v34, v29
    v_fmac_f32 v15, v34, v33
    v_lshlrev_b32 v26, 16, v116
    v_and_b32 v30, 0xffff0000, v116
    v_lshlrev_b32 v27, 16, v117
    v_and_b32 v31, 0xffff0000, v117
    v_lshlrev_b32 v28, 16, v118
    v_and_b32 v32, 0xffff0000, v118
    v_lshlrev_b32 v29, 16, v119
    v_and_b32 v33, 0xffff0000, v119
    v_fmac_f32 v8, v35, v26
    v_fmac_f32 v9, v35, v30
    v_fmac_f32 v10, v35, v27
    v_fmac_f32 v11, v35, v31
    v_fmac_f32 v12, v35, v28
    v_fmac_f32 v13, v35, v32
    v_fmac_f32 v14, v35, v29
    v_fmac_f32 v15, v35, v33
    v_lshlrev_b32 v26, 16, v120
    v_and_b32 v30, 0xffff0000, v120
    v_lshlrev_b32 v27, 16, v121
    v_and_b32 v31, 0xffff0000, v121
    v_lshlrev_b32 v28, 16, v122
    v_and_b32 v32, 0xffff0000, v122
    v_lshlrev_b32 v29, 16, v123
    v_and_b32 v33, 0xffff0000, v123
    v_fmac_f32 v8, v36, v26
    v_fmac_f32 v9, v36, v30
    v_fmac_f32 v10, v36, v27
    v_fmac_f32 v11, v36, v31
    v_fmac_f32 v12, v36, v28
    v_fmac_f32 v13, v36, v32
    v_fmac_f32 v14, v36, v29
    v_fmac_f32 v15, v36, v33
    v_lshlrev_b32 v26, 16, v124
    v_and_b32 v30, 0xffff0000, v124
    v_lshlrev_b32 v27, 16, v125
    v_and_b32 v31, 0xffff0000, v125
    v_lshlrev_b32 v28, 16, v126
    v_and_b32 v32, 0xffff0000, v126
    v_lshlrev_b32 v29, 16, v127
    v_and_b32 v33, 0xffff0000, v127
    v_fmac_f32 v8, v37, v26
    v_fmac_f32 v9, v37, v30
    v_fmac_f32 v10, v37, v27
    v_fmac_f32 v11, v37, v31
    v_fmac_f32 v12, v37, v28
    v_fmac_f32 v13, v37, v32
    v_fmac_f32 v14, v37, v29
    v_fmac_f32 v15, v37, v33
    buffer_load_dwordx4 v[112:115], v4, s[48:51], s8 offen offset:0 nt
    buffer_load_dwordx4 v[116:119], v4, s[48:51], s8 offen offset:1024 nt
    buffer_load_dwordx4 v[120:123], v4, s[48:51], s8 offen offset:2048 nt
    buffer_load_dwordx4 v[124:127], v4, s[48:51], s8 offen offset:3072 nt
    s_add_u32 s8, s8, 49152
    s_waitcnt vmcnt(12)
    v_dot2_f32_bf16 v22, v64, v16, 0
    v_dot2_f32_bf16 v23, v68, v16, 0
    v_dot2_f32_bf16 v24, v72, v16, 0
    v_dot2_f32_bf16 v25, v76, v16, 0
    v_dot2_f32_bf16 v22, v65, v17, v22
    v_dot2_f32_bf16 v23, v69, v17, v23
    v_dot2_f32_bf16 v24, v73, v17, v24
    v_dot2_f32_bf16 v25, v77, v17, v25
    v_dot2_f32_bf16 v22, v66, v18, v22
    v_dot2_f32_bf16 v23, v70, v18, v23
    v_dot2_f32_bf16 v24, v74, v18, v24
    v_dot2_f32_bf16 v25, v78, v18, v25
    v_dot2_f32_bf16 v22, v67, v19, v22
    v_dot2_f32_bf16 v23, v71, v19, v23
    v_dot2_f32_bf16 v24, v75, v19, v24
    v_dot2_f32_bf16 v25, v79, v19, v25
    v_add_f32_dpp v22, v22, v22 row_ror:8 row_mask:0xf bank_mask:0xf
    v_add_f32_dpp v23, v23, v23 row_ror:8 row_mask:0xf bank_mask:0xf
    v_add_f32_dpp v24, v24, v24 row_ror:8 row_mask:0xf bank_mask:0xf
    v_add_f32_dpp v25, v25, v25 row_ror:8 row_mask:0xf bank_mask:0xf
    v_add_f32_dpp v22, v22, v22 row_ror:4 row_mask:0xf bank_mask:0xf
    v_add_f32_dpp v23, v23, v23 row_ror:4 row_mask:0xf bank_mask:0xf
    v_add_f32_dpp v24, v24, v24 row_ror:4 row_mask:0xf bank_mask:0xf
    v_add_f32_dpp v25, v25, v25 row_ror:4 row_mask:0xf bank_mask:0xf
    v_add_f32_dpp v22, v22, v22 row_ror:2 row_mask:0xf bank_mask:0xf
    v_add_f32_dpp v23, v23, v23 row_ror:2 row_mask:0xf bank_mask:0xf
    v_add_f32_dpp v24, v24, v24 row_ror:2 row_mask:0xf bank_mask:0xf
    v_add_f32_dpp v25, v25, v25 row_ror:2 row_mask:0xf bank_mask:0xf
    v_add_f32_dpp v22, v22, v22 row_ror:1 row_mask:0xf bank_mask:0xf
    v_add_f32_dpp v23, v23, v23 row_ror:1 row_mask:0xf bank_mask:0xf
    v_add_f32_dpp v24, v24, v24 row_ror:1 row_mask:0xf bank_mask:0xf
    v_add_f32_dpp v25, v25, v25 row_ror:1 row_mask:0xf bank_mask:0xf
    buffer_load_dwordx4 v[64:67], v4, s[44:47], s8 offen offset:0 nt
    buffer_load_dwordx4 v[68:71], v4, s[44:47], s8 offen offset:1024 nt
    buffer_load_dwordx4 v[72:75], v4, s[44:47], s8 offen offset:2048 nt
    buffer_load_dwordx4 v[76:79], v4, s[44:47], s8 offen offset:3072 nt
    v_cvt_pk_bf16_f32 v26, v22, v23
    v_cvt_pk_bf16_f32 v27, v24, v25
    v_lshlrev_b32 v34, 16, v26
    v_and_b32 v35, 0xffff0000, v26
    v_lshlrev_b32 v36, 16, v27
    v_and_b32 v37, 0xffff0000, v27
    v_mul_f32 v34, s68, v34
    v_mul_f32 v35, s68, v35
    v_mul_f32 v36, s68, v36
    v_mul_f32 v37, s68, v37
    v_cvt_pk_bf16_f32 v26, v34, v35
    v_cvt_pk_bf16_f32 v27, v36, v37
    v_lshlrev_b32 v34, 16, v26
    v_and_b32 v35, 0xffff0000, v26
    v_lshlrev_b32 v36, 16, v27
    v_and_b32 v37, 0xffff0000, v27
    v_max3_f32 v26, v34, v35, v36
    v_max3_f32 v26, v26, v37, v20
    v_sub_f32 v27, v20, v26
    v_mul_f32 v39, s70, v26
    v_mul_f32 v27, s69, v27
    v_mov_b32 v20, v26
    v_fma_f32 v34, v34, s69, v39
    v_fma_f32 v35, v35, s69, v39
    v_fma_f32 v36, v36, s69, v39
    v_fma_f32 v37, v37, s69, v39
    v_exp_f32 v38, v27
    v_exp_f32 v34, v34
    v_exp_f32 v35, v35
    v_exp_f32 v36, v36
    v_exp_f32 v37, v37
    s_nop 0
    v_fma_f32 v21, v21, v38, v34
    v_mul_f32 v8, v38, v8
    v_mul_f32 v9, v38, v9
    v_mul_f32 v10, v38, v10
    v_mul_f32 v11, v38, v11
    v_mul_f32 v12, v38, v12
    v_mul_f32 v13, v38, v13
    v_mul_f32 v14, v38, v14
    v_mul_f32 v15, v38, v15
    v_add_f32 v26, v35, v36
    v_add_f32 v26, v26, v37
    v_add_f32 v21, v21, v26
    s_waitcnt vmcnt(12)
    v_lshlrev_b32 v26, 16, v80
    v_and_b32 v30, 0xffff0000, v80
    v_lshlrev_b32 v27, 16, v81
    v_and_b32 v31, 0xffff0000, v81
    v_lshlrev_b32 v28, 16, v82
    v_and_b32 v32, 0xffff0000, v82
    v_lshlrev_b32 v29, 16, v83
    v_and_b32 v33, 0xffff0000, v83
    v_fmac_f32 v8, v34, v26
    v_fmac_f32 v9, v34, v30
    v_fmac_f32 v10, v34, v27
    v_fmac_f32 v11, v34, v31
    v_fmac_f32 v12, v34, v28
    v_fmac_f32 v13, v34, v32
    v_fmac_f32 v14, v34, v29
    v_fmac_f32 v15, v34, v33
    v_lshlrev_b32 v26, 16, v84
    v_and_b32 v30, 0xffff0000, v84
    v_lshlrev_b32 v27, 16, v85
    v_and_b32 v31, 0xffff0000, v85
    v_lshlrev_b32 v28, 16, v86
    v_and_b32 v32, 0xffff0000, v86
    v_lshlrev_b32 v29, 16, v87
    v_and_b32 v33, 0xffff0000, v87
    v_fmac_f32 v8, v35, v26
    v_fmac_f32 v9, v35, v30
    v_fmac_f32 v10, v35, v27
    v_fmac_f32 v11, v35, v31
    v_fmac_f32 v12, v35, v28
    v_fmac_f32 v13, v35, v32
    v_fmac_f32 v14, v35, v29
    v_fmac_f32 v15, v35, v33
    v_lshlrev_b32 v26, 16, v88
    v_and_b32 v30, 0xffff0000, v88
    v_lshlrev_b32 v27, 16, v89
    v_and_b32 v31, 0xffff0000, v89
    v_lshlrev_b32 v28, 16, v90
    v_and_b32 v32, 0xffff0000, v90
    v_lshlrev_b32 v29, 16, v91
    v_and_b32 v33, 0xffff0000, v91
    v_fmac_f32 v8, v36, v26
    v_fmac_f32 v9, v36, v30
    v_fmac_f32 v10, v36, v27
    v_fmac_f32 v11, v36, v31
    v_fmac_f32 v12, v36, v28
    v_fmac_f32 v13, v36, v32
    v_fmac_f32 v14, v36, v29
    v_fmac_f32 v15, v36, v33
    v_lshlrev_b32 v26, 16, v92
    v_and_b32 v30, 0xffff0000, v92
    v_lshlrev_b32 v27, 16, v93
    v_and_b32 v31, 0xffff0000, v93
    v_lshlrev_b32 v28, 16, v94
    v_and_b32 v32, 0xffff0000, v94
    v_lshlrev_b32 v29, 16, v95
    v_and_b32 v33, 0xffff0000, v95
    v_fmac_f32 v8, v37, v26
    v_fmac_f32 v9, v37, v30
    v_fmac_f32 v10, v37, v27
    v_fmac_f32 v11, v37, v31
    v_fmac_f32 v12, v37, v28
    v_fmac_f32 v13, v37, v32
    v_fmac_f32 v14, v37, v29
    v_fmac_f32 v15, v37, v33
    buffer_load_dwordx4 v[80:83], v4, s[48:51], s8 offen offset:0 nt
    buffer_load_dwordx4 v[84:87], v4, s[48:51], s8 offen offset:1024 nt
    buffer_load_dwordx4 v[88:91], v4, s[48:51], s8 offen offset:2048 nt
    buffer_load_dwordx4 v[92:95], v4, s[48:51], s8 offen offset:3072 nt
    s_add_u32 s8, s8, 49152
    s_waitcnt vmcnt(12)
    v_dot2_f32_bf16 v22, v96, v16, 0
    v_dot2_f32_bf16 v23, v100, v16, 0
    v_dot2_f32_bf16 v24, v104, v16, 0
    v_dot2_f32_bf16 v25, v108, v16, 0
    v_dot2_f32_bf16 v22, v97, v17, v22
    v_dot2_f32_bf16 v23, v101, v17, v23
    v_dot2_f32_bf16 v24, v105, v17, v24
    v_dot2_f32_bf16 v25, v109, v17, v25
    v_dot2_f32_bf16 v22, v98, v18, v22
    v_dot2_f32_bf16 v23, v102, v18, v23
    v_dot2_f32_bf16 v24, v106, v18, v24
    v_dot2_f32_bf16 v25, v110, v18, v25
    v_dot2_f32_bf16 v22, v99, v19, v22
    v_dot2_f32_bf16 v23, v103, v19, v23
    v_dot2_f32_bf16 v24, v107, v19, v24
    v_dot2_f32_bf16 v25, v111, v19, v25
    v_add_f32_dpp v22, v22, v22 row_ror:8 row_mask:0xf bank_mask:0xf
    v_add_f32_dpp v23, v23, v23 row_ror:8 row_mask:0xf bank_mask:0xf
    v_add_f32_dpp v24, v24, v24 row_ror:8 row_mask:0xf bank_mask:0xf
    v_add_f32_dpp v25, v25, v25 row_ror:8 row_mask:0xf bank_mask:0xf
    v_add_f32_dpp v22, v22, v22 row_ror:4 row_mask:0xf bank_mask:0xf
    v_add_f32_dpp v23, v23, v23 row_ror:4 row_mask:0xf bank_mask:0xf
    v_add_f32_dpp v24, v24, v24 row_ror:4 row_mask:0xf bank_mask:0xf
    v_add_f32_dpp v25, v25, v25 row_ror:4 row_mask:0xf bank_mask:0xf
    v_add_f32_dpp v22, v22, v22 row_ror:2 row_mask:0xf bank_mask:0xf
    v_add_f32_dpp v23, v23, v23 row_ror:2 row_mask:0xf bank_mask:0xf
    v_add_f32_dpp v24, v24, v24 row_ror:2 row_mask:0xf bank_mask:0xf
    v_add_f32_dpp v25, v25, v25 row_ror:2 row_mask:0xf bank_mask:0xf
    v_add_f32_dpp v22, v22, v22 row_ror:1 row_mask:0xf bank_mask:0xf
    v_add_f32_dpp v23, v23, v23 row_ror:1 row_mask:0xf bank_mask:0xf
    v_add_f32_dpp v24, v24, v24 row_ror:1 row_mask:0xf bank_mask:0xf
    v_add_f32_dpp v25, v25, v25 row_ror:1 row_mask:0xf bank_mask:0xf
    buffer_load_dwordx4 v[96:99], v4, s[44:47], s8 offen offset:0 nt
    buffer_load_dwordx4 v[100:103], v4, s[44:47], s8 offen offset:1024 nt
    buffer_load_dwordx4 v[104:107], v4, s[44:47], s8 offen offset:2048 nt
    buffer_load_dwordx4 v[108:111], v4, s[44:47], s8 offen offset:3072 nt
    v_cvt_pk_bf16_f32 v26, v22, v23
    v_cvt_pk_bf16_f32 v27, v24, v25
    v_lshlrev_b32 v34, 16, v26
    v_and_b32 v35, 0xffff0000, v26
    v_lshlrev_b32 v36, 16, v27
    v_and_b32 v37, 0xffff0000, v27
    v_mul_f32 v34, s68, v34
    v_mul_f32 v35, s68, v35
    v_mul_f32 v36, s68, v36
    v_mul_f32 v37, s68, v37
    v_cvt_pk_bf16_f32 v26, v34, v35
    v_cvt_pk_bf16_f32 v27, v36, v37
    v_lshlrev_b32 v34, 16, v26
    v_and_b32 v35, 0xffff0000, v26
    v_lshlrev_b32 v36, 16, v27
    v_and_b32 v37, 0xffff0000, v27
    v_max3_f32 v26, v34, v35, v36
    v_max3_f32 v26, v26, v37, v20
    v_sub_f32 v27, v20, v26
    v_mul_f32 v39, s70, v26
    v_mul_f32 v27, s69, v27
    v_mov_b32 v20, v26
    v_fma_f32 v34, v34, s69, v39
    v_fma_f32 v35, v35, s69, v39
    v_fma_f32 v36, v36, s69, v39
    v_fma_f32 v37, v37, s69, v39
    v_exp_f32 v38, v27
    v_exp_f32 v34, v34
    v_exp_f32 v35, v35
    v_exp_f32 v36, v36
    v_exp_f32 v37, v37
    s_nop 0
    v_fma_f32 v21, v21, v38, v34
    v_mul_f32 v8, v38, v8
    v_mul_f32 v9, v38, v9
    v_mul_f32 v10, v38, v10
    v_mul_f32 v11, v38, v11
    v_mul_f32 v12, v38, v12
    v_mul_f32 v13, v38, v13
    v_mul_f32 v14, v38, v14
    v_mul_f32 v15, v38, v15
    v_add_f32 v26, v35, v36
    v_add_f32 v26, v26, v37
    v_add_f32 v21, v21, v26
    s_waitcnt vmcnt(12)
    v_lshlrev_b32 v26, 16, v112
    v_and_b32 v30, 0xffff0000, v112
    v_lshlrev_b32 v27, 16, v113
    v_and_b32 v31, 0xffff0000, v113
    v_lshlrev_b32 v28, 16, v114
    v_and_b32 v32, 0xffff0000, v114
    v_lshlrev_b32 v29, 16, v115
    v_and_b32 v33, 0xffff0000, v115
    v_fmac_f32 v8, v34, v26
    v_fmac_f32 v9, v34, v30
    v_fmac_f32 v10, v34, v27
    v_fmac_f32 v11, v34, v31
    v_fmac_f32 v12, v34, v28
    v_fmac_f32 v13, v34, v32
    v_fmac_f32 v14, v34, v29
    v_fmac_f32 v15, v34, v33
    v_lshlrev_b32 v26, 16, v116
    v_and_b32 v30, 0xffff0000, v116
    v_lshlrev_b32 v27, 16, v117
    v_and_b32 v31, 0xffff0000, v117
    v_lshlrev_b32 v28, 16, v118
    v_and_b32 v32, 0xffff0000, v118
    v_lshlrev_b32 v29, 16, v119
    v_and_b32 v33, 0xffff0000, v119
    v_fmac_f32 v8, v35, v26
    v_fmac_f32 v9, v35, v30
    v_fmac_f32 v10, v35, v27
    v_fmac_f32 v11, v35, v31
    v_fmac_f32 v12, v35, v28
    v_fmac_f32 v13, v35, v32
    v_fmac_f32 v14, v35, v29
    v_fmac_f32 v15, v35, v33
    v_lshlrev_b32 v26, 16, v120
    v_and_b32 v30, 0xffff0000, v120
    v_lshlrev_b32 v27, 16, v121
    v_and_b32 v31, 0xffff0000, v121
    v_lshlrev_b32 v28, 16, v122
    v_and_b32 v32, 0xffff0000, v122
    v_lshlrev_b32 v29, 16, v123
    v_and_b32 v33, 0xffff0000, v123
    v_fmac_f32 v8, v36, v26
    v_fmac_f32 v9, v36, v30
    v_fmac_f32 v10, v36, v27
    v_fmac_f32 v11, v36, v31
    v_fmac_f32 v12, v36, v28
    v_fmac_f32 v13, v36, v32
    v_fmac_f32 v14, v36, v29
    v_fmac_f32 v15, v36, v33
    v_lshlrev_b32 v26, 16, v124
    v_and_b32 v30, 0xffff0000, v124
    v_lshlrev_b32 v27, 16, v125
    v_and_b32 v31, 0xffff0000, v125
    v_lshlrev_b32 v28, 16, v126
    v_and_b32 v32, 0xffff0000, v126
    v_lshlrev_b32 v29, 16, v127
    v_and_b32 v33, 0xffff0000, v127
    v_fmac_f32 v8, v37, v26
    v_fmac_f32 v9, v37, v30
    v_fmac_f32 v10, v37, v27
    v_fmac_f32 v11, v37, v31
    v_fmac_f32 v12, v37, v28
    v_fmac_f32 v13, v37, v32
    v_fmac_f32 v14, v37, v29
    v_fmac_f32 v15, v37, v33
    buffer_load_dwordx4 v[112:115], v4, s[48:51], s8 offen offset:0 nt
    buffer_load_dwordx4 v[116:119], v4, s[48:51], s8 offen offset:1024 nt
    buffer_load_dwordx4 v[120:123], v4, s[48:51], s8 offen offset:2048 nt
    buffer_load_dwordx4 v[124:127], v4, s[48:51], s8 offen offset:3072 nt
    s_add_u32 s8, s8, 49152
    s_waitcnt vmcnt(12)
    v_dot2_f32_bf16 v22, v64, v16, 0
    v_dot2_f32_bf16 v23, v68, v16, 0
    v_dot2_f32_bf16 v24, v72, v16, 0
    v_dot2_f32_bf16 v25, v76, v16, 0
    v_dot2_f32_bf16 v22, v65, v17, v22
    v_dot2_f32_bf16 v23, v69, v17, v23
    v_dot2_f32_bf16 v24, v73, v17, v24
    v_dot2_f32_bf16 v25, v77, v17, v25
    v_dot2_f32_bf16 v22, v66, v18, v22
    v_dot2_f32_bf16 v23, v70, v18, v23
    v_dot2_f32_bf16 v24, v74, v18, v24
    v_dot2_f32_bf16 v25, v78, v18, v25
    v_dot2_f32_bf16 v22, v67, v19, v22
    v_dot2_f32_bf16 v23, v71, v19, v23
    v_dot2_f32_bf16 v24, v75, v19, v24
    v_dot2_f32_bf16 v25, v79, v19, v25
    v_add_f32_dpp v22, v22, v22 row_ror:8 row_mask:0xf bank_mask:0xf
    v_add_f32_dpp v23, v23, v23 row_ror:8 row_mask:0xf bank_mask:0xf
    v_add_f32_dpp v24, v24, v24 row_ror:8 row_mask:0xf bank_mask:0xf
    v_add_f32_dpp v25, v25, v25 row_ror:8 row_mask:0xf bank_mask:0xf
    v_add_f32_dpp v22, v22, v22 row_ror:4 row_mask:0xf bank_mask:0xf
    v_add_f32_dpp v23, v23, v23 row_ror:4 row_mask:0xf bank_mask:0xf
    v_add_f32_dpp v24, v24, v24 row_ror:4 row_mask:0xf bank_mask:0xf
    v_add_f32_dpp v25, v25, v25 row_ror:4 row_mask:0xf bank_mask:0xf
    v_add_f32_dpp v22, v22, v22 row_ror:2 row_mask:0xf bank_mask:0xf
    v_add_f32_dpp v23, v23, v23 row_ror:2 row_mask:0xf bank_mask:0xf
    v_add_f32_dpp v24, v24, v24 row_ror:2 row_mask:0xf bank_mask:0xf
    v_add_f32_dpp v25, v25, v25 row_ror:2 row_mask:0xf bank_mask:0xf
    v_add_f32_dpp v22, v22, v22 row_ror:1 row_mask:0xf bank_mask:0xf
    v_add_f32_dpp v23, v23, v23 row_ror:1 row_mask:0xf bank_mask:0xf
    v_add_f32_dpp v24, v24, v24 row_ror:1 row_mask:0xf bank_mask:0xf
    v_add_f32_dpp v25, v25, v25 row_ror:1 row_mask:0xf bank_mask:0xf
    buffer_load_dwordx4 v[64:67], v4, s[44:47], s8 offen offset:0 nt
    buffer_load_dwordx4 v[68:71], v4, s[44:47], s8 offen offset:1024 nt
    buffer_load_dwordx4 v[72:75], v4, s[44:47], s8 offen offset:2048 nt
    buffer_load_dwordx4 v[76:79], v4, s[44:47], s8 offen offset:3072 nt
    v_cvt_pk_bf16_f32 v26, v22, v23
    v_cvt_pk_bf16_f32 v27, v24, v25
    v_lshlrev_b32 v34, 16, v26
    v_and_b32 v35, 0xffff0000, v26
    v_lshlrev_b32 v36, 16, v27
    v_and_b32 v37, 0xffff0000, v27
    v_mul_f32 v34, s68, v34
    v_mul_f32 v35, s68, v35
    v_mul_f32 v36, s68, v36
    v_mul_f32 v37, s68, v37
    v_cvt_pk_bf16_f32 v26, v34, v35
    v_cvt_pk_bf16_f32 v27, v36, v37
    v_lshlrev_b32 v34, 16, v26
    v_and_b32 v35, 0xffff0000, v26
    v_lshlrev_b32 v36, 16, v27
    v_and_b32 v37, 0xffff0000, v27
    v_max3_f32 v26, v34, v35, v36
    v_max3_f32 v26, v26, v37, v20
    v_sub_f32 v27, v20, v26
    v_mul_f32 v39, s70, v26
    v_mul_f32 v27, s69, v27
    v_mov_b32 v20, v26
    v_fma_f32 v34, v34, s69, v39
    v_fma_f32 v35, v35, s69, v39
    v_fma_f32 v36, v36, s69, v39
    v_fma_f32 v37, v37, s69, v39
    v_exp_f32 v38, v27
    v_exp_f32 v34, v34
    v_exp_f32 v35, v35
    v_exp_f32 v36, v36
    v_exp_f32 v37, v37
    s_nop 0
    v_fma_f32 v21, v21, v38, v34
    v_mul_f32 v8, v38, v8
    v_mul_f32 v9, v38, v9
    v_mul_f32 v10, v38, v10
    v_mul_f32 v11, v38, v11
    v_mul_f32 v12, v38, v12
    v_mul_f32 v13, v38, v13
    v_mul_f32 v14, v38, v14
    v_mul_f32 v15, v38, v15
    v_add_f32 v26, v35, v36
    v_add_f32 v26, v26, v37
    v_add_f32 v21, v21, v26
    s_waitcnt vmcnt(12)
    v_lshlrev_b32 v26, 16, v80
    v_and_b32 v30, 0xffff0000, v80
    v_lshlrev_b32 v27, 16, v81
    v_and_b32 v31, 0xffff0000, v81
    v_lshlrev_b32 v28, 16, v82
    v_and_b32 v32, 0xffff0000, v82
    v_lshlrev_b32 v29, 16, v83
    v_and_b32 v33, 0xffff0000, v83
    v_fmac_f32 v8, v34, v26
    v_fmac_f32 v9, v34, v30
    v_fmac_f32 v10, v34, v27
    v_fmac_f32 v11, v34, v31
    v_fmac_f32 v12, v34, v28
    v_fmac_f32 v13, v34, v32
    v_fmac_f32 v14, v34, v29
    v_fmac_f32 v15, v34, v33
    v_lshlrev_b32 v26, 16, v84
    v_and_b32 v30, 0xffff0000, v84
    v_lshlrev_b32 v27, 16, v85
    v_and_b32 v31, 0xffff0000, v85
    v_lshlrev_b32 v28, 16, v86
    v_and_b32 v32, 0xffff0000, v86
    v_lshlrev_b32 v29, 16, v87
    v_and_b32 v33, 0xffff0000, v87
    v_fmac_f32 v8, v35, v26
    v_fmac_f32 v9, v35, v30
    v_fmac_f32 v10, v35, v27
    v_fmac_f32 v11, v35, v31
    v_fmac_f32 v12, v35, v28
    v_fmac_f32 v13, v35, v32
    v_fmac_f32 v14, v35, v29
    v_fmac_f32 v15, v35, v33
    v_lshlrev_b32 v26, 16, v88
    v_and_b32 v30, 0xffff0000, v88
    v_lshlrev_b32 v27, 16, v89
    v_and_b32 v31, 0xffff0000, v89
    v_lshlrev_b32 v28, 16, v90
    v_and_b32 v32, 0xffff0000, v90
    v_lshlrev_b32 v29, 16, v91
    v_and_b32 v33, 0xffff0000, v91
    v_fmac_f32 v8, v36, v26
    v_fmac_f32 v9, v36, v30
    v_fmac_f32 v10, v36, v27
    v_fmac_f32 v11, v36, v31
    v_fmac_f32 v12, v36, v28
    v_fmac_f32 v13, v36, v32
    v_fmac_f32 v14, v36, v29
    v_fmac_f32 v15, v36, v33
    v_lshlrev_b32 v26, 16, v92
    v_and_b32 v30, 0xffff0000, v92
    v_lshlrev_b32 v27, 16, v93
    v_and_b32 v31, 0xffff0000, v93
    v_lshlrev_b32 v28, 16, v94
    v_and_b32 v32, 0xffff0000, v94
    v_lshlrev_b32 v29, 16, v95
    v_and_b32 v33, 0xffff0000, v95
    v_fmac_f32 v8, v37, v26
    v_fmac_f32 v9, v37, v30
    v_fmac_f32 v10, v37, v27
    v_fmac_f32 v11, v37, v31
    v_fmac_f32 v12, v37, v28
    v_fmac_f32 v13, v37, v32
    v_fmac_f32 v14, v37, v29
    v_fmac_f32 v15, v37, v33
    buffer_load_dwordx4 v[80:83], v4, s[48:51], s8 offen offset:0 nt
    buffer_load_dwordx4 v[84:87], v4, s[48:51], s8 offen offset:1024 nt
    buffer_load_dwordx4 v[88:91], v4, s[48:51], s8 offen offset:2048 nt
    buffer_load_dwordx4 v[92:95], v4, s[48:51], s8 offen offset:3072 nt
    s_add_u32 s8, s8, 49152
    s_waitcnt vmcnt(12)
    v_dot2_f32_bf16 v22, v96, v16, 0
    v_dot2_f32_bf16 v23, v100, v16, 0
    v_dot2_f32_bf16 v24, v104, v16, 0
    v_dot2_f32_bf16 v25, v108, v16, 0
    v_dot2_f32_bf16 v22, v97, v17, v22
    v_dot2_f32_bf16 v23, v101, v17, v23
    v_dot2_f32_bf16 v24, v105, v17, v24
    v_dot2_f32_bf16 v25, v109, v17, v25
    v_dot2_f32_bf16 v22, v98, v18, v22
    v_dot2_f32_bf16 v23, v102, v18, v23
    v_dot2_f32_bf16 v24, v106, v18, v24
    v_dot2_f32_bf16 v25, v110, v18, v25
    v_dot2_f32_bf16 v22, v99, v19, v22
    v_dot2_f32_bf16 v23, v103, v19, v23
    v_dot2_f32_bf16 v24, v107, v19, v24
    v_dot2_f32_bf16 v25, v111, v19, v25
    v_add_f32_dpp v22, v22, v22 row_ror:8 row_mask:0xf bank_mask:0xf
    v_add_f32_dpp v23, v23, v23 row_ror:8 row_mask:0xf bank_mask:0xf
    v_add_f32_dpp v24, v24, v24 row_ror:8 row_mask:0xf bank_mask:0xf
    v_add_f32_dpp v25, v25, v25 row_ror:8 row_mask:0xf bank_mask:0xf
    v_add_f32_dpp v22, v22, v22 row_ror:4 row_mask:0xf bank_mask:0xf
    v_add_f32_dpp v23, v23, v23 row_ror:4 row_mask:0xf bank_mask:0xf
    v_add_f32_dpp v24, v24, v24 row_ror:4 row_mask:0xf bank_mask:0xf
    v_add_f32_dpp v25, v25, v25 row_ror:4 row_mask:0xf bank_mask:0xf
    v_add_f32_dpp v22, v22, v22 row_ror:2 row_mask:0xf bank_mask:0xf
    v_add_f32_dpp v23, v23, v23 row_ror:2 row_mask:0xf bank_mask:0xf
    v_add_f32_dpp v24, v24, v24 row_ror:2 row_mask:0xf bank_mask:0xf
    v_add_f32_dpp v25, v25, v25 row_ror:2 row_mask:0xf bank_mask:0xf
    v_add_f32_dpp v22, v22, v22 row_ror:1 row_mask:0xf bank_mask:0xf
    v_add_f32_dpp v23, v23, v23 row_ror:1 row_mask:0xf bank_mask:0xf
    v_add_f32_dpp v24, v24, v24 row_ror:1 row_mask:0xf bank_mask:0xf
    v_add_f32_dpp v25, v25, v25 row_ror:1 row_mask:0xf bank_mask:0xf
    buffer_load_dwordx4 v[96:99], v4, s[44:47], s8 offen offset:0 nt
    buffer_load_dwordx4 v[100:103], v4, s[44:47], s8 offen offset:1024 nt
    buffer_load_dwordx4 v[104:107], v4, s[44:47], s8 offen offset:2048 nt
    buffer_load_dwordx4 v[108:111], v4, s[44:47], s8 offen offset:3072 nt
    v_cvt_pk_bf16_f32 v26, v22, v23
    v_cvt_pk_bf16_f32 v27, v24, v25
    v_lshlrev_b32 v34, 16, v26
    v_and_b32 v35, 0xffff0000, v26
    v_lshlrev_b32 v36, 16, v27
    v_and_b32 v37, 0xffff0000, v27
    v_mul_f32 v34, s68, v34
    v_mul_f32 v35, s68, v35
    v_mul_f32 v36, s68, v36
    v_mul_f32 v37, s68, v37
    v_cvt_pk_bf16_f32 v26, v34, v35
    v_cvt_pk_bf16_f32 v27, v36, v37
    v_lshlrev_b32 v34, 16, v26
    v_and_b32 v35, 0xffff0000, v26
    v_lshlrev_b32 v36, 16, v27
    v_and_b32 v37, 0xffff0000, v27
    v_max3_f32 v26, v34, v35, v36
    v_max3_f32 v26, v26, v37, v20
    v_sub_f32 v27, v20, v26
    v_mul_f32 v39, s70, v26
    v_mul_f32 v27, s69, v27
    v_mov_b32 v20, v26
    v_fma_f32 v34, v34, s69, v39
    v_fma_f32 v35, v35, s69, v39
    v_fma_f32 v36, v36, s69, v39
    v_fma_f32 v37, v37, s69, v39
    v_exp_f32 v38, v27
    v_exp_f32 v34, v34
    v_exp_f32 v35, v35
    v_exp_f32 v36, v36
    v_exp_f32 v37, v37
    s_nop 0
    v_fma_f32 v21, v21, v38, v34
    v_mul_f32 v8, v38, v8
    v_mul_f32 v9, v38, v9
    v_mul_f32 v10, v38, v10
    v_mul_f32 v11, v38, v11
    v_mul_f32 v12, v38, v12
    v_mul_f32 v13, v38, v13
    v_mul_f32 v14, v38, v14
    v_mul_f32 v15, v38, v15
    v_add_f32 v26, v35, v36
    v_add_f32 v26, v26, v37
    v_add_f32 v21, v21, v26
    s_waitcnt vmcnt(12)
    v_lshlrev_b32 v26, 16, v112
    v_and_b32 v30, 0xffff0000, v112
    v_lshlrev_b32 v27, 16, v113
    v_and_b32 v31, 0xffff0000, v113
    v_lshlrev_b32 v28, 16, v114
    v_and_b32 v32, 0xffff0000, v114
    v_lshlrev_b32 v29, 16, v115
    v_and_b32 v33, 0xffff0000, v115
    v_fmac_f32 v8, v34, v26
    v_fmac_f32 v9, v34, v30
    v_fmac_f32 v10, v34, v27
    v_fmac_f32 v11, v34, v31
    v_fmac_f32 v12, v34, v28
    v_fmac_f32 v13, v34, v32
    v_fmac_f32 v14, v34, v29
    v_fmac_f32 v15, v34, v33
    v_lshlrev_b32 v26, 16, v116
    v_and_b32 v30, 0xffff0000, v116
    v_lshlrev_b32 v27, 16, v117
    v_and_b32 v31, 0xffff0000, v117
    v_lshlrev_b32 v28, 16, v118
    v_and_b32 v32, 0xffff0000, v118
    v_lshlrev_b32 v29, 16, v119
    v_and_b32 v33, 0xffff0000, v119
    v_fmac_f32 v8, v35, v26
    v_fmac_f32 v9, v35, v30
    v_fmac_f32 v10, v35, v27
    v_fmac_f32 v11, v35, v31
    v_fmac_f32 v12, v35, v28
    v_fmac_f32 v13, v35, v32
    v_fmac_f32 v14, v35, v29
    v_fmac_f32 v15, v35, v33
    v_lshlrev_b32 v26, 16, v120
    v_and_b32 v30, 0xffff0000, v120
    v_lshlrev_b32 v27, 16, v121
    v_and_b32 v31, 0xffff0000, v121
    v_lshlrev_b32 v28, 16, v122
    v_and_b32 v32, 0xffff0000, v122
    v_lshlrev_b32 v29, 16, v123
    v_and_b32 v33, 0xffff0000, v123
    v_fmac_f32 v8, v36, v26
    v_fmac_f32 v9, v36, v30
    v_fmac_f32 v10, v36, v27
    v_fmac_f32 v11, v36, v31
    v_fmac_f32 v12, v36, v28
    v_fmac_f32 v13, v36, v32
    v_fmac_f32 v14, v36, v29
    v_fmac_f32 v15, v36, v33
    v_lshlrev_b32 v26, 16, v124
    v_and_b32 v30, 0xffff0000, v124
    v_lshlrev_b32 v27, 16, v125
    v_and_b32 v31, 0xffff0000, v125
    v_lshlrev_b32 v28, 16, v126
    v_and_b32 v32, 0xffff0000, v126
    v_lshlrev_b32 v29, 16, v127
    v_and_b32 v33, 0xffff0000, v127
    v_fmac_f32 v8, v37, v26
    v_fmac_f32 v9, v37, v30
    v_fmac_f32 v10, v37, v27
    v_fmac_f32 v11, v37, v31
    v_fmac_f32 v12, v37, v28
    v_fmac_f32 v13, v37, v32
    v_fmac_f32 v14, v37, v29
    v_fmac_f32 v15, v37, v33
    buffer_load_dwordx4 v[112:115], v4, s[48:51], s8 offen offset:0 nt
    buffer_load_dwordx4 v[116:119], v4, s[48:51], s8 offen offset:1024 nt
    buffer_load_dwordx4 v[120:123], v4, s[48:51], s8 offen offset:2048 nt
    buffer_load_dwordx4 v[124:127], v4, s[48:51], s8 offen offset:3072 nt
    s_add_u32 s8, s8, 49152
    s_waitcnt vmcnt(12)
    v_dot2_f32_bf16 v22, v64, v16, 0
    v_dot2_f32_bf16 v23, v68, v16, 0
    v_dot2_f32_bf16 v24, v72, v16, 0
    v_dot2_f32_bf16 v25, v76, v16, 0
    v_dot2_f32_bf16 v22, v65, v17, v22
    v_dot2_f32_bf16 v23, v69, v17, v23
    v_dot2_f32_bf16 v24, v73, v17, v24
    v_dot2_f32_bf16 v25, v77, v17, v25
    v_dot2_f32_bf16 v22, v66, v18, v22
    v_dot2_f32_bf16 v23, v70, v18, v23
    v_dot2_f32_bf16 v24, v74, v18, v24
    v_dot2_f32_bf16 v25, v78, v18, v25
    v_dot2_f32_bf16 v22, v67, v19, v22
    v_dot2_f32_bf16 v23, v71, v19, v23
    v_dot2_f32_bf16 v24, v75, v19, v24
    v_dot2_f32_bf16 v25, v79, v19, v25
    v_add_f32_dpp v22, v22, v22 row_ror:8 row_mask:0xf bank_mask:0xf
    v_add_f32_dpp v23, v23, v23 row_ror:8 row_mask:0xf bank_mask:0xf
    v_add_f32_dpp v24, v24, v24 row_ror:8 row_mask:0xf bank_mask:0xf
    v_add_f32_dpp v25, v25, v25 row_ror:8 row_mask:0xf bank_mask:0xf
    v_add_f32_dpp v22, v22, v22 row_ror:4 row_mask:0xf bank_mask:0xf
    v_add_f32_dpp v23, v23, v23 row_ror:4 row_mask:0xf bank_mask:0xf
    v_add_f32_dpp v24, v24, v24 row_ror:4 row_mask:0xf bank_mask:0xf
    v_add_f32_dpp v25, v25, v25 row_ror:4 row_mask:0xf bank_mask:0xf
    v_add_f32_dpp v22, v22, v22 row_ror:2 row_mask:0xf bank_mask:0xf
    v_add_f32_dpp v23, v23, v23 row_ror:2 row_mask:0xf bank_mask:0xf
    v_add_f32_dpp v24, v24, v24 row_ror:2 row_mask:0xf bank_mask:0xf
    v_add_f32_dpp v25, v25, v25 row_ror:2 row_mask:0xf bank_mask:0xf
    v_add_f32_dpp v22, v22, v22 row_ror:1 row_mask:0xf bank_mask:0xf
    v_add_f32_dpp v23, v23, v23 row_ror:1 row_mask:0xf bank_mask:0xf
    v_add_f32_dpp v24, v24, v24 row_ror:1 row_mask:0xf bank_mask:0xf
    v_add_f32_dpp v25, v25, v25 row_ror:1 row_mask:0xf bank_mask:0xf
    buffer_load_dwordx4 v[64:67], v4, s[44:47], s8 offen offset:0 nt
    buffer_load_dwordx4 v[68:71], v4, s[44:47], s8 offen offset:1024 nt
    buffer_load_dwordx4 v[72:75], v4, s[44:47], s8 offen offset:2048 nt
    buffer_load_dwordx4 v[76:79], v4, s[44:47], s8 offen offset:3072 nt
    v_cvt_pk_bf16_f32 v26, v22, v23
    v_cvt_pk_bf16_f32 v27, v24, v25
    v_lshlrev_b32 v34, 16, v26
    v_and_b32 v35, 0xffff0000, v26
    v_lshlrev_b32 v36, 16, v27
    v_and_b32 v37, 0xffff0000, v27
    v_mul_f32 v34, s68, v34
    v_mul_f32 v35, s68, v35
    v_mul_f32 v36, s68, v36
    v_mul_f32 v37, s68, v37
    v_cvt_pk_bf16_f32 v26, v34, v35
    v_cvt_pk_bf16_f32 v27, v36, v37
    v_lshlrev_b32 v34, 16, v26
    v_and_b32 v35, 0xffff0000, v26
    v_lshlrev_b32 v36, 16, v27
    v_and_b32 v37, 0xffff0000, v27
    v_max3_f32 v26, v34, v35, v36
    v_max3_f32 v26, v26, v37, v20
    v_sub_f32 v27, v20, v26
    v_mul_f32 v39, s70, v26
    v_mul_f32 v27, s69, v27
    v_mov_b32 v20, v26
    v_fma_f32 v34, v34, s69, v39
    v_fma_f32 v35, v35, s69, v39
    v_fma_f32 v36, v36, s69, v39
    v_fma_f32 v37, v37, s69, v39
    v_exp_f32 v38, v27
    v_exp_f32 v34, v34
    v_exp_f32 v35, v35
    v_exp_f32 v36, v36
    v_exp_f32 v37, v37
    s_nop 0
    v_fma_f32 v21, v21, v38, v34
    v_mul_f32 v8, v38, v8
    v_mul_f32 v9, v38, v9
    v_mul_f32 v10, v38, v10
    v_mul_f32 v11, v38, v11
    v_mul_f32 v12, v38, v12
    v_mul_f32 v13, v38, v13
    v_mul_f32 v14, v38, v14
    v_mul_f32 v15, v38, v15
    v_add_f32 v26, v35, v36
    v_add_f32 v26, v26, v37
    v_add_f32 v21, v21, v26
    s_waitcnt vmcnt(12)
    v_lshlrev_b32 v26, 16, v80
    v_and_b32 v30, 0xffff0000, v80
    v_lshlrev_b32 v27, 16, v81
    v_and_b32 v31, 0xffff0000, v81
    v_lshlrev_b32 v28, 16, v82
    v_and_b32 v32, 0xffff0000, v82
    v_lshlrev_b32 v29, 16, v83
    v_and_b32 v33, 0xffff0000, v83
    v_fmac_f32 v8, v34, v26
    v_fmac_f32 v9, v34, v30
    v_fmac_f32 v10, v34, v27
    v_fmac_f32 v11, v34, v31
    v_fmac_f32 v12, v34, v28
    v_fmac_f32 v13, v34, v32
    v_fmac_f32 v14, v34, v29
    v_fmac_f32 v15, v34, v33
    v_lshlrev_b32 v26, 16, v84
    v_and_b32 v30, 0xffff0000, v84
    v_lshlrev_b32 v27, 16, v85
    v_and_b32 v31, 0xffff0000, v85
    v_lshlrev_b32 v28, 16, v86
    v_and_b32 v32, 0xffff0000, v86
    v_lshlrev_b32 v29, 16, v87
    v_and_b32 v33, 0xffff0000, v87
    v_fmac_f32 v8, v35, v26
    v_fmac_f32 v9, v35, v30
    v_fmac_f32 v10, v35, v27
    v_fmac_f32 v11, v35, v31
    v_fmac_f32 v12, v35, v28
    v_fmac_f32 v13, v35, v32
    v_fmac_f32 v14, v35, v29
    v_fmac_f32 v15, v35, v33
    v_lshlrev_b32 v26, 16, v88
    v_and_b32 v30, 0xffff0000, v88
    v_lshlrev_b32 v27, 16, v89
    v_and_b32 v31, 0xffff0000, v89
    v_lshlrev_b32 v28, 16, v90
    v_and_b32 v32, 0xffff0000, v90
    v_lshlrev_b32 v29, 16, v91
    v_and_b32 v33, 0xffff0000, v91
    v_fmac_f32 v8, v36, v26
    v_fmac_f32 v9, v36, v30
    v_fmac_f32 v10, v36, v27
    v_fmac_f32 v11, v36, v31
    v_fmac_f32 v12, v36, v28
    v_fmac_f32 v13, v36, v32
    v_fmac_f32 v14, v36, v29
    v_fmac_f32 v15, v36, v33
    v_lshlrev_b32 v26, 16, v92
    v_and_b32 v30, 0xffff0000, v92
    v_lshlrev_b32 v27, 16, v93
    v_and_b32 v31, 0xffff0000, v93
    v_lshlrev_b32 v28, 16, v94
    v_and_b32 v32, 0xffff0000, v94
    v_lshlrev_b32 v29, 16, v95
    v_and_b32 v33, 0xffff0000, v95
    v_fmac_f32 v8, v37, v26
    v_fmac_f32 v9, v37, v30
    v_fmac_f32 v10, v37, v27
    v_fmac_f32 v11, v37, v31
    v_fmac_f32 v12, v37, v28
    v_fmac_f32 v13, v37, v32
    v_fmac_f32 v14, v37, v29
    v_fmac_f32 v15, v37, v33
    buffer_load_dwordx4 v[80:83], v4, s[48:51], s8 offen offset:0 nt
    buffer_load_dwordx4 v[84:87], v4, s[48:51], s8 offen offset:1024 nt
    buffer_load_dwordx4 v[88:91], v4, s[48:51], s8 offen offset:2048 nt
    buffer_load_dwordx4 v[92:95], v4, s[48:51], s8 offen offset:3072 nt
    s_add_u32 s8, s8, 49152
    s_waitcnt vmcnt(12)
    v_dot2_f32_bf16 v22, v96, v16, 0
    v_dot2_f32_bf16 v23, v100, v16, 0
    v_dot2_f32_bf16 v24, v104, v16, 0
    v_dot2_f32_bf16 v25, v108, v16, 0
    v_dot2_f32_bf16 v22, v97, v17, v22
    v_dot2_f32_bf16 v23, v101, v17, v23
    v_dot2_f32_bf16 v24, v105, v17, v24
    v_dot2_f32_bf16 v25, v109, v17, v25
    v_dot2_f32_bf16 v22, v98, v18, v22
    v_dot2_f32_bf16 v23, v102, v18, v23
    v_dot2_f32_bf16 v24, v106, v18, v24
    v_dot2_f32_bf16 v25, v110, v18, v25
    v_dot2_f32_bf16 v22, v99, v19, v22
    v_dot2_f32_bf16 v23, v103, v19, v23
    v_dot2_f32_bf16 v24, v107, v19, v24
    v_dot2_f32_bf16 v25, v111, v19, v25
    v_add_f32_dpp v22, v22, v22 row_ror:8 row_mask:0xf bank_mask:0xf
    v_add_f32_dpp v23, v23, v23 row_ror:8 row_mask:0xf bank_mask:0xf
    v_add_f32_dpp v24, v24, v24 row_ror:8 row_mask:0xf bank_mask:0xf
    v_add_f32_dpp v25, v25, v25 row_ror:8 row_mask:0xf bank_mask:0xf
    v_add_f32_dpp v22, v22, v22 row_ror:4 row_mask:0xf bank_mask:0xf
    v_add_f32_dpp v23, v23, v23 row_ror:4 row_mask:0xf bank_mask:0xf
    v_add_f32_dpp v24, v24, v24 row_ror:4 row_mask:0xf bank_mask:0xf
    v_add_f32_dpp v25, v25, v25 row_ror:4 row_mask:0xf bank_mask:0xf
    v_add_f32_dpp v22, v22, v22 row_ror:2 row_mask:0xf bank_mask:0xf
    v_add_f32_dpp v23, v23, v23 row_ror:2 row_mask:0xf bank_mask:0xf
    v_add_f32_dpp v24, v24, v24 row_ror:2 row_mask:0xf bank_mask:0xf
    v_add_f32_dpp v25, v25, v25 row_ror:2 row_mask:0xf bank_mask:0xf
    v_add_f32_dpp v22, v22, v22 row_ror:1 row_mask:0xf bank_mask:0xf
    v_add_f32_dpp v23, v23, v23 row_ror:1 row_mask:0xf bank_mask:0xf
    v_add_f32_dpp v24, v24, v24 row_ror:1 row_mask:0xf bank_mask:0xf
    v_add_f32_dpp v25, v25, v25 row_ror:1 row_mask:0xf bank_mask:0xf
    buffer_load_dwordx4 v[96:99], v4, s[44:47], s8 offen offset:0 nt
    buffer_load_dwordx4 v[100:103], v4, s[44:47], s8 offen offset:1024 nt
    buffer_load_dwordx4 v[104:107], v4, s[44:47], s8 offen offset:2048 nt
    buffer_load_dwordx4 v[108:111], v4, s[44:47], s8 offen offset:3072 nt
    v_cvt_pk_bf16_f32 v26, v22, v23
    v_cvt_pk_bf16_f32 v27, v24, v25
    v_lshlrev_b32 v34, 16, v26
    v_and_b32 v35, 0xffff0000, v26
    v_lshlrev_b32 v36, 16, v27
    v_and_b32 v37, 0xffff0000, v27
    v_mul_f32 v34, s68, v34
    v_mul_f32 v35, s68, v35
    v_mul_f32 v36, s68, v36
    v_mul_f32 v37, s68, v37
    v_cvt_pk_bf16_f32 v26, v34, v35
    v_cvt_pk_bf16_f32 v27, v36, v37
    v_lshlrev_b32 v34, 16, v26
    v_and_b32 v35, 0xffff0000, v26
    v_lshlrev_b32 v36, 16, v27
    v_and_b32 v37, 0xffff0000, v27
    v_max3_f32 v26, v34, v35, v36
    v_max3_f32 v26, v26, v37, v20
    v_sub_f32 v27, v20, v26
    v_mul_f32 v39, s70, v26
    v_mul_f32 v27, s69, v27
    v_mov_b32 v20, v26
    v_fma_f32 v34, v34, s69, v39
    v_fma_f32 v35, v35, s69, v39
    v_fma_f32 v36, v36, s69, v39
    v_fma_f32 v37, v37, s69, v39
    v_exp_f32 v38, v27
    v_exp_f32 v34, v34
    v_exp_f32 v35, v35
    v_exp_f32 v36, v36
    v_exp_f32 v37, v37
    s_nop 0
    v_fma_f32 v21, v21, v38, v34
    v_mul_f32 v8, v38, v8
    v_mul_f32 v9, v38, v9
    v_mul_f32 v10, v38, v10
    v_mul_f32 v11, v38, v11
    v_mul_f32 v12, v38, v12
    v_mul_f32 v13, v38, v13
    v_mul_f32 v14, v38, v14
    v_mul_f32 v15, v38, v15
    v_add_f32 v26, v35, v36
    v_add_f32 v26, v26, v37
    v_add_f32 v21, v21, v26
    s_waitcnt vmcnt(12)
    v_lshlrev_b32 v26, 16, v112
    v_and_b32 v30, 0xffff0000, v112
    v_lshlrev_b32 v27, 16, v113
    v_and_b32 v31, 0xffff0000, v113
    v_lshlrev_b32 v28, 16, v114
    v_and_b32 v32, 0xffff0000, v114
    v_lshlrev_b32 v29, 16, v115
    v_and_b32 v33, 0xffff0000, v115
    v_fmac_f32 v8, v34, v26
    v_fmac_f32 v9, v34, v30
    v_fmac_f32 v10, v34, v27
    v_fmac_f32 v11, v34, v31
    v_fmac_f32 v12, v34, v28
    v_fmac_f32 v13, v34, v32
    v_fmac_f32 v14, v34, v29
    v_fmac_f32 v15, v34, v33
    v_lshlrev_b32 v26, 16, v116
    v_and_b32 v30, 0xffff0000, v116
    v_lshlrev_b32 v27, 16, v117
    v_and_b32 v31, 0xffff0000, v117
    v_lshlrev_b32 v28, 16, v118
    v_and_b32 v32, 0xffff0000, v118
    v_lshlrev_b32 v29, 16, v119
    v_and_b32 v33, 0xffff0000, v119
    v_fmac_f32 v8, v35, v26
    v_fmac_f32 v9, v35, v30
    v_fmac_f32 v10, v35, v27
    v_fmac_f32 v11, v35, v31
    v_fmac_f32 v12, v35, v28
    v_fmac_f32 v13, v35, v32
    v_fmac_f32 v14, v35, v29
    v_fmac_f32 v15, v35, v33
    v_lshlrev_b32 v26, 16, v120
    v_and_b32 v30, 0xffff0000, v120
    v_lshlrev_b32 v27, 16, v121
    v_and_b32 v31, 0xffff0000, v121
    v_lshlrev_b32 v28, 16, v122
    v_and_b32 v32, 0xffff0000, v122
    v_lshlrev_b32 v29, 16, v123
    v_and_b32 v33, 0xffff0000, v123
    v_fmac_f32 v8, v36, v26
    v_fmac_f32 v9, v36, v30
    v_fmac_f32 v10, v36, v27
    v_fmac_f32 v11, v36, v31
    v_fmac_f32 v12, v36, v28
    v_fmac_f32 v13, v36, v32
    v_fmac_f32 v14, v36, v29
    v_fmac_f32 v15, v36, v33
    v_lshlrev_b32 v26, 16, v124
    v_and_b32 v30, 0xffff0000, v124
    v_lshlrev_b32 v27, 16, v125
    v_and_b32 v31, 0xffff0000, v125
    v_lshlrev_b32 v28, 16, v126
    v_and_b32 v32, 0xffff0000, v126
    v_lshlrev_b32 v29, 16, v127
    v_and_b32 v33, 0xffff0000, v127
    v_fmac_f32 v8, v37, v26
    v_fmac_f32 v9, v37, v30
    v_fmac_f32 v10, v37, v27
    v_fmac_f32 v11, v37, v31
    v_fmac_f32 v12, v37, v28
    v_fmac_f32 v13, v37, v32
    v_fmac_f32 v14, v37, v29
    v_fmac_f32 v15, v37, v33
    buffer_load_dwordx4 v[112:115], v4, s[48:51], s8 offen offset:0 nt
    buffer_load_dwordx4 v[116:119], v4, s[48:51], s8 offen offset:1024 nt
    buffer_load_dwordx4 v[120:123], v4, s[48:51], s8 offen offset:2048 nt
    buffer_load_dwordx4 v[124:127], v4, s[48:51], s8 offen offset:3072 nt
    s_add_u32 s8, s8, 49152
    s_waitcnt vmcnt(12)
    v_dot2_f32_bf16 v22, v64, v16, 0
    v_dot2_f32_bf16 v23, v68, v16, 0
    v_dot2_f32_bf16 v24, v72, v16, 0
    v_dot2_f32_bf16 v25, v76, v16, 0
    v_dot2_f32_bf16 v22, v65, v17, v22
    v_dot2_f32_bf16 v23, v69, v17, v23
    v_dot2_f32_bf16 v24, v73, v17, v24
    v_dot2_f32_bf16 v25, v77, v17, v25
    v_dot2_f32_bf16 v22, v66, v18, v22
    v_dot2_f32_bf16 v23, v70, v18, v23
    v_dot2_f32_bf16 v24, v74, v18, v24
    v_dot2_f32_bf16 v25, v78, v18, v25
    v_dot2_f32_bf16 v22, v67, v19, v22
    v_dot2_f32_bf16 v23, v71, v19, v23
    v_dot2_f32_bf16 v24, v75, v19, v24
    v_dot2_f32_bf16 v25, v79, v19, v25
    v_add_f32_dpp v22, v22, v22 row_ror:8 row_mask:0xf bank_mask:0xf
    v_add_f32_dpp v23, v23, v23 row_ror:8 row_mask:0xf bank_mask:0xf
    v_add_f32_dpp v24, v24, v24 row_ror:8 row_mask:0xf bank_mask:0xf
    v_add_f32_dpp v25, v25, v25 row_ror:8 row_mask:0xf bank_mask:0xf
    v_add_f32_dpp v22, v22, v22 row_ror:4 row_mask:0xf bank_mask:0xf
    v_add_f32_dpp v23, v23, v23 row_ror:4 row_mask:0xf bank_mask:0xf
    v_add_f32_dpp v24, v24, v24 row_ror:4 row_mask:0xf bank_mask:0xf
    v_add_f32_dpp v25, v25, v25 row_ror:4 row_mask:0xf bank_mask:0xf
    v_add_f32_dpp v22, v22, v22 row_ror:2 row_mask:0xf bank_mask:0xf
    v_add_f32_dpp v23, v23, v23 row_ror:2 row_mask:0xf bank_mask:0xf
    v_add_f32_dpp v24, v24, v24 row_ror:2 row_mask:0xf bank_mask:0xf
    v_add_f32_dpp v25, v25, v25 row_ror:2 row_mask:0xf bank_mask:0xf
    v_add_f32_dpp v22, v22, v22 row_ror:1 row_mask:0xf bank_mask:0xf
    v_add_f32_dpp v23, v23, v23 row_ror:1 row_mask:0xf bank_mask:0xf
    v_add_f32_dpp v24, v24, v24 row_ror:1 row_mask:0xf bank_mask:0xf
    v_add_f32_dpp v25, v25, v25 row_ror:1 row_mask:0xf bank_mask:0xf
    buffer_load_dwordx4 v[64:67], v4, s[44:47], s8 offen offset:0 nt
    buffer_load_dwordx4 v[68:71], v4, s[44:47], s8 offen offset:1024 nt
    buffer_load_dwordx4 v[72:75], v4, s[44:47], s8 offen offset:2048 nt
    buffer_load_dwordx4 v[76:79], v4, s[44:47], s8 offen offset:3072 nt
    v_cvt_pk_bf16_f32 v26, v22, v23
    v_cvt_pk_bf16_f32 v27, v24, v25
    v_lshlrev_b32 v34, 16, v26
    v_and_b32 v35, 0xffff0000, v26
    v_lshlrev_b32 v36, 16, v27
    v_and_b32 v37, 0xffff0000, v27
    v_mul_f32 v34, s68, v34
    v_mul_f32 v35, s68, v35
    v_mul_f32 v36, s68, v36
    v_mul_f32 v37, s68, v37
    v_cvt_pk_bf16_f32 v26, v34, v35
    v_cvt_pk_bf16_f32 v27, v36, v37
    v_lshlrev_b32 v34, 16, v26
    v_and_b32 v35, 0xffff0000, v26
    v_lshlrev_b32 v36, 16, v27
    v_and_b32 v37, 0xffff0000, v27
    v_max3_f32 v26, v34, v35, v36
    v_max3_f32 v26, v26, v37, v20
    v_sub_f32 v27, v20, v26
    v_mul_f32 v39, s70, v26
    v_mul_f32 v27, s69, v27
    v_mov_b32 v20, v26
    v_fma_f32 v34, v34, s69, v39
    v_fma_f32 v35, v35, s69, v39
    v_fma_f32 v36, v36, s69, v39
    v_fma_f32 v37, v37, s69, v39
    v_exp_f32 v38, v27
    v_exp_f32 v34, v34
    v_exp_f32 v35, v35
    v_exp_f32 v36, v36
    v_exp_f32 v37, v37
    s_nop 0
    v_fma_f32 v21, v21, v38, v34
    v_mul_f32 v8, v38, v8
    v_mul_f32 v9, v38, v9
    v_mul_f32 v10, v38, v10
    v_mul_f32 v11, v38, v11
    v_mul_f32 v12, v38, v12
    v_mul_f32 v13, v38, v13
    v_mul_f32 v14, v38, v14
    v_mul_f32 v15, v38, v15
    v_add_f32 v26, v35, v36
    v_add_f32 v26, v26, v37
    v_add_f32 v21, v21, v26
    s_waitcnt vmcnt(12)
    v_lshlrev_b32 v26, 16, v80
    v_and_b32 v30, 0xffff0000, v80
    v_lshlrev_b32 v27, 16, v81
    v_and_b32 v31, 0xffff0000, v81
    v_lshlrev_b32 v28, 16, v82
    v_and_b32 v32, 0xffff0000, v82
    v_lshlrev_b32 v29, 16, v83
    v_and_b32 v33, 0xffff0000, v83
    v_fmac_f32 v8, v34, v26
    v_fmac_f32 v9, v34, v30
    v_fmac_f32 v10, v34, v27
    v_fmac_f32 v11, v34, v31
    v_fmac_f32 v12, v34, v28
    v_fmac_f32 v13, v34, v32
    v_fmac_f32 v14, v34, v29
    v_fmac_f32 v15, v34, v33
    v_lshlrev_b32 v26, 16, v84
    v_and_b32 v30, 0xffff0000, v84
    v_lshlrev_b32 v27, 16, v85
    v_and_b32 v31, 0xffff0000, v85
    v_lshlrev_b32 v28, 16, v86
    v_and_b32 v32, 0xffff0000, v86
    v_lshlrev_b32 v29, 16, v87
    v_and_b32 v33, 0xffff0000, v87
    v_fmac_f32 v8, v35, v26
    v_fmac_f32 v9, v35, v30
    v_fmac_f32 v10, v35, v27
    v_fmac_f32 v11, v35, v31
    v_fmac_f32 v12, v35, v28
    v_fmac_f32 v13, v35, v32
    v_fmac_f32 v14, v35, v29
    v_fmac_f32 v15, v35, v33
    v_lshlrev_b32 v26, 16, v88
    v_and_b32 v30, 0xffff0000, v88
    v_lshlrev_b32 v27, 16, v89
    v_and_b32 v31, 0xffff0000, v89
    v_lshlrev_b32 v28, 16, v90
    v_and_b32 v32, 0xffff0000, v90
    v_lshlrev_b32 v29, 16, v91
    v_and_b32 v33, 0xffff0000, v91
    v_fmac_f32 v8, v36, v26
    v_fmac_f32 v9, v36, v30
    v_fmac_f32 v10, v36, v27
    v_fmac_f32 v11, v36, v31
    v_fmac_f32 v12, v36, v28
    v_fmac_f32 v13, v36, v32
    v_fmac_f32 v14, v36, v29
    v_fmac_f32 v15, v36, v33
    v_lshlrev_b32 v26, 16, v92
    v_and_b32 v30, 0xffff0000, v92
    v_lshlrev_b32 v27, 16, v93
    v_and_b32 v31, 0xffff0000, v93
    v_lshlrev_b32 v28, 16, v94
    v_and_b32 v32, 0xffff0000, v94
    v_lshlrev_b32 v29, 16, v95
    v_and_b32 v33, 0xffff0000, v95
    v_fmac_f32 v8, v37, v26
    v_fmac_f32 v9, v37, v30
    v_fmac_f32 v10, v37, v27
    v_fmac_f32 v11, v37, v31
    v_fmac_f32 v12, v37, v28
    v_fmac_f32 v13, v37, v32
    v_fmac_f32 v14, v37, v29
    v_fmac_f32 v15, v37, v33
    buffer_load_dwordx4 v[80:83], v4, s[48:51], s8 offen offset:0 nt
    buffer_load_dwordx4 v[84:87], v4, s[48:51], s8 offen offset:1024 nt
    buffer_load_dwordx4 v[88:91], v4, s[48:51], s8 offen offset:2048 nt
    buffer_load_dwordx4 v[92:95], v4, s[48:51], s8 offen offset:3072 nt
    s_add_u32 s8, s8, 49152
    s_waitcnt vmcnt(12)
    v_dot2_f32_bf16 v22, v96, v16, 0
    v_dot2_f32_bf16 v23, v100, v16, 0
    v_dot2_f32_bf16 v24, v104, v16, 0
    v_dot2_f32_bf16 v25, v108, v16, 0
    v_dot2_f32_bf16 v22, v97, v17, v22
    v_dot2_f32_bf16 v23, v101, v17, v23
    v_dot2_f32_bf16 v24, v105, v17, v24
    v_dot2_f32_bf16 v25, v109, v17, v25
    v_dot2_f32_bf16 v22, v98, v18, v22
    v_dot2_f32_bf16 v23, v102, v18, v23
    v_dot2_f32_bf16 v24, v106, v18, v24
    v_dot2_f32_bf16 v25, v110, v18, v25
    v_dot2_f32_bf16 v22, v99, v19, v22
    v_dot2_f32_bf16 v23, v103, v19, v23
    v_dot2_f32_bf16 v24, v107, v19, v24
    v_dot2_f32_bf16 v25, v111, v19, v25
    v_add_f32_dpp v22, v22, v22 row_ror:8 row_mask:0xf bank_mask:0xf
    v_add_f32_dpp v23, v23, v23 row_ror:8 row_mask:0xf bank_mask:0xf
    v_add_f32_dpp v24, v24, v24 row_ror:8 row_mask:0xf bank_mask:0xf
    v_add_f32_dpp v25, v25, v25 row_ror:8 row_mask:0xf bank_mask:0xf
    v_add_f32_dpp v22, v22, v22 row_ror:4 row_mask:0xf bank_mask:0xf
    v_add_f32_dpp v23, v23, v23 row_ror:4 row_mask:0xf bank_mask:0xf
    v_add_f32_dpp v24, v24, v24 row_ror:4 row_mask:0xf bank_mask:0xf
    v_add_f32_dpp v25, v25, v25 row_ror:4 row_mask:0xf bank_mask:0xf
    v_add_f32_dpp v22, v22, v22 row_ror:2 row_mask:0xf bank_mask:0xf
    v_add_f32_dpp v23, v23, v23 row_ror:2 row_mask:0xf bank_mask:0xf
    v_add_f32_dpp v24, v24, v24 row_ror:2 row_mask:0xf bank_mask:0xf
    v_add_f32_dpp v25, v25, v25 row_ror:2 row_mask:0xf bank_mask:0xf
    v_add_f32_dpp v22, v22, v22 row_ror:1 row_mask:0xf bank_mask:0xf
    v_add_f32_dpp v23, v23, v23 row_ror:1 row_mask:0xf bank_mask:0xf
    v_add_f32_dpp v24, v24, v24 row_ror:1 row_mask:0xf bank_mask:0xf
    v_add_f32_dpp v25, v25, v25 row_ror:1 row_mask:0xf bank_mask:0xf
    buffer_load_dwordx4 v[96:99], v4, s[44:47], s8 offen offset:0 nt
    buffer_load_dwordx4 v[100:103], v4, s[44:47], s8 offen offset:1024 nt
    buffer_load_dwordx4 v[104:107], v4, s[44:47], s8 offen offset:2048 nt
    buffer_load_dwordx4 v[108:111], v4, s[44:47], s8 offen offset:3072 nt
    v_cvt_pk_bf16_f32 v26, v22, v23
    v_cvt_pk_bf16_f32 v27, v24, v25
    v_lshlrev_b32 v34, 16, v26
    v_and_b32 v35, 0xffff0000, v26
    v_lshlrev_b32 v36, 16, v27
    v_and_b32 v37, 0xffff0000, v27
    v_mul_f32 v34, s68, v34
    v_mul_f32 v35, s68, v35
    v_mul_f32 v36, s68, v36
    v_mul_f32 v37, s68, v37
    v_cvt_pk_bf16_f32 v26, v34, v35
    v_cvt_pk_bf16_f32 v27, v36, v37
    v_lshlrev_b32 v34, 16, v26
    v_and_b32 v35, 0xffff0000, v26
    v_lshlrev_b32 v36, 16, v27
    v_and_b32 v37, 0xffff0000, v27
    v_max3_f32 v26, v34, v35, v36
    v_max3_f32 v26, v26, v37, v20
    v_sub_f32 v27, v20, v26
    v_mul_f32 v39, s70, v26
    v_mul_f32 v27, s69, v27
    v_mov_b32 v20, v26
    v_fma_f32 v34, v34, s69, v39
    v_fma_f32 v35, v35, s69, v39
    v_fma_f32 v36, v36, s69, v39
    v_fma_f32 v37, v37, s69, v39
    v_exp_f32 v38, v27
    v_exp_f32 v34, v34
    v_exp_f32 v35, v35
    v_exp_f32 v36, v36
    v_exp_f32 v37, v37
    s_nop 0
    v_fma_f32 v21, v21, v38, v34
    v_mul_f32 v8, v38, v8
    v_mul_f32 v9, v38, v9
    v_mul_f32 v10, v38, v10
    v_mul_f32 v11, v38, v11
    v_mul_f32 v12, v38, v12
    v_mul_f32 v13, v38, v13
    v_mul_f32 v14, v38, v14
    v_mul_f32 v15, v38, v15
    v_add_f32 v26, v35, v36
    v_add_f32 v26, v26, v37
    v_add_f32 v21, v21, v26
    s_waitcnt vmcnt(12)
    v_lshlrev_b32 v26, 16, v112
    v_and_b32 v30, 0xffff0000, v112
    v_lshlrev_b32 v27, 16, v113
    v_and_b32 v31, 0xffff0000, v113
    v_lshlrev_b32 v28, 16, v114
    v_and_b32 v32, 0xffff0000, v114
    v_lshlrev_b32 v29, 16, v115
    v_and_b32 v33, 0xffff0000, v115
    v_fmac_f32 v8, v34, v26
    v_fmac_f32 v9, v34, v30
    v_fmac_f32 v10, v34, v27
    v_fmac_f32 v11, v34, v31
    v_fmac_f32 v12, v34, v28
    v_fmac_f32 v13, v34, v32
    v_fmac_f32 v14, v34, v29
    v_fmac_f32 v15, v34, v33
    v_lshlrev_b32 v26, 16, v116
    v_and_b32 v30, 0xffff0000, v116
    v_lshlrev_b32 v27, 16, v117
    v_and_b32 v31, 0xffff0000, v117
    v_lshlrev_b32 v28, 16, v118
    v_and_b32 v32, 0xffff0000, v118
    v_lshlrev_b32 v29, 16, v119
    v_and_b32 v33, 0xffff0000, v119
    v_fmac_f32 v8, v35, v26
    v_fmac_f32 v9, v35, v30
    v_fmac_f32 v10, v35, v27
    v_fmac_f32 v11, v35, v31
    v_fmac_f32 v12, v35, v28
    v_fmac_f32 v13, v35, v32
    v_fmac_f32 v14, v35, v29
    v_fmac_f32 v15, v35, v33
    v_lshlrev_b32 v26, 16, v120
    v_and_b32 v30, 0xffff0000, v120
    v_lshlrev_b32 v27, 16, v121
    v_and_b32 v31, 0xffff0000, v121
    v_lshlrev_b32 v28, 16, v122
    v_and_b32 v32, 0xffff0000, v122
    v_lshlrev_b32 v29, 16, v123
    v_and_b32 v33, 0xffff0000, v123
    v_fmac_f32 v8, v36, v26
    v_fmac_f32 v9, v36, v30
    v_fmac_f32 v10, v36, v27
    v_fmac_f32 v11, v36, v31
    v_fmac_f32 v12, v36, v28
    v_fmac_f32 v13, v36, v32
    v_fmac_f32 v14, v36, v29
    v_fmac_f32 v15, v36, v33
    v_lshlrev_b32 v26, 16, v124
    v_and_b32 v30, 0xffff0000, v124
    v_lshlrev_b32 v27, 16, v125
    v_and_b32 v31, 0xffff0000, v125
    v_lshlrev_b32 v28, 16, v126
    v_and_b32 v32, 0xffff0000, v126
    v_lshlrev_b32 v29, 16, v127
    v_and_b32 v33, 0xffff0000, v127
    v_fmac_f32 v8, v37, v26
    v_fmac_f32 v9, v37, v30
    v_fmac_f32 v10, v37, v27
    v_fmac_f32 v11, v37, v31
    v_fmac_f32 v12, v37, v28
    v_fmac_f32 v13, v37, v32
    v_fmac_f32 v14, v37, v29
    v_fmac_f32 v15, v37, v33
    buffer_load_dwordx4 v[112:115], v4, s[48:51], s8 offen offset:0 nt
    buffer_load_dwordx4 v[116:119], v4, s[48:51], s8 offen offset:1024 nt
    buffer_load_dwordx4 v[120:123], v4, s[48:51], s8 offen offset:2048 nt
    buffer_load_dwordx4 v[124:127], v4, s[48:51], s8 offen offset:3072 nt
    s_add_u32 s8, s8, 49152
    s_waitcnt vmcnt(12)
    v_dot2_f32_bf16 v22, v64, v16, 0
    v_dot2_f32_bf16 v23, v68, v16, 0
    v_dot2_f32_bf16 v24, v72, v16, 0
    v_dot2_f32_bf16 v25, v76, v16, 0
    v_dot2_f32_bf16 v22, v65, v17, v22
    v_dot2_f32_bf16 v23, v69, v17, v23
    v_dot2_f32_bf16 v24, v73, v17, v24
    v_dot2_f32_bf16 v25, v77, v17, v25
    v_dot2_f32_bf16 v22, v66, v18, v22
    v_dot2_f32_bf16 v23, v70, v18, v23
    v_dot2_f32_bf16 v24, v74, v18, v24
    v_dot2_f32_bf16 v25, v78, v18, v25
    v_dot2_f32_bf16 v22, v67, v19, v22
    v_dot2_f32_bf16 v23, v71, v19, v23
    v_dot2_f32_bf16 v24, v75, v19, v24
    v_dot2_f32_bf16 v25, v79, v19, v25
    v_add_f32_dpp v22, v22, v22 row_ror:8 row_mask:0xf bank_mask:0xf
    v_add_f32_dpp v23, v23, v23 row_ror:8 row_mask:0xf bank_mask:0xf
    v_add_f32_dpp v24, v24, v24 row_ror:8 row_mask:0xf bank_mask:0xf
    v_add_f32_dpp v25, v25, v25 row_ror:8 row_mask:0xf bank_mask:0xf
    v_add_f32_dpp v22, v22, v22 row_ror:4 row_mask:0xf bank_mask:0xf
    v_add_f32_dpp v23, v23, v23 row_ror:4 row_mask:0xf bank_mask:0xf
    v_add_f32_dpp v24, v24, v24 row_ror:4 row_mask:0xf bank_mask:0xf
    v_add_f32_dpp v25, v25, v25 row_ror:4 row_mask:0xf bank_mask:0xf
    v_add_f32_dpp v22, v22, v22 row_ror:2 row_mask:0xf bank_mask:0xf
    v_add_f32_dpp v23, v23, v23 row_ror:2 row_mask:0xf bank_mask:0xf
    v_add_f32_dpp v24, v24, v24 row_ror:2 row_mask:0xf bank_mask:0xf
    v_add_f32_dpp v25, v25, v25 row_ror:2 row_mask:0xf bank_mask:0xf
    v_add_f32_dpp v22, v22, v22 row_ror:1 row_mask:0xf bank_mask:0xf
    v_add_f32_dpp v23, v23, v23 row_ror:1 row_mask:0xf bank_mask:0xf
    v_add_f32_dpp v24, v24, v24 row_ror:1 row_mask:0xf bank_mask:0xf
    v_add_f32_dpp v25, v25, v25 row_ror:1 row_mask:0xf bank_mask:0xf
    buffer_load_dwordx4 v[64:67], v4, s[44:47], s8 offen offset:0 nt
    buffer_load_dwordx4 v[68:71], v4, s[44:47], s8 offen offset:1024 nt
    buffer_load_dwordx4 v[72:75], v4, s[44:47], s8 offen offset:2048 nt
    buffer_load_dwordx4 v[76:79], v4, s[44:47], s8 offen offset:3072 nt
    v_cvt_pk_bf16_f32 v26, v22, v23
    v_cvt_pk_bf16_f32 v27, v24, v25
    v_lshlrev_b32 v34, 16, v26
    v_and_b32 v35, 0xffff0000, v26
    v_lshlrev_b32 v36, 16, v27
    v_and_b32 v37, 0xffff0000, v27
    v_mul_f32 v34, s68, v34
    v_mul_f32 v35, s68, v35
    v_mul_f32 v36, s68, v36
    v_mul_f32 v37, s68, v37
    v_cvt_pk_bf16_f32 v26, v34, v35
    v_cvt_pk_bf16_f32 v27, v36, v37
    v_lshlrev_b32 v34, 16, v26
    v_and_b32 v35, 0xffff0000, v26
    v_lshlrev_b32 v36, 16, v27
    v_and_b32 v37, 0xffff0000, v27
    v_max3_f32 v26, v34, v35, v36
    v_max3_f32 v26, v26, v37, v20
    v_sub_f32 v27, v20, v26
    v_mul_f32 v39, s70, v26
    v_mul_f32 v27, s69, v27
    v_mov_b32 v20, v26
    v_fma_f32 v34, v34, s69, v39
    v_fma_f32 v35, v35, s69, v39
    v_fma_f32 v36, v36, s69, v39
    v_fma_f32 v37, v37, s69, v39
    v_exp_f32 v38, v27
    v_exp_f32 v34, v34
    v_exp_f32 v35, v35
    v_exp_f32 v36, v36
    v_exp_f32 v37, v37
    s_nop 0
    v_fma_f32 v21, v21, v38, v34
    v_mul_f32 v8, v38, v8
    v_mul_f32 v9, v38, v9
    v_mul_f32 v10, v38, v10
    v_mul_f32 v11, v38, v11
    v_mul_f32 v12, v38, v12
    v_mul_f32 v13, v38, v13
    v_mul_f32 v14, v38, v14
    v_mul_f32 v15, v38, v15
    v_add_f32 v26, v35, v36
    v_add_f32 v26, v26, v37
    v_add_f32 v21, v21, v26
    s_waitcnt vmcnt(12)
    v_lshlrev_b32 v26, 16, v80
    v_and_b32 v30, 0xffff0000, v80
    v_lshlrev_b32 v27, 16, v81
    v_and_b32 v31, 0xffff0000, v81
    v_lshlrev_b32 v28, 16, v82
    v_and_b32 v32, 0xffff0000, v82
    v_lshlrev_b32 v29, 16, v83
    v_and_b32 v33, 0xffff0000, v83
    v_fmac_f32 v8, v34, v26
    v_fmac_f32 v9, v34, v30
    v_fmac_f32 v10, v34, v27
    v_fmac_f32 v11, v34, v31
    v_fmac_f32 v12, v34, v28
    v_fmac_f32 v13, v34, v32
    v_fmac_f32 v14, v34, v29
    v_fmac_f32 v15, v34, v33
    v_lshlrev_b32 v26, 16, v84
    v_and_b32 v30, 0xffff0000, v84
    v_lshlrev_b32 v27, 16, v85
    v_and_b32 v31, 0xffff0000, v85
    v_lshlrev_b32 v28, 16, v86
    v_and_b32 v32, 0xffff0000, v86
    v_lshlrev_b32 v29, 16, v87
    v_and_b32 v33, 0xffff0000, v87
    v_fmac_f32 v8, v35, v26
    v_fmac_f32 v9, v35, v30
    v_fmac_f32 v10, v35, v27
    v_fmac_f32 v11, v35, v31
    v_fmac_f32 v12, v35, v28
    v_fmac_f32 v13, v35, v32
    v_fmac_f32 v14, v35, v29
    v_fmac_f32 v15, v35, v33
    v_lshlrev_b32 v26, 16, v88
    v_and_b32 v30, 0xffff0000, v88
    v_lshlrev_b32 v27, 16, v89
    v_and_b32 v31, 0xffff0000, v89
    v_lshlrev_b32 v28, 16, v90
    v_and_b32 v32, 0xffff0000, v90
    v_lshlrev_b32 v29, 16, v91
    v_and_b32 v33, 0xffff0000, v91
    v_fmac_f32 v8, v36, v26
    v_fmac_f32 v9, v36, v30
    v_fmac_f32 v10, v36, v27
    v_fmac_f32 v11, v36, v31
    v_fmac_f32 v12, v36, v28
    v_fmac_f32 v13, v36, v32
    v_fmac_f32 v14, v36, v29
    v_fmac_f32 v15, v36, v33
    v_lshlrev_b32 v26, 16, v92
    v_and_b32 v30, 0xffff0000, v92
    v_lshlrev_b32 v27, 16, v93
    v_and_b32 v31, 0xffff0000, v93
    v_lshlrev_b32 v28, 16, v94
    v_and_b32 v32, 0xffff0000, v94
    v_lshlrev_b32 v29, 16, v95
    v_and_b32 v33, 0xffff0000, v95
    v_fmac_f32 v8, v37, v26
    v_fmac_f32 v9, v37, v30
    v_fmac_f32 v10, v37, v27
    v_fmac_f32 v11, v37, v31
    v_fmac_f32 v12, v37, v28
    v_fmac_f32 v13, v37, v32
    v_fmac_f32 v14, v37, v29
    v_fmac_f32 v15, v37, v33
    buffer_load_dwordx4 v[80:83], v4, s[48:51], s8 offen offset:0 nt
    buffer_load_dwordx4 v[84:87], v4, s[48:51], s8 offen offset:1024 nt
    buffer_load_dwordx4 v[88:91], v4, s[48:51], s8 offen offset:2048 nt
    buffer_load_dwordx4 v[92:95], v4, s[48:51], s8 offen offset:3072 nt
    s_add_u32 s8, s8, 49152
    s_waitcnt vmcnt(12)
    v_dot2_f32_bf16 v22, v96, v16, 0
    v_dot2_f32_bf16 v23, v100, v16, 0
    v_dot2_f32_bf16 v24, v104, v16, 0
    v_dot2_f32_bf16 v25, v108, v16, 0
    v_dot2_f32_bf16 v22, v97, v17, v22
    v_dot2_f32_bf16 v23, v101, v17, v23
    v_dot2_f32_bf16 v24, v105, v17, v24
    v_dot2_f32_bf16 v25, v109, v17, v25
    v_dot2_f32_bf16 v22, v98, v18, v22
    v_dot2_f32_bf16 v23, v102, v18, v23
    v_dot2_f32_bf16 v24, v106, v18, v24
    v_dot2_f32_bf16 v25, v110, v18, v25
    v_dot2_f32_bf16 v22, v99, v19, v22
    v_dot2_f32_bf16 v23, v103, v19, v23
    v_dot2_f32_bf16 v24, v107, v19, v24
    v_dot2_f32_bf16 v25, v111, v19, v25
    v_add_f32_dpp v22, v22, v22 row_ror:8 row_mask:0xf bank_mask:0xf
    v_add_f32_dpp v23, v23, v23 row_ror:8 row_mask:0xf bank_mask:0xf
    v_add_f32_dpp v24, v24, v24 row_ror:8 row_mask:0xf bank_mask:0xf
    v_add_f32_dpp v25, v25, v25 row_ror:8 row_mask:0xf bank_mask:0xf
    v_add_f32_dpp v22, v22, v22 row_ror:4 row_mask:0xf bank_mask:0xf
    v_add_f32_dpp v23, v23, v23 row_ror:4 row_mask:0xf bank_mask:0xf
    v_add_f32_dpp v24, v24, v24 row_ror:4 row_mask:0xf bank_mask:0xf
    v_add_f32_dpp v25, v25, v25 row_ror:4 row_mask:0xf bank_mask:0xf
    v_add_f32_dpp v22, v22, v22 row_ror:2 row_mask:0xf bank_mask:0xf
    v_add_f32_dpp v23, v23, v23 row_ror:2 row_mask:0xf bank_mask:0xf
    v_add_f32_dpp v24, v24, v24 row_ror:2 row_mask:0xf bank_mask:0xf
    v_add_f32_dpp v25, v25, v25 row_ror:2 row_mask:0xf bank_mask:0xf
    v_add_f32_dpp v22, v22, v22 row_ror:1 row_mask:0xf bank_mask:0xf
    v_add_f32_dpp v23, v23, v23 row_ror:1 row_mask:0xf bank_mask:0xf
    v_add_f32_dpp v24, v24, v24 row_ror:1 row_mask:0xf bank_mask:0xf
    v_add_f32_dpp v25, v25, v25 row_ror:1 row_mask:0xf bank_mask:0xf
    buffer_load_dwordx4 v[96:99], v4, s[44:47], s8 offen offset:0 nt
    buffer_load_dwordx4 v[100:103], v4, s[44:47], s8 offen offset:1024 nt
    buffer_load_dwordx4 v[104:107], v4, s[44:47], s8 offen offset:2048 nt
    buffer_load_dwordx4 v[108:111], v4, s[44:47], s8 offen offset:3072 nt
    v_cvt_pk_bf16_f32 v26, v22, v23
    v_cvt_pk_bf16_f32 v27, v24, v25
    v_lshlrev_b32 v34, 16, v26
    v_and_b32 v35, 0xffff0000, v26
    v_lshlrev_b32 v36, 16, v27
    v_and_b32 v37, 0xffff0000, v27
    v_mul_f32 v34, s68, v34
    v_mul_f32 v35, s68, v35
    v_mul_f32 v36, s68, v36
    v_mul_f32 v37, s68, v37
    v_cvt_pk_bf16_f32 v26, v34, v35
    v_cvt_pk_bf16_f32 v27, v36, v37
    v_lshlrev_b32 v34, 16, v26
    v_and_b32 v35, 0xffff0000, v26
    v_lshlrev_b32 v36, 16, v27
    v_and_b32 v37, 0xffff0000, v27
    v_max3_f32 v26, v34, v35, v36
    v_max3_f32 v26, v26, v37, v20
    v_sub_f32 v27, v20, v26
    v_mul_f32 v39, s70, v26
    v_mul_f32 v27, s69, v27
    v_mov_b32 v20, v26
    v_fma_f32 v34, v34, s69, v39
    v_fma_f32 v35, v35, s69, v39
    v_fma_f32 v36, v36, s69, v39
    v_fma_f32 v37, v37, s69, v39
    v_exp_f32 v38, v27
    v_exp_f32 v34, v34
    v_exp_f32 v35, v35
    v_exp_f32 v36, v36
    v_exp_f32 v37, v37
    s_nop 0
    v_fma_f32 v21, v21, v38, v34
    v_mul_f32 v8, v38, v8
    v_mul_f32 v9, v38, v9
    v_mul_f32 v10, v38, v10
    v_mul_f32 v11, v38, v11
    v_mul_f32 v12, v38, v12
    v_mul_f32 v13, v38, v13
    v_mul_f32 v14, v38, v14
    v_mul_f32 v15, v38, v15
    v_add_f32 v26, v35, v36
    v_add_f32 v26, v26, v37
    v_add_f32 v21, v21, v26
    s_waitcnt vmcnt(12)
    v_lshlrev_b32 v26, 16, v112
    v_and_b32 v30, 0xffff0000, v112
    v_lshlrev_b32 v27, 16, v113
    v_and_b32 v31, 0xffff0000, v113
    v_lshlrev_b32 v28, 16, v114
    v_and_b32 v32, 0xffff0000, v114
    v_lshlrev_b32 v29, 16, v115
    v_and_b32 v33, 0xffff0000, v115
    v_fmac_f32 v8, v34, v26
    v_fmac_f32 v9, v34, v30
    v_fmac_f32 v10, v34, v27
    v_fmac_f32 v11, v34, v31
    v_fmac_f32 v12, v34, v28
    v_fmac_f32 v13, v34, v32
    v_fmac_f32 v14, v34, v29
    v_fmac_f32 v15, v34, v33
    v_lshlrev_b32 v26, 16, v116
    v_and_b32 v30, 0xffff0000, v116
    v_lshlrev_b32 v27, 16, v117
    v_and_b32 v31, 0xffff0000, v117
    v_lshlrev_b32 v28, 16, v118
    v_and_b32 v32, 0xffff0000, v118
    v_lshlrev_b32 v29, 16, v119
    v_and_b32 v33, 0xffff0000, v119
    v_fmac_f32 v8, v35, v26
    v_fmac_f32 v9, v35, v30
    v_fmac_f32 v10, v35, v27
    v_fmac_f32 v11, v35, v31
    v_fmac_f32 v12, v35, v28
    v_fmac_f32 v13, v35, v32
    v_fmac_f32 v14, v35, v29
    v_fmac_f32 v15, v35, v33
    v_lshlrev_b32 v26, 16, v120
    v_and_b32 v30, 0xffff0000, v120
    v_lshlrev_b32 v27, 16, v121
    v_and_b32 v31, 0xffff0000, v121
    v_lshlrev_b32 v28, 16, v122
    v_and_b32 v32, 0xffff0000, v122
    v_lshlrev_b32 v29, 16, v123
    v_and_b32 v33, 0xffff0000, v123
    v_fmac_f32 v8, v36, v26
    v_fmac_f32 v9, v36, v30
    v_fmac_f32 v10, v36, v27
    v_fmac_f32 v11, v36, v31
    v_fmac_f32 v12, v36, v28
    v_fmac_f32 v13, v36, v32
    v_fmac_f32 v14, v36, v29
    v_fmac_f32 v15, v36, v33
    v_lshlrev_b32 v26, 16, v124
    v_and_b32 v30, 0xffff0000, v124
    v_lshlrev_b32 v27, 16, v125
    v_and_b32 v31, 0xffff0000, v125
    v_lshlrev_b32 v28, 16, v126
    v_and_b32 v32, 0xffff0000, v126
    v_lshlrev_b32 v29, 16, v127
    v_and_b32 v33, 0xffff0000, v127
    v_fmac_f32 v8, v37, v26
    v_fmac_f32 v9, v37, v30
    v_fmac_f32 v10, v37, v27
    v_fmac_f32 v11, v37, v31
    v_fmac_f32 v12, v37, v28
    v_fmac_f32 v13, v37, v32
    v_fmac_f32 v14, v37, v29
    v_fmac_f32 v15, v37, v33
    buffer_load_dwordx4 v[112:115], v4, s[48:51], s8 offen offset:0 nt
    buffer_load_dwordx4 v[116:119], v4, s[48:51], s8 offen offset:1024 nt
    buffer_load_dwordx4 v[120:123], v4, s[48:51], s8 offen offset:2048 nt
    buffer_load_dwordx4 v[124:127], v4, s[48:51], s8 offen offset:3072 nt
    s_add_u32 s8, s8, 49152
    s_waitcnt vmcnt(12)
    v_dot2_f32_bf16 v22, v64, v16, 0
    v_dot2_f32_bf16 v23, v68, v16, 0
    v_dot2_f32_bf16 v24, v72, v16, 0
    v_dot2_f32_bf16 v25, v76, v16, 0
    v_dot2_f32_bf16 v22, v65, v17, v22
    v_dot2_f32_bf16 v23, v69, v17, v23
    v_dot2_f32_bf16 v24, v73, v17, v24
    v_dot2_f32_bf16 v25, v77, v17, v25
    v_dot2_f32_bf16 v22, v66, v18, v22
    v_dot2_f32_bf16 v23, v70, v18, v23
    v_dot2_f32_bf16 v24, v74, v18, v24
    v_dot2_f32_bf16 v25, v78, v18, v25
    v_dot2_f32_bf16 v22, v67, v19, v22
    v_dot2_f32_bf16 v23, v71, v19, v23
    v_dot2_f32_bf16 v24, v75, v19, v24
    v_dot2_f32_bf16 v25, v79, v19, v25
    v_add_f32_dpp v22, v22, v22 row_ror:8 row_mask:0xf bank_mask:0xf
    v_add_f32_dpp v23, v23, v23 row_ror:8 row_mask:0xf bank_mask:0xf
    v_add_f32_dpp v24, v24, v24 row_ror:8 row_mask:0xf bank_mask:0xf
    v_add_f32_dpp v25, v25, v25 row_ror:8 row_mask:0xf bank_mask:0xf
    v_add_f32_dpp v22, v22, v22 row_ror:4 row_mask:0xf bank_mask:0xf
    v_add_f32_dpp v23, v23, v23 row_ror:4 row_mask:0xf bank_mask:0xf
    v_add_f32_dpp v24, v24, v24 row_ror:4 row_mask:0xf bank_mask:0xf
    v_add_f32_dpp v25, v25, v25 row_ror:4 row_mask:0xf bank_mask:0xf
    v_add_f32_dpp v22, v22, v22 row_ror:2 row_mask:0xf bank_mask:0xf
    v_add_f32_dpp v23, v23, v23 row_ror:2 row_mask:0xf bank_mask:0xf
    v_add_f32_dpp v24, v24, v24 row_ror:2 row_mask:0xf bank_mask:0xf
    v_add_f32_dpp v25, v25, v25 row_ror:2 row_mask:0xf bank_mask:0xf
    v_add_f32_dpp v22, v22, v22 row_ror:1 row_mask:0xf bank_mask:0xf
    v_add_f32_dpp v23, v23, v23 row_ror:1 row_mask:0xf bank_mask:0xf
    v_add_f32_dpp v24, v24, v24 row_ror:1 row_mask:0xf bank_mask:0xf
    v_add_f32_dpp v25, v25, v25 row_ror:1 row_mask:0xf bank_mask:0xf
    buffer_load_dwordx4 v[64:67], v4, s[44:47], s8 offen offset:0 nt
    buffer_load_dwordx4 v[68:71], v4, s[44:47], s8 offen offset:1024 nt
    buffer_load_dwordx4 v[72:75], v4, s[44:47], s8 offen offset:2048 nt
    buffer_load_dwordx4 v[76:79], v4, s[44:47], s8 offen offset:3072 nt
    v_cvt_pk_bf16_f32 v26, v22, v23
    v_cvt_pk_bf16_f32 v27, v24, v25
    v_lshlrev_b32 v34, 16, v26
    v_and_b32 v35, 0xffff0000, v26
    v_lshlrev_b32 v36, 16, v27
    v_and_b32 v37, 0xffff0000, v27
    v_mul_f32 v34, s68, v34
    v_mul_f32 v35, s68, v35
    v_mul_f32 v36, s68, v36
    v_mul_f32 v37, s68, v37
    v_cvt_pk_bf16_f32 v26, v34, v35
    v_cvt_pk_bf16_f32 v27, v36, v37
    v_lshlrev_b32 v34, 16, v26
    v_and_b32 v35, 0xffff0000, v26
    v_lshlrev_b32 v36, 16, v27
    v_and_b32 v37, 0xffff0000, v27
    v_max3_f32 v26, v34, v35, v36
    v_max3_f32 v26, v26, v37, v20
    v_sub_f32 v27, v20, v26
    v_mul_f32 v39, s70, v26
    v_mul_f32 v27, s69, v27
    v_mov_b32 v20, v26
    v_fma_f32 v34, v34, s69, v39
    v_fma_f32 v35, v35, s69, v39
    v_fma_f32 v36, v36, s69, v39
    v_fma_f32 v37, v37, s69, v39
    v_exp_f32 v38, v27
    v_exp_f32 v34, v34
    v_exp_f32 v35, v35
    v_exp_f32 v36, v36
    v_exp_f32 v37, v37
    s_nop 0
    v_fma_f32 v21, v21, v38, v34
    v_mul_f32 v8, v38, v8
    v_mul_f32 v9, v38, v9
    v_mul_f32 v10, v38, v10
    v_mul_f32 v11, v38, v11
    v_mul_f32 v12, v38, v12
    v_mul_f32 v13, v38, v13
    v_mul_f32 v14, v38, v14
    v_mul_f32 v15, v38, v15
    v_add_f32 v26, v35, v36
    v_add_f32 v26, v26, v37
    v_add_f32 v21, v21, v26
    s_waitcnt vmcnt(12)
    v_lshlrev_b32 v26, 16, v80
    v_and_b32 v30, 0xffff0000, v80
    v_lshlrev_b32 v27, 16, v81
    v_and_b32 v31, 0xffff0000, v81
    v_lshlrev_b32 v28, 16, v82
    v_and_b32 v32, 0xffff0000, v82
    v_lshlrev_b32 v29, 16, v83
    v_and_b32 v33, 0xffff0000, v83
    v_fmac_f32 v8, v34, v26
    v_fmac_f32 v9, v34, v30
    v_fmac_f32 v10, v34, v27
    v_fmac_f32 v11, v34, v31
    v_fmac_f32 v12, v34, v28
    v_fmac_f32 v13, v34, v32
    v_fmac_f32 v14, v34, v29
    v_fmac_f32 v15, v34, v33
    v_lshlrev_b32 v26, 16, v84
    v_and_b32 v30, 0xffff0000, v84
    v_lshlrev_b32 v27, 16, v85
    v_and_b32 v31, 0xffff0000, v85
    v_lshlrev_b32 v28, 16, v86
    v_and_b32 v32, 0xffff0000, v86
    v_lshlrev_b32 v29, 16, v87
    v_and_b32 v33, 0xffff0000, v87
    v_fmac_f32 v8, v35, v26
    v_fmac_f32 v9, v35, v30
    v_fmac_f32 v10, v35, v27
    v_fmac_f32 v11, v35, v31
    v_fmac_f32 v12, v35, v28
    v_fmac_f32 v13, v35, v32
    v_fmac_f32 v14, v35, v29
    v_fmac_f32 v15, v35, v33
    v_lshlrev_b32 v26, 16, v88
    v_and_b32 v30, 0xffff0000, v88
    v_lshlrev_b32 v27, 16, v89
    v_and_b32 v31, 0xffff0000, v89
    v_lshlrev_b32 v28, 16, v90
    v_and_b32 v32, 0xffff0000, v90
    v_lshlrev_b32 v29, 16, v91
    v_and_b32 v33, 0xffff0000, v91
    v_fmac_f32 v8, v36, v26
    v_fmac_f32 v9, v36, v30
    v_fmac_f32 v10, v36, v27
    v_fmac_f32 v11, v36, v31
    v_fmac_f32 v12, v36, v28
    v_fmac_f32 v13, v36, v32
    v_fmac_f32 v14, v36, v29
    v_fmac_f32 v15, v36, v33
    v_lshlrev_b32 v26, 16, v92
    v_and_b32 v30, 0xffff0000, v92
    v_lshlrev_b32 v27, 16, v93
    v_and_b32 v31, 0xffff0000, v93
    v_lshlrev_b32 v28, 16, v94
    v_and_b32 v32, 0xffff0000, v94
    v_lshlrev_b32 v29, 16, v95
    v_and_b32 v33, 0xffff0000, v95
    v_fmac_f32 v8, v37, v26
    v_fmac_f32 v9, v37, v30
    v_fmac_f32 v10, v37, v27
    v_fmac_f32 v11, v37, v31
    v_fmac_f32 v12, v37, v28
    v_fmac_f32 v13, v37, v32
    v_fmac_f32 v14, v37, v29
    v_fmac_f32 v15, v37, v33
    buffer_load_dwordx4 v[80:83], v4, s[48:51], s8 offen offset:0 nt
    buffer_load_dwordx4 v[84:87], v4, s[48:51], s8 offen offset:1024 nt
    buffer_load_dwordx4 v[88:91], v4, s[48:51], s8 offen offset:2048 nt
    buffer_load_dwordx4 v[92:95], v4, s[48:51], s8 offen offset:3072 nt
    s_add_u32 s8, s8, 49152
    s_waitcnt vmcnt(12)
    v_dot2_f32_bf16 v22, v96, v16, 0
    v_dot2_f32_bf16 v23, v100, v16, 0
    v_dot2_f32_bf16 v24, v104, v16, 0
    v_dot2_f32_bf16 v25, v108, v16, 0
    v_dot2_f32_bf16 v22, v97, v17, v22
    v_dot2_f32_bf16 v23, v101, v17, v23
    v_dot2_f32_bf16 v24, v105, v17, v24
    v_dot2_f32_bf16 v25, v109, v17, v25
    v_dot2_f32_bf16 v22, v98, v18, v22
    v_dot2_f32_bf16 v23, v102, v18, v23
    v_dot2_f32_bf16 v24, v106, v18, v24
    v_dot2_f32_bf16 v25, v110, v18, v25
    v_dot2_f32_bf16 v22, v99, v19, v22
    v_dot2_f32_bf16 v23, v103, v19, v23
    v_dot2_f32_bf16 v24, v107, v19, v24
    v_dot2_f32_bf16 v25, v111, v19, v25
    v_add_f32_dpp v22, v22, v22 row_ror:8 row_mask:0xf bank_mask:0xf
    v_add_f32_dpp v23, v23, v23 row_ror:8 row_mask:0xf bank_mask:0xf
    v_add_f32_dpp v24, v24, v24 row_ror:8 row_mask:0xf bank_mask:0xf
    v_add_f32_dpp v25, v25, v25 row_ror:8 row_mask:0xf bank_mask:0xf
    v_add_f32_dpp v22, v22, v22 row_ror:4 row_mask:0xf bank_mask:0xf
    v_add_f32_dpp v23, v23, v23 row_ror:4 row_mask:0xf bank_mask:0xf
    v_add_f32_dpp v24, v24, v24 row_ror:4 row_mask:0xf bank_mask:0xf
    v_add_f32_dpp v25, v25, v25 row_ror:4 row_mask:0xf bank_mask:0xf
    v_add_f32_dpp v22, v22, v22 row_ror:2 row_mask:0xf bank_mask:0xf
    v_add_f32_dpp v23, v23, v23 row_ror:2 row_mask:0xf bank_mask:0xf
    v_add_f32_dpp v24, v24, v24 row_ror:2 row_mask:0xf bank_mask:0xf
    v_add_f32_dpp v25, v25, v25 row_ror:2 row_mask:0xf bank_mask:0xf
    v_add_f32_dpp v22, v22, v22 row_ror:1 row_mask:0xf bank_mask:0xf
    v_add_f32_dpp v23, v23, v23 row_ror:1 row_mask:0xf bank_mask:0xf
    v_add_f32_dpp v24, v24, v24 row_ror:1 row_mask:0xf bank_mask:0xf
    v_add_f32_dpp v25, v25, v25 row_ror:1 row_mask:0xf bank_mask:0xf
    buffer_load_dwordx4 v[96:99], v4, s[44:47], s8 offen offset:0 nt
    buffer_load_dwordx4 v[100:103], v4, s[44:47], s8 offen offset:1024 nt
    buffer_load_dwordx4 v[104:107], v4, s[44:47], s8 offen offset:2048 nt
    buffer_load_dwordx4 v[108:111], v4, s[44:47], s8 offen offset:3072 nt
    v_cvt_pk_bf16_f32 v26, v22, v23
    v_cvt_pk_bf16_f32 v27, v24, v25
    v_lshlrev_b32 v34, 16, v26
    v_and_b32 v35, 0xffff0000, v26
    v_lshlrev_b32 v36, 16, v27
    v_and_b32 v37, 0xffff0000, v27
    v_mul_f32 v34, s68, v34
    v_mul_f32 v35, s68, v35
    v_mul_f32 v36, s68, v36
    v_mul_f32 v37, s68, v37
    v_cvt_pk_bf16_f32 v26, v34, v35
    v_cvt_pk_bf16_f32 v27, v36, v37
    v_lshlrev_b32 v34, 16, v26
    v_and_b32 v35, 0xffff0000, v26
    v_lshlrev_b32 v36, 16, v27
    v_and_b32 v37, 0xffff0000, v27
    v_max3_f32 v26, v34, v35, v36
    v_max3_f32 v26, v26, v37, v20
    v_sub_f32 v27, v20, v26
    v_mul_f32 v39, s70, v26
    v_mul_f32 v27, s69, v27
    v_mov_b32 v20, v26
    v_fma_f32 v34, v34, s69, v39
    v_fma_f32 v35, v35, s69, v39
    v_fma_f32 v36, v36, s69, v39
    v_fma_f32 v37, v37, s69, v39
    v_exp_f32 v38, v27
    v_exp_f32 v34, v34
    v_exp_f32 v35, v35
    v_exp_f32 v36, v36
    v_exp_f32 v37, v37
    s_nop 0
    v_fma_f32 v21, v21, v38, v34
    v_mul_f32 v8, v38, v8
    v_mul_f32 v9, v38, v9
    v_mul_f32 v10, v38, v10
    v_mul_f32 v11, v38, v11
    v_mul_f32 v12, v38, v12
    v_mul_f32 v13, v38, v13
    v_mul_f32 v14, v38, v14
    v_mul_f32 v15, v38, v15
    v_add_f32 v26, v35, v36
    v_add_f32 v26, v26, v37
    v_add_f32 v21, v21, v26
    s_waitcnt vmcnt(12)
    v_lshlrev_b32 v26, 16, v112
    v_and_b32 v30, 0xffff0000, v112
    v_lshlrev_b32 v27, 16, v113
    v_and_b32 v31, 0xffff0000, v113
    v_lshlrev_b32 v28, 16, v114
    v_and_b32 v32, 0xffff0000, v114
    v_lshlrev_b32 v29, 16, v115
    v_and_b32 v33, 0xffff0000, v115
    v_fmac_f32 v8, v34, v26
    v_fmac_f32 v9, v34, v30
    v_fmac_f32 v10, v34, v27
    v_fmac_f32 v11, v34, v31
    v_fmac_f32 v12, v34, v28
    v_fmac_f32 v13, v34, v32
    v_fmac_f32 v14, v34, v29
    v_fmac_f32 v15, v34, v33
    v_lshlrev_b32 v26, 16, v116
    v_and_b32 v30, 0xffff0000, v116
    v_lshlrev_b32 v27, 16, v117
    v_and_b32 v31, 0xffff0000, v117
    v_lshlrev_b32 v28, 16, v118
    v_and_b32 v32, 0xffff0000, v118
    v_lshlrev_b32 v29, 16, v119
    v_and_b32 v33, 0xffff0000, v119
    v_fmac_f32 v8, v35, v26
    v_fmac_f32 v9, v35, v30
    v_fmac_f32 v10, v35, v27
    v_fmac_f32 v11, v35, v31
    v_fmac_f32 v12, v35, v28
    v_fmac_f32 v13, v35, v32
    v_fmac_f32 v14, v35, v29
    v_fmac_f32 v15, v35, v33
    v_lshlrev_b32 v26, 16, v120
    v_and_b32 v30, 0xffff0000, v120
    v_lshlrev_b32 v27, 16, v121
    v_and_b32 v31, 0xffff0000, v121
    v_lshlrev_b32 v28, 16, v122
    v_and_b32 v32, 0xffff0000, v122
    v_lshlrev_b32 v29, 16, v123
    v_and_b32 v33, 0xffff0000, v123
    v_fmac_f32 v8, v36, v26
    v_fmac_f32 v9, v36, v30
    v_fmac_f32 v10, v36, v27
    v_fmac_f32 v11, v36, v31
    v_fmac_f32 v12, v36, v28
    v_fmac_f32 v13, v36, v32
    v_fmac_f32 v14, v36, v29
    v_fmac_f32 v15, v36, v33
    v_lshlrev_b32 v26, 16, v124
    v_and_b32 v30, 0xffff0000, v124
    v_lshlrev_b32 v27, 16, v125
    v_and_b32 v31, 0xffff0000, v125
    v_lshlrev_b32 v28, 16, v126
    v_and_b32 v32, 0xffff0000, v126
    v_lshlrev_b32 v29, 16, v127
    v_and_b32 v33, 0xffff0000, v127
    v_fmac_f32 v8, v37, v26
    v_fmac_f32 v9, v37, v30
    v_fmac_f32 v10, v37, v27
    v_fmac_f32 v11, v37, v31
    v_fmac_f32 v12, v37, v28
    v_fmac_f32 v13, v37, v32
    v_fmac_f32 v14, v37, v29
    v_fmac_f32 v15, v37, v33
    buffer_load_dwordx4 v[112:115], v4, s[48:51], s8 offen offset:0 nt
    buffer_load_dwordx4 v[116:119], v4, s[48:51], s8 offen offset:1024 nt
    buffer_load_dwordx4 v[120:123], v4, s[48:51], s8 offen offset:2048 nt
    buffer_load_dwordx4 v[124:127], v4, s[48:51], s8 offen offset:3072 nt
    s_add_u32 s8, s8, 49152
    s_waitcnt vmcnt(12)
    v_dot2_f32_bf16 v22, v64, v16, 0
    v_dot2_f32_bf16 v23, v68, v16, 0
    v_dot2_f32_bf16 v24, v72, v16, 0
    v_dot2_f32_bf16 v25, v76, v16, 0
    v_dot2_f32_bf16 v22, v65, v17, v22
    v_dot2_f32_bf16 v23, v69, v17, v23
    v_dot2_f32_bf16 v24, v73, v17, v24
    v_dot2_f32_bf16 v25, v77, v17, v25
    v_dot2_f32_bf16 v22, v66, v18, v22
    v_dot2_f32_bf16 v23, v70, v18, v23
    v_dot2_f32_bf16 v24, v74, v18, v24
    v_dot2_f32_bf16 v25, v78, v18, v25
    v_dot2_f32_bf16 v22, v67, v19, v22
    v_dot2_f32_bf16 v23, v71, v19, v23
    v_dot2_f32_bf16 v24, v75, v19, v24
    v_dot2_f32_bf16 v25, v79, v19, v25
    v_add_f32_dpp v22, v22, v22 row_ror:8 row_mask:0xf bank_mask:0xf
    v_add_f32_dpp v23, v23, v23 row_ror:8 row_mask:0xf bank_mask:0xf
    v_add_f32_dpp v24, v24, v24 row_ror:8 row_mask:0xf bank_mask:0xf
    v_add_f32_dpp v25, v25, v25 row_ror:8 row_mask:0xf bank_mask:0xf
    v_add_f32_dpp v22, v22, v22 row_ror:4 row_mask:0xf bank_mask:0xf
    v_add_f32_dpp v23, v23, v23 row_ror:4 row_mask:0xf bank_mask:0xf
    v_add_f32_dpp v24, v24, v24 row_ror:4 row_mask:0xf bank_mask:0xf
    v_add_f32_dpp v25, v25, v25 row_ror:4 row_mask:0xf bank_mask:0xf
    v_add_f32_dpp v22, v22, v22 row_ror:2 row_mask:0xf bank_mask:0xf
    v_add_f32_dpp v23, v23, v23 row_ror:2 row_mask:0xf bank_mask:0xf
    v_add_f32_dpp v24, v24, v24 row_ror:2 row_mask:0xf bank_mask:0xf
    v_add_f32_dpp v25, v25, v25 row_ror:2 row_mask:0xf bank_mask:0xf
    v_add_f32_dpp v22, v22, v22 row_ror:1 row_mask:0xf bank_mask:0xf
    v_add_f32_dpp v23, v23, v23 row_ror:1 row_mask:0xf bank_mask:0xf
    v_add_f32_dpp v24, v24, v24 row_ror:1 row_mask:0xf bank_mask:0xf
    v_add_f32_dpp v25, v25, v25 row_ror:1 row_mask:0xf bank_mask:0xf
    buffer_load_dwordx4 v[64:67], v4, s[44:47], s8 offen offset:0 nt
    buffer_load_dwordx4 v[68:71], v4, s[44:47], s8 offen offset:1024 nt
    buffer_load_dwordx4 v[72:75], v4, s[44:47], s8 offen offset:2048 nt
    buffer_load_dwordx4 v[76:79], v4, s[44:47], s8 offen offset:3072 nt
    v_cvt_pk_bf16_f32 v26, v22, v23
    v_cvt_pk_bf16_f32 v27, v24, v25
    v_lshlrev_b32 v34, 16, v26
    v_and_b32 v35, 0xffff0000, v26
    v_lshlrev_b32 v36, 16, v27
    v_and_b32 v37, 0xffff0000, v27
    v_mul_f32 v34, s68, v34
    v_mul_f32 v35, s68, v35
    v_mul_f32 v36, s68, v36
    v_mul_f32 v37, s68, v37
    v_cvt_pk_bf16_f32 v26, v34, v35
    v_cvt_pk_bf16_f32 v27, v36, v37
    v_lshlrev_b32 v34, 16, v26
    v_and_b32 v35, 0xffff0000, v26
    v_lshlrev_b32 v36, 16, v27
    v_and_b32 v37, 0xffff0000, v27
    v_max3_f32 v26, v34, v35, v36
    v_max3_f32 v26, v26, v37, v20
    v_sub_f32 v27, v20, v26
    v_mul_f32 v39, s70, v26
    v_mul_f32 v27, s69, v27
    v_mov_b32 v20, v26
    v_fma_f32 v34, v34, s69, v39
    v_fma_f32 v35, v35, s69, v39
    v_fma_f32 v36, v36, s69, v39
    v_fma_f32 v37, v37, s69, v39
    v_exp_f32 v38, v27
    v_exp_f32 v34, v34
    v_exp_f32 v35, v35
    v_exp_f32 v36, v36
    v_exp_f32 v37, v37
    s_nop 0
    v_fma_f32 v21, v21, v38, v34
    v_mul_f32 v8, v38, v8
    v_mul_f32 v9, v38, v9
    v_mul_f32 v10, v38, v10
    v_mul_f32 v11, v38, v11
    v_mul_f32 v12, v38, v12
    v_mul_f32 v13, v38, v13
    v_mul_f32 v14, v38, v14
    v_mul_f32 v15, v38, v15
    v_add_f32 v26, v35, v36
    v_add_f32 v26, v26, v37
    v_add_f32 v21, v21, v26
    s_waitcnt vmcnt(12)
    v_lshlrev_b32 v26, 16, v80
    v_and_b32 v30, 0xffff0000, v80
    v_lshlrev_b32 v27, 16, v81
    v_and_b32 v31, 0xffff0000, v81
    v_lshlrev_b32 v28, 16, v82
    v_and_b32 v32, 0xffff0000, v82
    v_lshlrev_b32 v29, 16, v83
    v_and_b32 v33, 0xffff0000, v83
    v_fmac_f32 v8, v34, v26
    v_fmac_f32 v9, v34, v30
    v_fmac_f32 v10, v34, v27
    v_fmac_f32 v11, v34, v31
    v_fmac_f32 v12, v34, v28
    v_fmac_f32 v13, v34, v32
    v_fmac_f32 v14, v34, v29
    v_fmac_f32 v15, v34, v33
    v_lshlrev_b32 v26, 16, v84
    v_and_b32 v30, 0xffff0000, v84
    v_lshlrev_b32 v27, 16, v85
    v_and_b32 v31, 0xffff0000, v85
    v_lshlrev_b32 v28, 16, v86
    v_and_b32 v32, 0xffff0000, v86
    v_lshlrev_b32 v29, 16, v87
    v_and_b32 v33, 0xffff0000, v87
    v_fmac_f32 v8, v35, v26
    v_fmac_f32 v9, v35, v30
    v_fmac_f32 v10, v35, v27
    v_fmac_f32 v11, v35, v31
    v_fmac_f32 v12, v35, v28
    v_fmac_f32 v13, v35, v32
    v_fmac_f32 v14, v35, v29
    v_fmac_f32 v15, v35, v33
    v_lshlrev_b32 v26, 16, v88
    v_and_b32 v30, 0xffff0000, v88
    v_lshlrev_b32 v27, 16, v89
    v_and_b32 v31, 0xffff0000, v89
    v_lshlrev_b32 v28, 16, v90
    v_and_b32 v32, 0xffff0000, v90
    v_lshlrev_b32 v29, 16, v91
    v_and_b32 v33, 0xffff0000, v91
    v_fmac_f32 v8, v36, v26
    v_fmac_f32 v9, v36, v30
    v_fmac_f32 v10, v36, v27
    v_fmac_f32 v11, v36, v31
    v_fmac_f32 v12, v36, v28
    v_fmac_f32 v13, v36, v32
    v_fmac_f32 v14, v36, v29
    v_fmac_f32 v15, v36, v33
    v_lshlrev_b32 v26, 16, v92
    v_and_b32 v30, 0xffff0000, v92
    v_lshlrev_b32 v27, 16, v93
    v_and_b32 v31, 0xffff0000, v93
    v_lshlrev_b32 v28, 16, v94
    v_and_b32 v32, 0xffff0000, v94
    v_lshlrev_b32 v29, 16, v95
    v_and_b32 v33, 0xffff0000, v95
    v_fmac_f32 v8, v37, v26
    v_fmac_f32 v9, v37, v30
    v_fmac_f32 v10, v37, v27
    v_fmac_f32 v11, v37, v31
    v_fmac_f32 v12, v37, v28
    v_fmac_f32 v13, v37, v32
    v_fmac_f32 v14, v37, v29
    v_fmac_f32 v15, v37, v33
    buffer_load_dwordx4 v[80:83], v4, s[48:51], s8 offen offset:0 nt
    buffer_load_dwordx4 v[84:87], v4, s[48:51], s8 offen offset:1024 nt
    buffer_load_dwordx4 v[88:91], v4, s[48:51], s8 offen offset:2048 nt
    buffer_load_dwordx4 v[92:95], v4, s[48:51], s8 offen offset:3072 nt
    s_add_u32 s8, s8, 49152
    s_waitcnt vmcnt(12)
    v_dot2_f32_bf16 v22, v96, v16, 0
    v_dot2_f32_bf16 v23, v100, v16, 0
    v_dot2_f32_bf16 v24, v104, v16, 0
    v_dot2_f32_bf16 v25, v108, v16, 0
    v_dot2_f32_bf16 v22, v97, v17, v22
    v_dot2_f32_bf16 v23, v101, v17, v23
    v_dot2_f32_bf16 v24, v105, v17, v24
    v_dot2_f32_bf16 v25, v109, v17, v25
    v_dot2_f32_bf16 v22, v98, v18, v22
    v_dot2_f32_bf16 v23, v102, v18, v23
    v_dot2_f32_bf16 v24, v106, v18, v24
    v_dot2_f32_bf16 v25, v110, v18, v25
    v_dot2_f32_bf16 v22, v99, v19, v22
    v_dot2_f32_bf16 v23, v103, v19, v23
    v_dot2_f32_bf16 v24, v107, v19, v24
    v_dot2_f32_bf16 v25, v111, v19, v25
    v_add_f32_dpp v22, v22, v22 row_ror:8 row_mask:0xf bank_mask:0xf
    v_add_f32_dpp v23, v23, v23 row_ror:8 row_mask:0xf bank_mask:0xf
    v_add_f32_dpp v24, v24, v24 row_ror:8 row_mask:0xf bank_mask:0xf
    v_add_f32_dpp v25, v25, v25 row_ror:8 row_mask:0xf bank_mask:0xf
    v_add_f32_dpp v22, v22, v22 row_ror:4 row_mask:0xf bank_mask:0xf
    v_add_f32_dpp v23, v23, v23 row_ror:4 row_mask:0xf bank_mask:0xf
    v_add_f32_dpp v24, v24, v24 row_ror:4 row_mask:0xf bank_mask:0xf
    v_add_f32_dpp v25, v25, v25 row_ror:4 row_mask:0xf bank_mask:0xf
    v_add_f32_dpp v22, v22, v22 row_ror:2 row_mask:0xf bank_mask:0xf
    v_add_f32_dpp v23, v23, v23 row_ror:2 row_mask:0xf bank_mask:0xf
    v_add_f32_dpp v24, v24, v24 row_ror:2 row_mask:0xf bank_mask:0xf
    v_add_f32_dpp v25, v25, v25 row_ror:2 row_mask:0xf bank_mask:0xf
    v_add_f32_dpp v22, v22, v22 row_ror:1 row_mask:0xf bank_mask:0xf
    v_add_f32_dpp v23, v23, v23 row_ror:1 row_mask:0xf bank_mask:0xf
    v_add_f32_dpp v24, v24, v24 row_ror:1 row_mask:0xf bank_mask:0xf
    v_add_f32_dpp v25, v25, v25 row_ror:1 row_mask:0xf bank_mask:0xf
    buffer_load_dwordx4 v[96:99], v4, s[44:47], s8 offen offset:0 nt
    buffer_load_dwordx4 v[100:103], v4, s[44:47], s8 offen offset:1024 nt
    buffer_load_dwordx4 v[104:107], v4, s[44:47], s8 offen offset:2048 nt
    buffer_load_dwordx4 v[108:111], v4, s[44:47], s8 offen offset:3072 nt
    v_cvt_pk_bf16_f32 v26, v22, v23
    v_cvt_pk_bf16_f32 v27, v24, v25
    v_lshlrev_b32 v34, 16, v26
    v_and_b32 v35, 0xffff0000, v26
    v_lshlrev_b32 v36, 16, v27
    v_and_b32 v37, 0xffff0000, v27
    v_mul_f32 v34, s68, v34
    v_mul_f32 v35, s68, v35
    v_mul_f32 v36, s68, v36
    v_mul_f32 v37, s68, v37
    v_cvt_pk_bf16_f32 v26, v34, v35
    v_cvt_pk_bf16_f32 v27, v36, v37
    v_lshlrev_b32 v34, 16, v26
    v_and_b32 v35, 0xffff0000, v26
    v_lshlrev_b32 v36, 16, v27
    v_and_b32 v37, 0xffff0000, v27
    v_max3_f32 v26, v34, v35, v36
    v_max3_f32 v26, v26, v37, v20
    v_sub_f32 v27, v20, v26
    v_mul_f32 v39, s70, v26
    v_mul_f32 v27, s69, v27
    v_mov_b32 v20, v26
    v_fma_f32 v34, v34, s69, v39
    v_fma_f32 v35, v35, s69, v39
    v_fma_f32 v36, v36, s69, v39
    v_fma_f32 v37, v37, s69, v39
    v_exp_f32 v38, v27
    v_exp_f32 v34, v34
    v_exp_f32 v35, v35
    v_exp_f32 v36, v36
    v_exp_f32 v37, v37
    s_nop 0
    v_fma_f32 v21, v21, v38, v34
    v_mul_f32 v8, v38, v8
    v_mul_f32 v9, v38, v9
    v_mul_f32 v10, v38, v10
    v_mul_f32 v11, v38, v11
    v_mul_f32 v12, v38, v12
    v_mul_f32 v13, v38, v13
    v_mul_f32 v14, v38, v14
    v_mul_f32 v15, v38, v15
    v_add_f32 v26, v35, v36
    v_add_f32 v26, v26, v37
    v_add_f32 v21, v21, v26
    s_waitcnt vmcnt(12)
    v_lshlrev_b32 v26, 16, v112
    v_and_b32 v30, 0xffff0000, v112
    v_lshlrev_b32 v27, 16, v113
    v_and_b32 v31, 0xffff0000, v113
    v_lshlrev_b32 v28, 16, v114
    v_and_b32 v32, 0xffff0000, v114
    v_lshlrev_b32 v29, 16, v115
    v_and_b32 v33, 0xffff0000, v115
    v_fmac_f32 v8, v34, v26
    v_fmac_f32 v9, v34, v30
    v_fmac_f32 v10, v34, v27
    v_fmac_f32 v11, v34, v31
    v_fmac_f32 v12, v34, v28
    v_fmac_f32 v13, v34, v32
    v_fmac_f32 v14, v34, v29
    v_fmac_f32 v15, v34, v33
    v_lshlrev_b32 v26, 16, v116
    v_and_b32 v30, 0xffff0000, v116
    v_lshlrev_b32 v27, 16, v117
    v_and_b32 v31, 0xffff0000, v117
    v_lshlrev_b32 v28, 16, v118
    v_and_b32 v32, 0xffff0000, v118
    v_lshlrev_b32 v29, 16, v119
    v_and_b32 v33, 0xffff0000, v119
    v_fmac_f32 v8, v35, v26
    v_fmac_f32 v9, v35, v30
    v_fmac_f32 v10, v35, v27
    v_fmac_f32 v11, v35, v31
    v_fmac_f32 v12, v35, v28
    v_fmac_f32 v13, v35, v32
    v_fmac_f32 v14, v35, v29
    v_fmac_f32 v15, v35, v33
    v_lshlrev_b32 v26, 16, v120
    v_and_b32 v30, 0xffff0000, v120
    v_lshlrev_b32 v27, 16, v121
    v_and_b32 v31, 0xffff0000, v121
    v_lshlrev_b32 v28, 16, v122
    v_and_b32 v32, 0xffff0000, v122
    v_lshlrev_b32 v29, 16, v123
    v_and_b32 v33, 0xffff0000, v123
    v_fmac_f32 v8, v36, v26
    v_fmac_f32 v9, v36, v30
    v_fmac_f32 v10, v36, v27
    v_fmac_f32 v11, v36, v31
    v_fmac_f32 v12, v36, v28
    v_fmac_f32 v13, v36, v32
    v_fmac_f32 v14, v36, v29
    v_fmac_f32 v15, v36, v33
    v_lshlrev_b32 v26, 16, v124
    v_and_b32 v30, 0xffff0000, v124
    v_lshlrev_b32 v27, 16, v125
    v_and_b32 v31, 0xffff0000, v125
    v_lshlrev_b32 v28, 16, v126
    v_and_b32 v32, 0xffff0000, v126
    v_lshlrev_b32 v29, 16, v127
    v_and_b32 v33, 0xffff0000, v127
    v_fmac_f32 v8, v37, v26
    v_fmac_f32 v9, v37, v30
    v_fmac_f32 v10, v37, v27
    v_fmac_f32 v11, v37, v31
    v_fmac_f32 v12, v37, v28
    v_fmac_f32 v13, v37, v32
    v_fmac_f32 v14, v37, v29
    v_fmac_f32 v15, v37, v33
    buffer_load_dwordx4 v[112:115], v4, s[48:51], s8 offen offset:0 nt
    buffer_load_dwordx4 v[116:119], v4, s[48:51], s8 offen offset:1024 nt
    buffer_load_dwordx4 v[120:123], v4, s[48:51], s8 offen offset:2048 nt
    buffer_load_dwordx4 v[124:127], v4, s[48:51], s8 offen offset:3072 nt
    s_add_u32 s8, s8, 49152
    buffer_load_dwordx4 v[128:131], v4, s[56:59], s10 offen
    s_add_u32 s10, s10, 1024
    buffer_load_dwordx4 v[132:135], v4, s[56:59], s10 offen
    s_add_u32 s10, s10, 1024
    buffer_load_dwordx4 v[136:139], v4, s[56:59], s10 offen
    s_add_u32 s10, s10, 1024
    buffer_load_dwordx4 v[140:143], v4, s[56:59], s10 offen
    s_add_u32 s10, s10, 1024
    buffer_load_dwordx4 v[144:147], v4, s[56:59], s10 offen
    s_add_u32 s10, s10, 1024
    buffer_load_dwordx4 v[148:151], v4, s[56:59], s10 offen
    s_add_u32 s10, s10, 1024
    buffer_load_dwordx4 v[152:155], v4, s[56:59], s10 offen
    s_add_u32 s10, s10, 1024
    buffer_load_dwordx4 v[156:159], v4, s[56:59], s10 offen
    s_add_u32 s10, s10, 1024
    buffer_load_dwordx4 v[160:163], v4, s[56:59], s10 offen
    s_add_u32 s10, s10, 1024
    buffer_load_dwordx4 v[164:167], v4, s[56:59], s10 offen
    s_add_u32 s10, s10, 1024
    buffer_load_dwordx4 v[168:171], v4, s[56:59], s10 offen
    s_add_u32 s10, s10, 1024
    buffer_load_dwordx4 v[172:175], v4, s[56:59], s10 offen
    s_add_u32 s10, s10, 1024
    buffer_load_dwordx4 v[176:179], v4, s[56:59], s10 offen
    s_add_u32 s10, s10, 1024
    buffer_load_dwordx4 v[180:183], v4, s[56:59], s10 offen
    s_add_u32 s10, s10, 1024
    buffer_load_dwordx4 v[184:187], v4, s[56:59], s10 offen
    s_add_u32 s10, s10, 1024
    buffer_load_dwordx4 v[188:191], v4, s[56:59], s10 offen
    s_add_u32 s10, s10, 1024
    buffer_load_dwordx4 v[192:195], v4, s[56:59], s10 offen
    s_add_u32 s10, s10, 1024
    buffer_load_dwordx4 v[196:199], v4, s[56:59], s10 offen
    s_add_u32 s10, s10, 1024
    buffer_load_dwordx4 v[200:203], v4, s[56:59], s10 offen
    s_add_u32 s10, s10, 1024
    buffer_load_dwordx4 v[204:207], v4, s[56:59], s10 offen
    s_add_u32 s10, s10, 1024
    buffer_load_dwordx4 v[208:211], v4, s[56:59], s10 offen
    s_add_u32 s10, s10, 1024
    buffer_load_dwordx4 v[212:215], v4, s[56:59], s10 offen
    s_add_u32 s10, s10, 1024
    buffer_load_dwordx4 v[216:219], v4, s[56:59], s10 offen
    s_add_u32 s10, s10, 1024
    buffer_load_dwordx4 v[220:223], v4, s[56:59], s10 offen
    s_add_u32 s10, s10, 1024
    buffer_load_dwordx4 v[224:227], v4, s[56:59], s10 offen
    s_add_u32 s10, s10, 1024
    buffer_load_dwordx4 v[228:231], v4, s[56:59], s10 offen
    s_add_u32 s10, s10, 1024
    buffer_load_dwordx4 v[232:235], v4, s[56:59], s10 offen
    s_add_u32 s10, s10, 1024
    buffer_load_dwordx4 v[236:239], v4, s[56:59], s10 offen
    s_add_u32 s10, s10, 1024
    buffer_load_dwordx4 v[240:243], v4, s[56:59], s10 offen
    s_add_u32 s10, s10, 1024
    buffer_load_dwordx4 v[244:247], v4, s[56:59], s10 offen
    s_add_u32 s10, s10, 1024
    buffer_load_dwordx4 v[248:251], v4, s[56:59], s10 offen
    s_add_u32 s10, s10, 1024
    buffer_load_dwordx4 v[252:255], v4, s[56:59], s10 offen
    s_add_u32 s10, s10, 1024
    s_waitcnt vmcnt(44)
    v_dot2_f32_bf16 v22, v64, v16, 0
    v_dot2_f32_bf16 v23, v68, v16, 0
    v_dot2_f32_bf16 v24, v72, v16, 0
    v_dot2_f32_bf16 v25, v76, v16, 0
    v_dot2_f32_bf16 v22, v65, v17, v22
    v_dot2_f32_bf16 v23, v69, v17, v23
    v_dot2_f32_bf16 v24, v73, v17, v24
    v_dot2_f32_bf16 v25, v77, v17, v25
    v_dot2_f32_bf16 v22, v66, v18, v22
    v_dot2_f32_bf16 v23, v70, v18, v23
    v_dot2_f32_bf16 v24, v74, v18, v24
    v_dot2_f32_bf16 v25, v78, v18, v25
    v_dot2_f32_bf16 v22, v67, v19, v22
    v_dot2_f32_bf16 v23, v71, v19, v23
    v_dot2_f32_bf16 v24, v75, v19, v24
    v_dot2_f32_bf16 v25, v79, v19, v25
    v_add_f32_dpp v22, v22, v22 row_ror:8 row_mask:0xf bank_mask:0xf
    v_add_f32_dpp v23, v23, v23 row_ror:8 row_mask:0xf bank_mask:0xf
    v_add_f32_dpp v24, v24, v24 row_ror:8 row_mask:0xf bank_mask:0xf
    v_add_f32_dpp v25, v25, v25 row_ror:8 row_mask:0xf bank_mask:0xf
    v_add_f32_dpp v22, v22, v22 row_ror:4 row_mask:0xf bank_mask:0xf
    v_add_f32_dpp v23, v23, v23 row_ror:4 row_mask:0xf bank_mask:0xf
    v_add_f32_dpp v24, v24, v24 row_ror:4 row_mask:0xf bank_mask:0xf
    v_add_f32_dpp v25, v25, v25 row_ror:4 row_mask:0xf bank_mask:0xf
    v_add_f32_dpp v22, v22, v22 row_ror:2 row_mask:0xf bank_mask:0xf
    v_add_f32_dpp v23, v23, v23 row_ror:2 row_mask:0xf bank_mask:0xf
    v_add_f32_dpp v24, v24, v24 row_ror:2 row_mask:0xf bank_mask:0xf
    v_add_f32_dpp v25, v25, v25 row_ror:2 row_mask:0xf bank_mask:0xf
    v_add_f32_dpp v22, v22, v22 row_ror:1 row_mask:0xf bank_mask:0xf
    v_add_f32_dpp v23, v23, v23 row_ror:1 row_mask:0xf bank_mask:0xf
    v_add_f32_dpp v24, v24, v24 row_ror:1 row_mask:0xf bank_mask:0xf
    v_add_f32_dpp v25, v25, v25 row_ror:1 row_mask:0xf bank_mask:0xf
    buffer_load_dwordx4 v[64:67], v4, s[44:47], s8 offen offset:0 nt
    buffer_load_dwordx4 v[68:71], v4, s[44:47], s8 offen offset:1024 nt
    buffer_load_dwordx4 v[72:75], v4, s[44:47], s8 offen offset:2048 nt
    buffer_load_dwordx4 v[76:79], v4, s[44:47], s8 offen offset:3072 nt
    v_cvt_pk_bf16_f32 v26, v22, v23
    v_cvt_pk_bf16_f32 v27, v24, v25
    v_lshlrev_b32 v34, 16, v26
    v_and_b32 v35, 0xffff0000, v26
    v_lshlrev_b32 v36, 16, v27
    v_and_b32 v37, 0xffff0000, v27
    v_mul_f32 v34, s68, v34
    v_mul_f32 v35, s68, v35
    v_mul_f32 v36, s68, v36
    v_mul_f32 v37, s68, v37
    v_cvt_pk_bf16_f32 v26, v34, v35
    v_cvt_pk_bf16_f32 v27, v36, v37
    v_lshlrev_b32 v34, 16, v26
    v_and_b32 v35, 0xffff0000, v26
    v_lshlrev_b32 v36, 16, v27
    v_and_b32 v37, 0xffff0000, v27
    v_max3_f32 v26, v34, v35, v36
    v_max3_f32 v26, v26, v37, v20
    v_sub_f32 v27, v20, v26
    v_mul_f32 v39, s70, v26
    v_mul_f32 v27, s69, v27
    v_mov_b32 v20, v26
    v_fma_f32 v34, v34, s69, v39
    v_fma_f32 v35, v35, s69, v39
    v_fma_f32 v36, v36, s69, v39
    v_fma_f32 v37, v37, s69, v39
    v_exp_f32 v38, v27
    v_exp_f32 v34, v34
    v_exp_f32 v35, v35
    v_exp_f32 v36, v36
    v_exp_f32 v37, v37
    s_nop 0
    v_fma_f32 v21, v21, v38, v34
    v_mul_f32 v8, v38, v8
    v_mul_f32 v9, v38, v9
    v_mul_f32 v10, v38, v10
    v_mul_f32 v11, v38, v11
    v_mul_f32 v12, v38, v12
    v_mul_f32 v13, v38, v13
    v_mul_f32 v14, v38, v14
    v_mul_f32 v15, v38, v15
    v_add_f32 v26, v35, v36
    v_add_f32 v26, v26, v37
    v_add_f32 v21, v21, v26
    s_waitcnt vmcnt(44)
    v_lshlrev_b32 v26, 16, v80
    v_and_b32 v30, 0xffff0000, v80
    v_lshlrev_b32 v27, 16, v81
    v_and_b32 v31, 0xffff0000, v81
    v_lshlrev_b32 v28, 16, v82
    v_and_b32 v32, 0xffff0000, v82
    v_lshlrev_b32 v29, 16, v83
    v_and_b32 v33, 0xffff0000, v83
    v_fmac_f32 v8, v34, v26
    v_fmac_f32 v9, v34, v30
    v_fmac_f32 v10, v34, v27
    v_fmac_f32 v11, v34, v31
    v_fmac_f32 v12, v34, v28
    v_fmac_f32 v13, v34, v32
    v_fmac_f32 v14, v34, v29
    v_fmac_f32 v15, v34, v33
    v_lshlrev_b32 v26, 16, v84
    v_and_b32 v30, 0xffff0000, v84
    v_lshlrev_b32 v27, 16, v85
    v_and_b32 v31, 0xffff0000, v85
    v_lshlrev_b32 v28, 16, v86
    v_and_b32 v32, 0xffff0000, v86
    v_lshlrev_b32 v29, 16, v87
    v_and_b32 v33, 0xffff0000, v87
    v_fmac_f32 v8, v35, v26
    v_fmac_f32 v9, v35, v30
    v_fmac_f32 v10, v35, v27
    v_fmac_f32 v11, v35, v31
    v_fmac_f32 v12, v35, v28
    v_fmac_f32 v13, v35, v32
    v_fmac_f32 v14, v35, v29
    v_fmac_f32 v15, v35, v33
    v_lshlrev_b32 v26, 16, v88
    v_and_b32 v30, 0xffff0000, v88
    v_lshlrev_b32 v27, 16, v89
    v_and_b32 v31, 0xffff0000, v89
    v_lshlrev_b32 v28, 16, v90
    v_and_b32 v32, 0xffff0000, v90
    v_lshlrev_b32 v29, 16, v91
    v_and_b32 v33, 0xffff0000, v91
    v_fmac_f32 v8, v36, v26
    v_fmac_f32 v9, v36, v30
    v_fmac_f32 v10, v36, v27
    v_fmac_f32 v11, v36, v31
    v_fmac_f32 v12, v36, v28
    v_fmac_f32 v13, v36, v32
    v_fmac_f32 v14, v36, v29
    v_fmac_f32 v15, v36, v33
    v_lshlrev_b32 v26, 16, v92
    v_and_b32 v30, 0xffff0000, v92
    v_lshlrev_b32 v27, 16, v93
    v_and_b32 v31, 0xffff0000, v93
    v_lshlrev_b32 v28, 16, v94
    v_and_b32 v32, 0xffff0000, v94
    v_lshlrev_b32 v29, 16, v95
    v_and_b32 v33, 0xffff0000, v95
    v_fmac_f32 v8, v37, v26
    v_fmac_f32 v9, v37, v30
    v_fmac_f32 v10, v37, v27
    v_fmac_f32 v11, v37, v31
    v_fmac_f32 v12, v37, v28
    v_fmac_f32 v13, v37, v32
    v_fmac_f32 v14, v37, v29
    v_fmac_f32 v15, v37, v33
    buffer_load_dwordx4 v[80:83], v4, s[48:51], s8 offen offset:0 nt
    buffer_load_dwordx4 v[84:87], v4, s[48:51], s8 offen offset:1024 nt
    buffer_load_dwordx4 v[88:91], v4, s[48:51], s8 offen offset:2048 nt
    buffer_load_dwordx4 v[92:95], v4, s[48:51], s8 offen offset:3072 nt
    s_add_u32 s8, s8, 49152
    s_waitcnt vmcnt(44)
    v_dot2_f32_bf16 v22, v96, v16, 0
    v_dot2_f32_bf16 v23, v100, v16, 0
    v_dot2_f32_bf16 v24, v104, v16, 0
    v_dot2_f32_bf16 v25, v108, v16, 0
    v_dot2_f32_bf16 v22, v97, v17, v22
    v_dot2_f32_bf16 v23, v101, v17, v23
    v_dot2_f32_bf16 v24, v105, v17, v24
    v_dot2_f32_bf16 v25, v109, v17, v25
    v_dot2_f32_bf16 v22, v98, v18, v22
    v_dot2_f32_bf16 v23, v102, v18, v23
    v_dot2_f32_bf16 v24, v106, v18, v24
    v_dot2_f32_bf16 v25, v110, v18, v25
    v_dot2_f32_bf16 v22, v99, v19, v22
    v_dot2_f32_bf16 v23, v103, v19, v23
    v_dot2_f32_bf16 v24, v107, v19, v24
    v_dot2_f32_bf16 v25, v111, v19, v25
    v_add_f32_dpp v22, v22, v22 row_ror:8 row_mask:0xf bank_mask:0xf
    v_add_f32_dpp v23, v23, v23 row_ror:8 row_mask:0xf bank_mask:0xf
    v_add_f32_dpp v24, v24, v24 row_ror:8 row_mask:0xf bank_mask:0xf
    v_add_f32_dpp v25, v25, v25 row_ror:8 row_mask:0xf bank_mask:0xf
    v_add_f32_dpp v22, v22, v22 row_ror:4 row_mask:0xf bank_mask:0xf
    v_add_f32_dpp v23, v23, v23 row_ror:4 row_mask:0xf bank_mask:0xf
    v_add_f32_dpp v24, v24, v24 row_ror:4 row_mask:0xf bank_mask:0xf
    v_add_f32_dpp v25, v25, v25 row_ror:4 row_mask:0xf bank_mask:0xf
    v_add_f32_dpp v22, v22, v22 row_ror:2 row_mask:0xf bank_mask:0xf
    v_add_f32_dpp v23, v23, v23 row_ror:2 row_mask:0xf bank_mask:0xf
    v_add_f32_dpp v24, v24, v24 row_ror:2 row_mask:0xf bank_mask:0xf
    v_add_f32_dpp v25, v25, v25 row_ror:2 row_mask:0xf bank_mask:0xf
    v_add_f32_dpp v22, v22, v22 row_ror:1 row_mask:0xf bank_mask:0xf
    v_add_f32_dpp v23, v23, v23 row_ror:1 row_mask:0xf bank_mask:0xf
    v_add_f32_dpp v24, v24, v24 row_ror:1 row_mask:0xf bank_mask:0xf
    v_add_f32_dpp v25, v25, v25 row_ror:1 row_mask:0xf bank_mask:0xf
    buffer_load_dwordx4 v[96:99], v4, s[44:47], s8 offen offset:0 nt
    buffer_load_dwordx4 v[100:103], v4, s[44:47], s8 offen offset:1024 nt
    buffer_load_dwordx4 v[104:107], v4, s[44:47], s8 offen offset:2048 nt
    buffer_load_dwordx4 v[108:111], v4, s[44:47], s8 offen offset:3072 nt
    v_cvt_pk_bf16_f32 v26, v22, v23
    v_cvt_pk_bf16_f32 v27, v24, v25
    v_lshlrev_b32 v34, 16, v26
    v_and_b32 v35, 0xffff0000, v26
    v_lshlrev_b32 v36, 16, v27
    v_and_b32 v37, 0xffff0000, v27
    v_mul_f32 v34, s68, v34
    v_mul_f32 v35, s68, v35
    v_mul_f32 v36, s68, v36
    v_mul_f32 v37, s68, v37
    v_cvt_pk_bf16_f32 v26, v34, v35
    v_cvt_pk_bf16_f32 v27, v36, v37
    v_lshlrev_b32 v34, 16, v26
    v_and_b32 v35, 0xffff0000, v26
    v_lshlrev_b32 v36, 16, v27
    v_and_b32 v37, 0xffff0000, v27
    v_max3_f32 v26, v34, v35, v36
    v_max3_f32 v26, v26, v37, v20
    v_sub_f32 v27, v20, v26
    v_mul_f32 v39, s70, v26
    v_mul_f32 v27, s69, v27
    v_mov_b32 v20, v26
    v_fma_f32 v34, v34, s69, v39
    v_fma_f32 v35, v35, s69, v39
    v_fma_f32 v36, v36, s69, v39
    v_fma_f32 v37, v37, s69, v39
    v_exp_f32 v38, v27
    v_exp_f32 v34, v34
    v_exp_f32 v35, v35
    v_exp_f32 v36, v36
    v_exp_f32 v37, v37
    s_nop 0
    v_fma_f32 v21, v21, v38, v34
    v_mul_f32 v8, v38, v8
    v_mul_f32 v9, v38, v9
    v_mul_f32 v10, v38, v10
    v_mul_f32 v11, v38, v11
    v_mul_f32 v12, v38, v12
    v_mul_f32 v13, v38, v13
    v_mul_f32 v14, v38, v14
    v_mul_f32 v15, v38, v15
    v_add_f32 v26, v35, v36
    v_add_f32 v26, v26, v37
    v_add_f32 v21, v21, v26
    s_waitcnt vmcnt(44)
    v_lshlrev_b32 v26, 16, v112
    v_and_b32 v30, 0xffff0000, v112
    v_lshlrev_b32 v27, 16, v113
    v_and_b32 v31, 0xffff0000, v113
    v_lshlrev_b32 v28, 16, v114
    v_and_b32 v32, 0xffff0000, v114
    v_lshlrev_b32 v29, 16, v115
    v_and_b32 v33, 0xffff0000, v115
    v_fmac_f32 v8, v34, v26
    v_fmac_f32 v9, v34, v30
    v_fmac_f32 v10, v34, v27
    v_fmac_f32 v11, v34, v31
    v_fmac_f32 v12, v34, v28
    v_fmac_f32 v13, v34, v32
    v_fmac_f32 v14, v34, v29
    v_fmac_f32 v15, v34, v33
    v_lshlrev_b32 v26, 16, v116
    v_and_b32 v30, 0xffff0000, v116
    v_lshlrev_b32 v27, 16, v117
    v_and_b32 v31, 0xffff0000, v117
    v_lshlrev_b32 v28, 16, v118
    v_and_b32 v32, 0xffff0000, v118
    v_lshlrev_b32 v29, 16, v119
    v_and_b32 v33, 0xffff0000, v119
    v_fmac_f32 v8, v35, v26
    v_fmac_f32 v9, v35, v30
    v_fmac_f32 v10, v35, v27
    v_fmac_f32 v11, v35, v31
    v_fmac_f32 v12, v35, v28
    v_fmac_f32 v13, v35, v32
    v_fmac_f32 v14, v35, v29
    v_fmac_f32 v15, v35, v33
    v_lshlrev_b32 v26, 16, v120
    v_and_b32 v30, 0xffff0000, v120
    v_lshlrev_b32 v27, 16, v121
    v_and_b32 v31, 0xffff0000, v121
    v_lshlrev_b32 v28, 16, v122
    v_and_b32 v32, 0xffff0000, v122
    v_lshlrev_b32 v29, 16, v123
    v_and_b32 v33, 0xffff0000, v123
    v_fmac_f32 v8, v36, v26
    v_fmac_f32 v9, v36, v30
    v_fmac_f32 v10, v36, v27
    v_fmac_f32 v11, v36, v31
    v_fmac_f32 v12, v36, v28
    v_fmac_f32 v13, v36, v32
    v_fmac_f32 v14, v36, v29
    v_fmac_f32 v15, v36, v33
    v_lshlrev_b32 v26, 16, v124
    v_and_b32 v30, 0xffff0000, v124
    v_lshlrev_b32 v27, 16, v125
    v_and_b32 v31, 0xffff0000, v125
    v_lshlrev_b32 v28, 16, v126
    v_and_b32 v32, 0xffff0000, v126
    v_lshlrev_b32 v29, 16, v127
    v_and_b32 v33, 0xffff0000, v127
    v_fmac_f32 v8, v37, v26
    v_fmac_f32 v9, v37, v30
    v_fmac_f32 v10, v37, v27
    v_fmac_f32 v11, v37, v31
    v_fmac_f32 v12, v37, v28
    v_fmac_f32 v13, v37, v32
    v_fmac_f32 v14, v37, v29
    v_fmac_f32 v15, v37, v33
    buffer_load_dwordx4 v[112:115], v4, s[48:51], s8 offen offset:0 nt
    buffer_load_dwordx4 v[116:119], v4, s[48:51], s8 offen offset:1024 nt
    buffer_load_dwordx4 v[120:123], v4, s[48:51], s8 offen offset:2048 nt
    buffer_load_dwordx4 v[124:127], v4, s[48:51], s8 offen offset:3072 nt
    s_add_u32 s8, s8, 49152
    s_waitcnt vmcnt(12)
    v_dot2_f32_bf16 v22, v64, v16, 0
    v_dot2_f32_bf16 v23, v68, v16, 0
    v_dot2_f32_bf16 v24, v72, v16, 0
    v_dot2_f32_bf16 v25, v76, v16, 0
    v_dot2_f32_bf16 v22, v65, v17, v22
    v_dot2_f32_bf16 v23, v69, v17, v23
    v_dot2_f32_bf16 v24, v73, v17, v24
    v_dot2_f32_bf16 v25, v77, v17, v25
    v_dot2_f32_bf16 v22, v66, v18, v22
    v_dot2_f32_bf16 v23, v70, v18, v23
    v_dot2_f32_bf16 v24, v74, v18, v24
    v_dot2_f32_bf16 v25, v78, v18, v25
    v_dot2_f32_bf16 v22, v67, v19, v22
    v_dot2_f32_bf16 v23, v71, v19, v23
    v_dot2_f32_bf16 v24, v75, v19, v24
    v_dot2_f32_bf16 v25, v79, v19, v25
    v_add_f32_dpp v22, v22, v22 row_ror:8 row_mask:0xf bank_mask:0xf
    v_add_f32_dpp v23, v23, v23 row_ror:8 row_mask:0xf bank_mask:0xf
    v_add_f32_dpp v24, v24, v24 row_ror:8 row_mask:0xf bank_mask:0xf
    v_add_f32_dpp v25, v25, v25 row_ror:8 row_mask:0xf bank_mask:0xf
    v_add_f32_dpp v22, v22, v22 row_ror:4 row_mask:0xf bank_mask:0xf
    v_add_f32_dpp v23, v23, v23 row_ror:4 row_mask:0xf bank_mask:0xf
    v_add_f32_dpp v24, v24, v24 row_ror:4 row_mask:0xf bank_mask:0xf
    v_add_f32_dpp v25, v25, v25 row_ror:4 row_mask:0xf bank_mask:0xf
    v_add_f32_dpp v22, v22, v22 row_ror:2 row_mask:0xf bank_mask:0xf
    v_add_f32_dpp v23, v23, v23 row_ror:2 row_mask:0xf bank_mask:0xf
    v_add_f32_dpp v24, v24, v24 row_ror:2 row_mask:0xf bank_mask:0xf
    v_add_f32_dpp v25, v25, v25 row_ror:2 row_mask:0xf bank_mask:0xf
    v_add_f32_dpp v22, v22, v22 row_ror:1 row_mask:0xf bank_mask:0xf
    v_add_f32_dpp v23, v23, v23 row_ror:1 row_mask:0xf bank_mask:0xf
    v_add_f32_dpp v24, v24, v24 row_ror:1 row_mask:0xf bank_mask:0xf
    v_add_f32_dpp v25, v25, v25 row_ror:1 row_mask:0xf bank_mask:0xf
    buffer_load_dwordx4 v[64:67], v4, s[44:47], s8 offen offset:0 nt
    buffer_load_dwordx4 v[68:71], v4, s[44:47], s8 offen offset:1024 nt
    buffer_load_dwordx4 v[72:75], v4, s[44:47], s8 offen offset:2048 nt
    buffer_load_dwordx4 v[76:79], v4, s[44:47], s8 offen offset:3072 nt
    v_cvt_pk_bf16_f32 v26, v22, v23
    v_cvt_pk_bf16_f32 v27, v24, v25
    v_lshlrev_b32 v34, 16, v26
    v_and_b32 v35, 0xffff0000, v26
    v_lshlrev_b32 v36, 16, v27
    v_and_b32 v37, 0xffff0000, v27
    v_mul_f32 v34, s68, v34
    v_mul_f32 v35, s68, v35
    v_mul_f32 v36, s68, v36
    v_mul_f32 v37, s68, v37
    v_cvt_pk_bf16_f32 v26, v34, v35
    v_cvt_pk_bf16_f32 v27, v36, v37
    v_lshlrev_b32 v34, 16, v26
    v_and_b32 v35, 0xffff0000, v26
    v_lshlrev_b32 v36, 16, v27
    v_and_b32 v37, 0xffff0000, v27
    v_max3_f32 v26, v34, v35, v36
    v_max3_f32 v26, v26, v37, v20
    v_sub_f32 v27, v20, v26
    v_mul_f32 v39, s70, v26
    v_mul_f32 v27, s69, v27
    v_mov_b32 v20, v26
    v_fma_f32 v34, v34, s69, v39
    v_fma_f32 v35, v35, s69, v39
    v_fma_f32 v36, v36, s69, v39
    v_fma_f32 v37, v37, s69, v39
    v_exp_f32 v38, v27
    v_exp_f32 v34, v34
    v_exp_f32 v35, v35
    v_exp_f32 v36, v36
    v_exp_f32 v37, v37
    s_nop 0
    v_fma_f32 v21, v21, v38, v34
    v_mul_f32 v8, v38, v8
    v_mul_f32 v9, v38, v9
    v_mul_f32 v10, v38, v10
    v_mul_f32 v11, v38, v11
    v_mul_f32 v12, v38, v12
    v_mul_f32 v13, v38, v13
    v_mul_f32 v14, v38, v14
    v_mul_f32 v15, v38, v15
    v_add_f32 v26, v35, v36
    v_add_f32 v26, v26, v37
    v_add_f32 v21, v21, v26
    s_waitcnt vmcnt(12)
    v_lshlrev_b32 v26, 16, v80
    v_and_b32 v30, 0xffff0000, v80
    v_lshlrev_b32 v27, 16, v81
    v_and_b32 v31, 0xffff0000, v81
    v_lshlrev_b32 v28, 16, v82
    v_and_b32 v32, 0xffff0000, v82
    v_lshlrev_b32 v29, 16, v83
    v_and_b32 v33, 0xffff0000, v83
    v_fmac_f32 v8, v34, v26
    v_fmac_f32 v9, v34, v30
    v_fmac_f32 v10, v34, v27
    v_fmac_f32 v11, v34, v31
    v_fmac_f32 v12, v34, v28
    v_fmac_f32 v13, v34, v32
    v_fmac_f32 v14, v34, v29
    v_fmac_f32 v15, v34, v33
    v_lshlrev_b32 v26, 16, v84
    v_and_b32 v30, 0xffff0000, v84
    v_lshlrev_b32 v27, 16, v85
    v_and_b32 v31, 0xffff0000, v85
    v_lshlrev_b32 v28, 16, v86
    v_and_b32 v32, 0xffff0000, v86
    v_lshlrev_b32 v29, 16, v87
    v_and_b32 v33, 0xffff0000, v87
    v_fmac_f32 v8, v35, v26
    v_fmac_f32 v9, v35, v30
    v_fmac_f32 v10, v35, v27
    v_fmac_f32 v11, v35, v31
    v_fmac_f32 v12, v35, v28
    v_fmac_f32 v13, v35, v32
    v_fmac_f32 v14, v35, v29
    v_fmac_f32 v15, v35, v33
    v_lshlrev_b32 v26, 16, v88
    v_and_b32 v30, 0xffff0000, v88
    v_lshlrev_b32 v27, 16, v89
    v_and_b32 v31, 0xffff0000, v89
    v_lshlrev_b32 v28, 16, v90
    v_and_b32 v32, 0xffff0000, v90
    v_lshlrev_b32 v29, 16, v91
    v_and_b32 v33, 0xffff0000, v91
    v_fmac_f32 v8, v36, v26
    v_fmac_f32 v9, v36, v30
    v_fmac_f32 v10, v36, v27
    v_fmac_f32 v11, v36, v31
    v_fmac_f32 v12, v36, v28
    v_fmac_f32 v13, v36, v32
    v_fmac_f32 v14, v36, v29
    v_fmac_f32 v15, v36, v33
    v_lshlrev_b32 v26, 16, v92
    v_and_b32 v30, 0xffff0000, v92
    v_lshlrev_b32 v27, 16, v93
    v_and_b32 v31, 0xffff0000, v93
    v_lshlrev_b32 v28, 16, v94
    v_and_b32 v32, 0xffff0000, v94
    v_lshlrev_b32 v29, 16, v95
    v_and_b32 v33, 0xffff0000, v95
    v_fmac_f32 v8, v37, v26
    v_fmac_f32 v9, v37, v30
    v_fmac_f32 v10, v37, v27
    v_fmac_f32 v11, v37, v31
    v_fmac_f32 v12, v37, v28
    v_fmac_f32 v13, v37, v32
    v_fmac_f32 v14, v37, v29
    v_fmac_f32 v15, v37, v33
    buffer_load_dwordx4 v[80:83], v4, s[48:51], s8 offen offset:0 nt
    buffer_load_dwordx4 v[84:87], v4, s[48:51], s8 offen offset:1024 nt
    buffer_load_dwordx4 v[88:91], v4, s[48:51], s8 offen offset:2048 nt
    buffer_load_dwordx4 v[92:95], v4, s[48:51], s8 offen offset:3072 nt
    s_add_u32 s8, s8, 49152
    s_waitcnt vmcnt(12)
    v_dot2_f32_bf16 v22, v96, v16, 0
    v_dot2_f32_bf16 v23, v100, v16, 0
    v_dot2_f32_bf16 v24, v104, v16, 0
    v_dot2_f32_bf16 v25, v108, v16, 0
    v_dot2_f32_bf16 v22, v97, v17, v22
    v_dot2_f32_bf16 v23, v101, v17, v23
    v_dot2_f32_bf16 v24, v105, v17, v24
    v_dot2_f32_bf16 v25, v109, v17, v25
    v_dot2_f32_bf16 v22, v98, v18, v22
    v_dot2_f32_bf16 v23, v102, v18, v23
    v_dot2_f32_bf16 v24, v106, v18, v24
    v_dot2_f32_bf16 v25, v110, v18, v25
    v_dot2_f32_bf16 v22, v99, v19, v22
    v_dot2_f32_bf16 v23, v103, v19, v23
    v_dot2_f32_bf16 v24, v107, v19, v24
    v_dot2_f32_bf16 v25, v111, v19, v25
    v_add_f32_dpp v22, v22, v22 row_ror:8 row_mask:0xf bank_mask:0xf
    v_add_f32_dpp v23, v23, v23 row_ror:8 row_mask:0xf bank_mask:0xf
    v_add_f32_dpp v24, v24, v24 row_ror:8 row_mask:0xf bank_mask:0xf
    v_add_f32_dpp v25, v25, v25 row_ror:8 row_mask:0xf bank_mask:0xf
    v_add_f32_dpp v22, v22, v22 row_ror:4 row_mask:0xf bank_mask:0xf
    v_add_f32_dpp v23, v23, v23 row_ror:4 row_mask:0xf bank_mask:0xf
    v_add_f32_dpp v24, v24, v24 row_ror:4 row_mask:0xf bank_mask:0xf
    v_add_f32_dpp v25, v25, v25 row_ror:4 row_mask:0xf bank_mask:0xf
    v_add_f32_dpp v22, v22, v22 row_ror:2 row_mask:0xf bank_mask:0xf
    v_add_f32_dpp v23, v23, v23 row_ror:2 row_mask:0xf bank_mask:0xf
    v_add_f32_dpp v24, v24, v24 row_ror:2 row_mask:0xf bank_mask:0xf
    v_add_f32_dpp v25, v25, v25 row_ror:2 row_mask:0xf bank_mask:0xf
    v_add_f32_dpp v22, v22, v22 row_ror:1 row_mask:0xf bank_mask:0xf
    v_add_f32_dpp v23, v23, v23 row_ror:1 row_mask:0xf bank_mask:0xf
    v_add_f32_dpp v24, v24, v24 row_ror:1 row_mask:0xf bank_mask:0xf
    v_add_f32_dpp v25, v25, v25 row_ror:1 row_mask:0xf bank_mask:0xf
    s_add_u32 s8, s8, s73
    buffer_load_dwordx4 v[96:99], v4, s[44:47], s8 offen offset:0 nt
    buffer_load_dwordx4 v[100:103], v4, s[44:47], s8 offen offset:1024 nt
    buffer_load_dwordx4 v[104:107], v4, s[44:47], s8 offen offset:2048 nt
    buffer_load_dwordx4 v[108:111], v4, s[44:47], s8 offen offset:3072 nt
    v_cvt_pk_bf16_f32 v26, v22, v23
    v_cvt_pk_bf16_f32 v27, v24, v25
    v_lshlrev_b32 v34, 16, v26
    v_and_b32 v35, 0xffff0000, v26
    v_lshlrev_b32 v36, 16, v27
    v_and_b32 v37, 0xffff0000, v27
    v_mul_f32 v34, s68, v34
    v_mul_f32 v35, s68, v35
    v_mul_f32 v36, s68, v36
    v_mul_f32 v37, s68, v37
    v_cvt_pk_bf16_f32 v26, v34, v35
    v_cvt_pk_bf16_f32 v27, v36, v37
    v_lshlrev_b32 v34, 16, v26
    v_and_b32 v35, 0xffff0000, v26
    v_lshlrev_b32 v36, 16, v27
    v_and_b32 v37, 0xffff0000, v27
    v_max3_f32 v26, v34, v35, v36
    v_max3_f32 v26, v26, v37, v20
    v_sub_f32 v27, v20, v26
    v_mul_f32 v39, s70, v26
    v_mul_f32 v27, s69, v27
    v_mov_b32 v20, v26
    v_fma_f32 v34, v34, s69, v39
    v_fma_f32 v35, v35, s69, v39
    v_fma_f32 v36, v36, s69, v39
    v_fma_f32 v37, v37, s69, v39
    v_exp_f32 v38, v27
    v_exp_f32 v34, v34
    v_exp_f32 v35, v35
    v_exp_f32 v36, v36
    v_exp_f32 v37, v37
    s_nop 0
    v_fma_f32 v21, v21, v38, v34
    v_mul_f32 v8, v38, v8
    v_mul_f32 v9, v38, v9
    v_mul_f32 v10, v38, v10
    v_mul_f32 v11, v38, v11
    v_mul_f32 v12, v38, v12
    v_mul_f32 v13, v38, v13
    v_mul_f32 v14, v38, v14
    v_mul_f32 v15, v38, v15
    v_add_f32 v26, v35, v36
    v_add_f32 v26, v26, v37
    v_add_f32 v21, v21, v26
    s_waitcnt vmcnt(12)
    v_lshlrev_b32 v26, 16, v112
    v_and_b32 v30, 0xffff0000, v112
    v_lshlrev_b32 v27, 16, v113
    v_and_b32 v31, 0xffff0000, v113
    v_lshlrev_b32 v28, 16, v114
    v_and_b32 v32, 0xffff0000, v114
    v_lshlrev_b32 v29, 16, v115
    v_and_b32 v33, 0xffff0000, v115
    v_fmac_f32 v8, v34, v26
    v_fmac_f32 v9, v34, v30
    v_fmac_f32 v10, v34, v27
    v_fmac_f32 v11, v34, v31
    v_fmac_f32 v12, v34, v28
    v_fmac_f32 v13, v34, v32
    v_fmac_f32 v14, v34, v29
    v_fmac_f32 v15, v34, v33
    v_lshlrev_b32 v26, 16, v116
    v_and_b32 v30, 0xffff0000, v116
    v_lshlrev_b32 v27, 16, v117
    v_and_b32 v31, 0xffff0000, v117
    v_lshlrev_b32 v28, 16, v118
    v_and_b32 v32, 0xffff0000, v118
    v_lshlrev_b32 v29, 16, v119
    v_and_b32 v33, 0xffff0000, v119
    v_fmac_f32 v8, v35, v26
    v_fmac_f32 v9, v35, v30
    v_fmac_f32 v10, v35, v27
    v_fmac_f32 v11, v35, v31
    v_fmac_f32 v12, v35, v28
    v_fmac_f32 v13, v35, v32
    v_fmac_f32 v14, v35, v29
    v_fmac_f32 v15, v35, v33
    v_lshlrev_b32 v26, 16, v120
    v_and_b32 v30, 0xffff0000, v120
    v_lshlrev_b32 v27, 16, v121
    v_and_b32 v31, 0xffff0000, v121
    v_lshlrev_b32 v28, 16, v122
    v_and_b32 v32, 0xffff0000, v122
    v_lshlrev_b32 v29, 16, v123
    v_and_b32 v33, 0xffff0000, v123
    v_fmac_f32 v8, v36, v26
    v_fmac_f32 v9, v36, v30
    v_fmac_f32 v10, v36, v27
    v_fmac_f32 v11, v36, v31
    v_fmac_f32 v12, v36, v28
    v_fmac_f32 v13, v36, v32
    v_fmac_f32 v14, v36, v29
    v_fmac_f32 v15, v36, v33
    v_lshlrev_b32 v26, 16, v124
    v_and_b32 v30, 0xffff0000, v124
    v_lshlrev_b32 v27, 16, v125
    v_and_b32 v31, 0xffff0000, v125
    v_lshlrev_b32 v28, 16, v126
    v_and_b32 v32, 0xffff0000, v126
    v_lshlrev_b32 v29, 16, v127
    v_and_b32 v33, 0xffff0000, v127
    v_fmac_f32 v8, v37, v26
    v_fmac_f32 v9, v37, v30
    v_fmac_f32 v10, v37, v27
    v_fmac_f32 v11, v37, v31
    v_fmac_f32 v12, v37, v28
    v_fmac_f32 v13, v37, v32
    v_fmac_f32 v14, v37, v29
    v_fmac_f32 v15, v37, v33
    buffer_load_dwordx4 v[112:115], v4, s[48:51], s8 offen offset:0 nt
    buffer_load_dwordx4 v[116:119], v4, s[48:51], s8 offen offset:1024 nt
    buffer_load_dwordx4 v[120:123], v4, s[48:51], s8 offen offset:2048 nt
    buffer_load_dwordx4 v[124:127], v4, s[48:51], s8 offen offset:3072 nt
    s_add_u32 s8, s8, 49152
    s_waitcnt vmcnt(12)
    v_dot2_f32_bf16 v22, v64, v16, 0
    v_dot2_f32_bf16 v23, v68, v16, 0
    v_dot2_f32_bf16 v24, v72, v16, 0
    v_dot2_f32_bf16 v25, v76, v16, 0
    v_dot2_f32_bf16 v22, v65, v17, v22
    v_dot2_f32_bf16 v23, v69, v17, v23
    v_dot2_f32_bf16 v24, v73, v17, v24
    v_dot2_f32_bf16 v25, v77, v17, v25
    v_dot2_f32_bf16 v22, v66, v18, v22
    v_dot2_f32_bf16 v23, v70, v18, v23
    v_dot2_f32_bf16 v24, v74, v18, v24
    v_dot2_f32_bf16 v25, v78, v18, v25
    v_dot2_f32_bf16 v22, v67, v19, v22
    v_dot2_f32_bf16 v23, v71, v19, v23
    v_dot2_f32_bf16 v24, v75, v19, v24
    v_dot2_f32_bf16 v25, v79, v19, v25
    v_add_f32_dpp v22, v22, v22 row_ror:8 row_mask:0xf bank_mask:0xf
    v_add_f32_dpp v23, v23, v23 row_ror:8 row_mask:0xf bank_mask:0xf
    v_add_f32_dpp v24, v24, v24 row_ror:8 row_mask:0xf bank_mask:0xf
    v_add_f32_dpp v25, v25, v25 row_ror:8 row_mask:0xf bank_mask:0xf
    v_add_f32_dpp v22, v22, v22 row_ror:4 row_mask:0xf bank_mask:0xf
    v_add_f32_dpp v23, v23, v23 row_ror:4 row_mask:0xf bank_mask:0xf
    v_add_f32_dpp v24, v24, v24 row_ror:4 row_mask:0xf bank_mask:0xf
    v_add_f32_dpp v25, v25, v25 row_ror:4 row_mask:0xf bank_mask:0xf
    v_add_f32_dpp v22, v22, v22 row_ror:2 row_mask:0xf bank_mask:0xf
    v_add_f32_dpp v23, v23, v23 row_ror:2 row_mask:0xf bank_mask:0xf
    v_add_f32_dpp v24, v24, v24 row_ror:2 row_mask:0xf bank_mask:0xf
    v_add_f32_dpp v25, v25, v25 row_ror:2 row_mask:0xf bank_mask:0xf
    v_add_f32_dpp v22, v22, v22 row_ror:1 row_mask:0xf bank_mask:0xf
    v_add_f32_dpp v23, v23, v23 row_ror:1 row_mask:0xf bank_mask:0xf
    v_add_f32_dpp v24, v24, v24 row_ror:1 row_mask:0xf bank_mask:0xf
    v_add_f32_dpp v25, v25, v25 row_ror:1 row_mask:0xf bank_mask:0xf
    v_cvt_pk_bf16_f32 v26, v22, v23
    v_cvt_pk_bf16_f32 v27, v24, v25
    v_lshlrev_b32 v34, 16, v26
    v_and_b32 v35, 0xffff0000, v26
    v_lshlrev_b32 v36, 16, v27
    v_and_b32 v37, 0xffff0000, v27
    v_mul_f32 v34, s68, v34
    v_mul_f32 v35, s68, v35
    v_mul_f32 v36, s68, v36
    v_mul_f32 v37, s68, v37
    v_cvt_pk_bf16_f32 v26, v34, v35
    v_cvt_pk_bf16_f32 v27, v36, v37
    v_lshlrev_b32 v34, 16, v26
    v_and_b32 v35, 0xffff0000, v26
    v_lshlrev_b32 v36, 16, v27
    v_and_b32 v37, 0xffff0000, v27
    v_max3_f32 v26, v34, v35, v36
    v_max3_f32 v26, v26, v37, v20
    v_sub_f32 v27, v20, v26
    v_mul_f32 v39, s70, v26
    v_mul_f32 v27, s69, v27
    v_mov_b32 v20, v26
    v_fma_f32 v34, v34, s69, v39
    v_fma_f32 v35, v35, s69, v39
    v_fma_f32 v36, v36, s69, v39
    v_fma_f32 v37, v37, s69, v39
    v_exp_f32 v38, v27
    v_exp_f32 v34, v34
    v_exp_f32 v35, v35
    v_exp_f32 v36, v36
    v_exp_f32 v37, v37
    s_nop 0
    v_fma_f32 v21, v21, v38, v34
    v_mul_f32 v8, v38, v8
    v_mul_f32 v9, v38, v9
    v_mul_f32 v10, v38, v10
    v_mul_f32 v11, v38, v11
    v_mul_f32 v12, v38, v12
    v_mul_f32 v13, v38, v13
    v_mul_f32 v14, v38, v14
    v_mul_f32 v15, v38, v15
    v_add_f32 v26, v35, v36
    v_add_f32 v26, v26, v37
    v_add_f32 v21, v21, v26
    s_waitcnt vmcnt(8)
    v_lshlrev_b32 v26, 16, v80
    v_and_b32 v30, 0xffff0000, v80
    v_lshlrev_b32 v27, 16, v81
    v_and_b32 v31, 0xffff0000, v81
    v_lshlrev_b32 v28, 16, v82
    v_and_b32 v32, 0xffff0000, v82
    v_lshlrev_b32 v29, 16, v83
    v_and_b32 v33, 0xffff0000, v83
    v_fmac_f32 v8, v34, v26
    v_fmac_f32 v9, v34, v30
    v_fmac_f32 v10, v34, v27
    v_fmac_f32 v11, v34, v31
    v_fmac_f32 v12, v34, v28
    v_fmac_f32 v13, v34, v32
    v_fmac_f32 v14, v34, v29
    v_fmac_f32 v15, v34, v33
    v_lshlrev_b32 v26, 16, v84
    v_and_b32 v30, 0xffff0000, v84
    v_lshlrev_b32 v27, 16, v85
    v_and_b32 v31, 0xffff0000, v85
    v_lshlrev_b32 v28, 16, v86
    v_and_b32 v32, 0xffff0000, v86
    v_lshlrev_b32 v29, 16, v87
    v_and_b32 v33, 0xffff0000, v87
    v_fmac_f32 v8, v35, v26
    v_fmac_f32 v9, v35, v30
    v_fmac_f32 v10, v35, v27
    v_fmac_f32 v11, v35, v31
    v_fmac_f32 v12, v35, v28
    v_fmac_f32 v13, v35, v32
    v_fmac_f32 v14, v35, v29
    v_fmac_f32 v15, v35, v33
    v_lshlrev_b32 v26, 16, v88
    v_and_b32 v30, 0xffff0000, v88
    v_lshlrev_b32 v27, 16, v89
    v_and_b32 v31, 0xffff0000, v89
    v_lshlrev_b32 v28, 16, v90
    v_and_b32 v32, 0xffff0000, v90
    v_lshlrev_b32 v29, 16, v91
    v_and_b32 v33, 0xffff0000, v91
    v_fmac_f32 v8, v36, v26
    v_fmac_f32 v9, v36, v30
    v_fmac_f32 v10, v36, v27
    v_fmac_f32 v11, v36, v31
    v_fmac_f32 v12, v36, v28
    v_fmac_f32 v13, v36, v32
    v_fmac_f32 v14, v36, v29
    v_fmac_f32 v15, v36, v33
    v_lshlrev_b32 v26, 16, v92
    v_and_b32 v30, 0xffff0000, v92
    v_lshlrev_b32 v27, 16, v93
    v_and_b32 v31, 0xffff0000, v93
    v_lshlrev_b32 v28, 16, v94
    v_and_b32 v32, 0xffff0000, v94
    v_lshlrev_b32 v29, 16, v95
    v_and_b32 v33, 0xffff0000, v95
    v_fmac_f32 v8, v37, v26
    v_fmac_f32 v9, v37, v30
    v_fmac_f32 v10, v37, v27
    v_fmac_f32 v11, v37, v31
    v_fmac_f32 v12, v37, v28
    v_fmac_f32 v13, v37, v32
    v_fmac_f32 v14, v37, v29
    v_fmac_f32 v15, v37, v33
    s_cmp_eq_u32 s6, 0
    s_cbranch_scc0 A_skip_last
    s_waitcnt vmcnt(4)
    v_dot2_f32_bf16 v22, v96, v16, 0
    v_dot2_f32_bf16 v23, v100, v16, 0
    v_dot2_f32_bf16 v24, v104, v16, 0
    v_dot2_f32_bf16 v25, v108, v16, 0
    v_dot2_f32_bf16 v22, v97, v17, v22
    v_dot2_f32_bf16 v23, v101, v17, v23
    v_dot2_f32_bf16 v24, v105, v17, v24
    v_dot2_f32_bf16 v25, v109, v17, v25
    v_dot2_f32_bf16 v22, v98, v18, v22
    v_dot2_f32_bf16 v23, v102, v18, v23
    v_dot2_f32_bf16 v24, v106, v18, v24
    v_dot2_f32_bf16 v25, v110, v18, v25
    v_dot2_f32_bf16 v22, v99, v19, v22
    v_dot2_f32_bf16 v23, v103, v19, v23
    v_dot2_f32_bf16 v24, v107, v19, v24
    v_dot2_f32_bf16 v25, v111, v19, v25
    v_add_f32_dpp v22, v22, v22 row_ror:8 row_mask:0xf bank_mask:0xf
    v_add_f32_dpp v23, v23, v23 row_ror:8 row_mask:0xf bank_mask:0xf
    v_add_f32_dpp v24, v24, v24 row_ror:8 row_mask:0xf bank_mask:0xf
    v_add_f32_dpp v25, v25, v25 row_ror:8 row_mask:0xf bank_mask:0xf
    v_add_f32_dpp v22, v22, v22 row_ror:4 row_mask:0xf bank_mask:0xf
    v_add_f32_dpp v23, v23, v23 row_ror:4 row_mask:0xf bank_mask:0xf
    v_add_f32_dpp v24, v24, v24 row_ror:4 row_mask:0xf bank_mask:0xf
    v_add_f32_dpp v25, v25, v25 row_ror:4 row_mask:0xf bank_mask:0xf
    v_add_f32_dpp v22, v22, v22 row_ror:2 row_mask:0xf bank_mask:0xf
    v_add_f32_dpp v23, v23, v23 row_ror:2 row_mask:0xf bank_mask:0xf
    v_add_f32_dpp v24, v24, v24 row_ror:2 row_mask:0xf bank_mask:0xf
    v_add_f32_dpp v25, v25, v25 row_ror:2 row_mask:0xf bank_mask:0xf
    v_add_f32_dpp v22, v22, v22 row_ror:1 row_mask:0xf bank_mask:0xf
    v_add_f32_dpp v23, v23, v23 row_ror:1 row_mask:0xf bank_mask:0xf
    v_add_f32_dpp v24, v24, v24 row_ror:1 row_mask:0xf bank_mask:0xf
    v_add_f32_dpp v25, v25, v25 row_ror:1 row_mask:0xf bank_mask:0xf
    v_cvt_pk_bf16_f32 v26, v22, v23
    v_cvt_pk_bf16_f32 v27, v24, v25
    v_lshlrev_b32 v34, 16, v26
    v_and_b32 v35, 0xffff0000, v26
    v_lshlrev_b32 v36, 16, v27
    v_and_b32 v37, 0xffff0000, v27
    v_mul_f32 v34, s68, v34
    v_mul_f32 v35, s68, v35
    v_mul_f32 v36, s68, v36
    v_mul_f32 v37, s68, v37
    v_cvt_pk_bf16_f32 v26, v34, v35
    v_cvt_pk_bf16_f32 v27, v36, v37
    v_lshlrev_b32 v34, 16, v26
    v_and_b32 v35, 0xffff0000, v26
    v_lshlrev_b32 v36, 16, v27
    v_and_b32 v37, 0xffff0000, v27
    v_max3_f32 v26, v34, v35, v36
    v_max3_f32 v26, v26, v37, v20
    v_sub_f32 v27, v20, v26
    v_mul_f32 v39, s70, v26
    v_mul_f32 v27, s69, v27
    v_mov_b32 v20, v26
    v_fma_f32 v34, v34, s69, v39
    v_fma_f32 v35, v35, s69, v39
    v_fma_f32 v36, v36, s69, v39
    v_fma_f32 v37, v37, s69, v39
    v_exp_f32 v38, v27
    v_exp_f32 v34, v34
    v_exp_f32 v35, v35
    v_exp_f32 v36, v36
    v_exp_f32 v37, v37
    s_nop 0
    v_fma_f32 v21, v21, v38, v34
    v_mul_f32 v8, v38, v8
    v_mul_f32 v9, v38, v9
    v_mul_f32 v10, v38, v10
    v_mul_f32 v11, v38, v11
    v_mul_f32 v12, v38, v12
    v_mul_f32 v13, v38, v13
    v_mul_f32 v14, v38, v14
    v_mul_f32 v15, v38, v15
    v_add_f32 v26, v35, v36
    v_add_f32 v26, v26, v37
    v_add_f32 v21, v21, v26
    s_waitcnt vmcnt(0)
    v_lshlrev_b32 v26, 16, v112
    v_and_b32 v30, 0xffff0000, v112
    v_lshlrev_b32 v27, 16, v113
    v_and_b32 v31, 0xffff0000, v113
    v_lshlrev_b32 v28, 16, v114
    v_and_b32 v32, 0xffff0000, v114
    v_lshlrev_b32 v29, 16, v115
    v_and_b32 v33, 0xffff0000, v115
    v_fmac_f32 v8, v34, v26
    v_fmac_f32 v9, v34, v30
    v_fmac_f32 v10, v34, v27
    v_fmac_f32 v11, v34, v31
    v_fmac_f32 v12, v34, v28
    v_fmac_f32 v13, v34, v32
    v_fmac_f32 v14, v34, v29
    v_fmac_f32 v15, v34, v33
    v_lshlrev_b32 v26, 16, v116
    v_and_b32 v30, 0xffff0000, v116
    v_lshlrev_b32 v27, 16, v117
    v_and_b32 v31, 0xffff0000, v117
    v_lshlrev_b32 v28, 16, v118
    v_and_b32 v32, 0xffff0000, v118
    v_lshlrev_b32 v29, 16, v119
    v_and_b32 v33, 0xffff0000, v119
    v_fmac_f32 v8, v35, v26
    v_fmac_f32 v9, v35, v30
    v_fmac_f32 v10, v35, v27
    v_fmac_f32 v11, v35, v31
    v_fmac_f32 v12, v35, v28
    v_fmac_f32 v13, v35, v32
    v_fmac_f32 v14, v35, v29
    v_fmac_f32 v15, v35, v33
    v_lshlrev_b32 v26, 16, v120
    v_and_b32 v30, 0xffff0000, v120
    v_lshlrev_b32 v27, 16, v121
    v_and_b32 v31, 0xffff0000, v121
    v_lshlrev_b32 v28, 16, v122
    v_and_b32 v32, 0xffff0000, v122
    v_lshlrev_b32 v29, 16, v123
    v_and_b32 v33, 0xffff0000, v123
    v_fmac_f32 v8, v36, v26
    v_fmac_f32 v9, v36, v30
    v_fmac_f32 v10, v36, v27
    v_fmac_f32 v11, v36, v31
    v_fmac_f32 v12, v36, v28
    v_fmac_f32 v13, v36, v32
    v_fmac_f32 v14, v36, v29
    v_fmac_f32 v15, v36, v33
    v_lshlrev_b32 v26, 16, v124
    v_and_b32 v30, 0xffff0000, v124
    v_lshlrev_b32 v27, 16, v125
    v_and_b32 v31, 0xffff0000, v125
    v_lshlrev_b32 v28, 16, v126
    v_and_b32 v32, 0xffff0000, v126
    v_lshlrev_b32 v29, 16, v127
    v_and_b32 v33, 0xffff0000, v127
    v_fmac_f32 v8, v37, v26
    v_fmac_f32 v9, v37, v30
    v_fmac_f32 v10, v37, v27
    v_fmac_f32 v11, v37, v31
    v_fmac_f32 v12, v37, v28
    v_fmac_f32 v13, v37, v32
    v_fmac_f32 v14, v37, v29
    v_fmac_f32 v15, v37, v33
A_skip_last:
    ds_write_b32 v7, v20 offset:8704
    ds_write_b32 v7, v21 offset:8768
    v_lshlrev_b32 v26, 7, v7
    v_lshl_add_u32 v26, v3, 5, v26
    ds_write_b128 v26, v[8:11] offset:12288
    ds_write_b128 v26, v[12:15] offset:12304
    s_waitcnt lgkmcnt(0)
    s_barrier
    v_mov_b32 v26, 0
    ds_read_b128 v[64:67], v26 offset:8704
    ds_read_b128 v[80:83], v26 offset:8768
    ds_read_b128 v[68:71], v26 offset:8720
    ds_read_b128 v[84:87], v26 offset:8784
    ds_read_b128 v[72:75], v26 offset:8736
    ds_read_b128 v[88:91], v26 offset:8800
    ds_read_b128 v[76:79], v26 offset:8752
    ds_read_b128 v[92:95], v26 offset:8816
    v_and_b32 v27, 31, v1
    s_lshl_b32 s11, s7, 5
    v_add_u32 v27, s11, v27
    v_lshlrev_b32 v27, 2, v27
    ds_read_b32 v96, v27 offset:12288
    ds_read_b32 v97, v27 offset:12800
    ds_read_b32 v98, v27 offset:13312
    ds_read_b32 v99, v27 offset:13824
    ds_read_b32 v100, v27 offset:14336
    ds_read_b32 v101, v27 offset:14848
    ds_read_b32 v102, v27 offset:15360
    ds_read_b32 v103, v27 offset:15872
    ds_read_b32 v104, v27 offset:16384
    ds_read_b32 v105, v27 offset:16896
    ds_read_b32 v106, v27 offset:17408
    ds_read_b32 v107, v27 offset:17920
    ds_read_b32 v108, v27 offset:18432
    ds_read_b32 v109, v27 offset:18944
    ds_read_b32 v110, v27 offset:19456
    ds_read_b32 v111, v27 offset:19968
    s_waitcnt lgkmcnt(0)
    v_max3_f32 v112, v64, v65, v66
    v_max3_f32 v112, v112, v67, v68
    v_max3_f32 v112, v112, v69, v70
    v_max3_f32 v112, v112, v71, v72
    v_max3_f32 v112, v112, v73, v74
    v_max3_f32 v112, v112, v75, v76
    v_max3_f32 v112, v112, v77, v78
    v_max_f32 v112, v112, v79
    v_mul_f32 v39, s70, v112
    v_fma_f32 v64, v64, s69, v39
    v_fma_f32 v65, v65, s69, v39
    v_fma_f32 v66, v66, s69, v39
    v_fma_f32 v67, v67, s69, v39
    v_fma_f32 v68, v68, s69, v39
    v_fma_f32 v69, v69, s69, v39
    v_fma_f32 v70, v70, s69, v39
    v_fma_f32 v71, v71, s69, v39
    v_fma_f32 v72, v72, s69, v39
    v_fma_f32 v73, v73, s69, v39
    v_fma_f32 v74, v74, s69, v39
    v_fma_f32 v75, v75, s69, v39
    v_fma_f32 v76, v76, s69, v39
    v_fma_f32 v77, v77, s69, v39
    v_fma_f32 v78, v78, s69, v39
    v_fma_f32 v79, v79, s69, v39
    v_exp_f32 v64, v64
    v_exp_f32 v65, v65
    v_exp_f32 v66, v66
    v_exp_f32 v67, v67
    v_exp_f32 v68, v68
    v_exp_f32 v69, v69
    v_exp_f32 v70, v70
    v_exp_f32 v71, v71
    v_exp_f32 v72, v72
    v_exp_f32 v73, v73
    v_exp_f32 v74, v74
    v_exp_f32 v75, v75
    v_exp_f32 v76, v76
    v_exp_f32 v77, v77
    v_exp_f32 v78, v78
    v_exp_f32 v79, v79
    s_nop 0
    v_mul_f32 v113, v64, v80
    v_mul_f32 v58, v64, v96
    v_fmac_f32 v113, v65, v81
    v_fmac_f32 v58, v65, v97
    v_fmac_f32 v113, v66, v82
    v_fmac_f32 v58, v66, v98
    v_fmac_f32 v113, v67, v83
    v_fmac_f32 v58, v67, v99
    v_fmac_f32 v113, v68, v84
    v_fmac_f32 v58, v68, v100
    v_fmac_f32 v113, v69, v85
    v_fmac_f32 v58, v69, v101
    v_fmac_f32 v113, v70, v86
    v_fmac_f32 v58, v70, v102
    v_fmac_f32 v113, v71, v87
    v_fmac_f32 v58, v71, v103
    v_fmac_f32 v113, v72, v88
    v_fmac_f32 v58, v72, v104
    v_fmac_f32 v113, v73, v89
    v_fmac_f32 v58, v73, v105
    v_fmac_f32 v113, v74, v90
    v_fmac_f32 v58, v74, v106
    v_fmac_f32 v113, v75, v91
    v_fmac_f32 v58, v75, v107
    v_fmac_f32 v113, v76, v92
    v_fmac_f32 v58, v76, v108
    v_fmac_f32 v113, v77, v93
    v_fmac_f32 v58, v77, v109
    v_fmac_f32 v113, v78, v94
    v_fmac_f32 v58, v78, v110
    v_fmac_f32 v113, v79, v95
    v_fmac_f32 v58, v79, v111
    s_nop 1
    v_mov_b32_dpp v59, v58 quad_perm:[1,0,3,2] row_mask:0xf bank_mask:0xf
    v_cvt_pk_bf16_f32 v60, v58, v59
    s_nop 1
    v_readlane_b32 s76, v60, 0
    v_readlane_b32 s77, v60, 2
    v_readlane_b32 s78, v60, 4
    v_readlane_b32 s79, v60, 6
    v_readlane_b32 s80, v60, 8
    v_readlane_b32 s81, v60, 10
    v_readlane_b32 s82, v60, 12
    v_readlane_b32 s83, v60, 14
    v_readlane_b32 s84, v60, 16
    v_readlane_b32 s85, v60, 18
    v_readlane_b32 s86, v60, 20
    v_readlane_b32 s87, v60, 22
    v_readlane_b32 s88, v60, 24
    v_readlane_b32 s89, v60, 26
    v_readlane_b32 s90, v60, 28
    v_readlane_b32 s91, v60, 30
    v_mov_b32 v8, 0
    v_mov_b32 v9, 0
    v_mov_b32 v10, 0
    v_mov_b32 v11, 0
    v_mov_b32 v12, 0
    v_mov_b32 v13, 0
    v_mov_b32 v14, 0
    v_mov_b32 v15, 0
    s_nop 3
    v_perm_b32 v26, v132, v128, s71
    v_perm_b32 v27, v132, v128, s72
    v_dot2_f32_bf16 v8, v26, s76, v8
    v_dot2_f32_bf16 v9, v27, s76, v9
    v_perm_b32 v26, v133, v129, s71
    v_perm_b32 v27, v133, v129, s72
    v_dot2_f32_bf16 v10, v26, s76, v10
    v_dot2_f32_bf16 v11, v27, s76, v11
    v_perm_b32 v26, v134, v130, s71
    v_perm_b32 v27, v134, v130, s72
    v_dot2_f32_bf16 v12, v26, s76, v12
    v_dot2_f32_bf16 v13, v27, s76, v13
    v_perm_b32 v26, v135, v131, s71
    v_perm_b32 v27, v135, v131, s72
    v_dot2_f32_bf16 v14, v26, s76, v14
    v_dot2_f32_bf16 v15, v27, s76, v15
    v_perm_b32 v26, v140, v136, s71
    v_perm_b32 v27, v140, v136, s72
    v_dot2_f32_bf16 v8, v26, s77, v8
    v_dot2_f32_bf16 v9, v27, s77, v9
    v_perm_b32 v26, v141, v137, s71
    v_perm_b32 v27, v141, v137, s72
    v_dot2_f32_bf16 v10, v26, s77, v10
    v_dot2_f32_bf16 v11, v27, s77, v11
    v_perm_b32 v26, v142, v138, s71
    v_perm_b32 v27, v142, v138, s72
    v_dot2_f32_bf16 v12, v26, s77, v12
    v_dot2_f32_bf16 v13, v27, s77, v13
    v_perm_b32 v26, v143, v139, s71
    v_perm_b32 v27, v143, v139, s72
    v_dot2_f32_bf16 v14, v26, s77, v14
    v_dot2_f32_bf16 v15, v27, s77, v15
    v_perm_b32 v26, v148, v144, s71
    v_perm_b32 v27, v148, v144, s72
    v_dot2_f32_bf16 v8, v26, s78, v8
    v_dot2_f32_bf16 v9, v27, s78, v9
    v_perm_b32 v26, v149, v145, s71
    v_perm_b32 v27, v149, v145, s72
    v_dot2_f32_bf16 v10, v26, s78, v10
    v_dot2_f32_bf16 v11, v27, s78, v11
    v_perm_b32 v26, v150, v146, s71
    v_perm_b32 v27, v150, v146, s72
    v_dot2_f32_bf16 v12, v26, s78, v12
    v_dot2_f32_bf16 v13, v27, s78, v13
    v_perm_b32 v26, v151, v147, s71
    v_perm_b32 v27, v151, v147, s72
    v_dot2_f32_bf16 v14, v26, s78, v14
    v_dot2_f32_bf16 v15, v27, s78, v15
    v_perm_b32 v26, v156, v152, s71
    v_perm_b32 v27, v156, v152, s72
    v_dot2_f32_bf16 v8, v26, s79, v8
    v_dot2_f32_bf16 v9, v27, s79, v9
    v_perm_b32 v26, v157, v153, s71
    v_perm_b32 v27, v157, v153, s72
    v_dot2_f32_bf16 v10, v26, s79, v10
    v_dot2_f32_bf16 v11, v27, s79, v11
    v_perm_b32 v26, v158, v154, s71
    v_perm_b32 v27, v158, v154, s72
    v_dot2_f32_bf16 v12, v26, s79, v12
    v_dot2_f32_bf16 v13, v27, s79, v13
    v_perm_b32 v26, v159, v155, s71
    v_perm_b32 v27, v159, v155, s72
    v_dot2_f32_bf16 v14, v26, s79, v14
    v_dot2_f32_bf16 v15, v27, s79, v15
    v_perm_b32 v26, v164, v160, s71
    v_perm_b32 v27, v164, v160, s72
    v_dot2_f32_bf16 v8, v26, s80, v8
    v_dot2_f32_bf16 v9, v27, s80, v9
    v_perm_b32 v26, v165, v161, s71
    v_perm_b32 v27, v165, v161, s72
    v_dot2_f32_bf16 v10, v26, s80, v10
    v_dot2_f32_bf16 v11, v27, s80, v11
    v_perm_b32 v26, v166, v162, s71
    v_perm_b32 v27, v166, v162, s72
    v_dot2_f32_bf16 v12, v26, s80, v12
    v_dot2_f32_bf16 v13, v27, s80, v13
    v_perm_b32 v26, v167, v163, s71
    v_perm_b32 v27, v167, v163, s72
    v_dot2_f32_bf16 v14, v26, s80, v14
    v_dot2_f32_bf16 v15, v27, s80, v15
    v_perm_b32 v26, v172, v168, s71
    v_perm_b32 v27, v172, v168, s72
    v_dot2_f32_bf16 v8, v26, s81, v8
    v_dot2_f32_bf16 v9, v27, s81, v9
    v_perm_b32 v26, v173, v169, s71
    v_perm_b32 v27, v173, v169, s72
    v_dot2_f32_bf16 v10, v26, s81, v10
    v_dot2_f32_bf16 v11, v27, s81, v11
    v_perm_b32 v26, v174, v170, s71
    v_perm_b32 v27, v174, v170, s72
    v_dot2_f32_bf16 v12, v26, s81, v12
    v_dot2_f32_bf16 v13, v27, s81, v13
    v_perm_b32 v26, v175, v171, s71
    v_perm_b32 v27, v175, v171, s72
    v_dot2_f32_bf16 v14, v26, s81, v14
    v_dot2_f32_bf16 v15, v27, s81, v15
    v_perm_b32 v26, v180, v176, s71
    v_perm_b32 v27, v180, v176, s72
    v_dot2_f32_bf16 v8, v26, s82, v8
    v_dot2_f32_bf16 v9, v27, s82, v9
    v_perm_b32 v26, v181, v177, s71
    v_perm_b32 v27, v181, v177, s72
    v_dot2_f32_bf16 v10, v26, s82, v10
    v_dot2_f32_bf16 v11, v27, s82, v11
    v_perm_b32 v26, v182, v178, s71
    v_perm_b32 v27, v182, v178, s72
    v_dot2_f32_bf16 v12, v26, s82, v12
    v_dot2_f32_bf16 v13, v27, s82, v13
    v_perm_b32 v26, v183, v179, s71
    v_perm_b32 v27, v183, v179, s72
    v_dot2_f32_bf16 v14, v26, s82, v14
    v_dot2_f32_bf16 v15, v27, s82, v15
    v_perm_b32 v26, v188, v184, s71
    v_perm_b32 v27, v188, v184, s72
    v_dot2_f32_bf16 v8, v26, s83, v8
    v_dot2_f32_bf16 v9, v27, s83, v9
    v_perm_b32 v26, v189, v185, s71
    v_perm_b32 v27, v189, v185, s72
    v_dot2_f32_bf16 v10, v26, s83, v10
    v_dot2_f32_bf16 v11, v27, s83, v11
    v_perm_b32 v26, v190, v186, s71
    v_perm_b32 v27, v190, v186, s72
    v_dot2_f32_bf16 v12, v26, s83, v12
    v_dot2_f32_bf16 v13, v27, s83, v13
    v_perm_b32 v26, v191, v187, s71
    v_perm_b32 v27, v191, v187, s72
    v_dot2_f32_bf16 v14, v26, s83, v14
    v_dot2_f32_bf16 v15, v27, s83, v15
    v_perm_b32 v26, v196, v192, s71
    v_perm_b32 v27, v196, v192, s72
    v_dot2_f32_bf16 v8, v26, s84, v8
    v_dot2_f32_bf16 v9, v27, s84, v9
    v_perm_b32 v26, v197, v193, s71
    v_perm_b32 v27, v197, v193, s72
    v_dot2_f32_bf16 v10, v26, s84, v10
    v_dot2_f32_bf16 v11, v27, s84, v11
    v_perm_b32 v26, v198, v194, s71
    v_perm_b32 v27, v198, v194, s72
    v_dot2_f32_bf16 v12, v26, s84, v12
    v_dot2_f32_bf16 v13, v27, s84, v13
    v_perm_b32 v26, v199, v195, s71
    v_perm_b32 v27, v199, v195, s72
    v_dot2_f32_bf16 v14, v26, s84, v14
    v_dot2_f32_bf16 v15, v27, s84, v15
    v_perm_b32 v26, v204, v200, s71
    v_perm_b32 v27, v204, v200, s72
    v_dot2_f32_bf16 v8, v26, s85, v8
    v_dot2_f32_bf16 v9, v27, s85, v9
    v_perm_b32 v26, v205, v201, s71
    v_perm_b32 v27, v205, v201, s72
    v_dot2_f32_bf16 v10, v26, s85, v10
    v_dot2_f32_bf16 v11, v27, s85, v11
    v_perm_b32 v26, v206, v202, s71
    v_perm_b32 v27, v206, v202, s72
    v_dot2_f32_bf16 v12, v26, s85, v12
    v_dot2_f32_bf16 v13, v27, s85, v13
    v_perm_b32 v26, v207, v203, s71
    v_perm_b32 v27, v207, v203, s72
    v_dot2_f32_bf16 v14, v26, s85, v14
    v_dot2_f32_bf16 v15, v27, s85, v15
    v_perm_b32 v26, v212, v208, s71
    v_perm_b32 v27, v212, v208, s72
    v_dot2_f32_bf16 v8, v26, s86, v8
    v_dot2_f32_bf16 v9, v27, s86, v9
    v_perm_b32 v26, v213, v209, s71
    v_perm_b32 v27, v213, v209, s72
    v_dot2_f32_bf16 v10, v26, s86, v10
    v_dot2_f32_bf16 v11, v27, s86, v11
    v_perm_b32 v26, v214, v210, s71
    v_perm_b32 v27, v214, v210, s72
    v_dot2_f32_bf16 v12, v26, s86, v12
    v_dot2_f32_bf16 v13, v27, s86, v13
    v_perm_b32 v26, v215, v211, s71
    v_perm_b32 v27, v215, v211, s72
    v_dot2_f32_bf16 v14, v26, s86, v14
    v_dot2_f32_bf16 v15, v27, s86, v15
    v_perm_b32 v26, v220, v216, s71
    v_perm_b32 v27, v220, v216, s72
    v_dot2_f32_bf16 v8, v26, s87, v8
    v_dot2_f32_bf16 v9, v27, s87, v9
    v_perm_b32 v26, v221, v217, s71
    v_perm_b32 v27, v221, v217, s72
    v_dot2_f32_bf16 v10, v26, s87, v10
    v_dot2_f32_bf16 v11, v27, s87, v11
    v_perm_b32 v26, v222, v218, s71
    v_perm_b32 v27, v222, v218, s72
    v_dot2_f32_bf16 v12, v26, s87, v12
    v_dot2_f32_bf16 v13, v27, s87, v13
    v_perm_b32 v26, v223, v219, s71
    v_perm_b32 v27, v223, v219, s72
    v_dot2_f32_bf16 v14, v26, s87, v14
    v_dot2_f32_bf16 v15, v27, s87, v15
    v_perm_b32 v26, v228, v224, s71
    v_perm_b32 v27, v228, v224, s72
    v_dot2_f32_bf16 v8, v26, s88, v8
    v_dot2_f32_bf16 v9, v27, s88, v9
    v_perm_b32 v26, v229, v225, s71
    v_perm_b32 v27, v229, v225, s72
    v_dot2_f32_bf16 v10, v26, s88, v10
    v_dot2_f32_bf16 v11, v27, s88, v11
    v_perm_b32 v26, v230, v226, s71
    v_perm_b32 v27, v230, v226, s72
    v_dot2_f32_bf16 v12, v26, s88, v12
    v_dot2_f32_bf16 v13, v27, s88, v13
    v_perm_b32 v26, v231, v227, s71
    v_perm_b32 v27, v231, v227, s72
    v_dot2_f32_bf16 v14, v26, s88, v14
    v_dot2_f32_bf16 v15, v27, s88, v15
    v_perm_b32 v26, v236, v232, s71
    v_perm_b32 v27, v236, v232, s72
    v_dot2_f32_bf16 v8, v26, s89, v8
    v_dot2_f32_bf16 v9, v27, s89, v9
    v_perm_b32 v26, v237, v233, s71
    v_perm_b32 v27, v237, v233, s72
    v_dot2_f32_bf16 v10, v26, s89, v10
    v_dot2_f32_bf16 v11, v27, s89, v11
    v_perm_b32 v26, v238, v234, s71
    v_perm_b32 v27, v238, v234, s72
    v_dot2_f32_bf16 v12, v26, s89, v12
    v_dot2_f32_bf16 v13, v27, s89, v13
    v_perm_b32 v26, v239, v235, s71
    v_perm_b32 v27, v239, v235, s72
    v_dot2_f32_bf16 v14, v26, s89, v14
    v_dot2_f32_bf16 v15, v27, s89, v15
    v_perm_b32 v26, v244, v240, s71
    v_perm_b32 v27, v244, v240, s72
    v_dot2_f32_bf16 v8, v26, s90, v8
    v_dot2_f32_bf16 v9, v27, s90, v9
    v_perm_b32 v26, v245, v241, s71
    v_perm_b32 v27, v245, v241, s72
    v_dot2_f32_bf16 v10, v26, s90, v10
    v_dot2_f32_bf16 v11, v27, s90, v11
    v_perm_b32 v26, v246, v242, s71
    v_perm_b32 v27, v246, v242, s72
    v_dot2_f32_bf16 v12, v26, s90, v12
    v_dot2_f32_bf16 v13, v27, s90, v13
    v_perm_b32 v26, v247, v243, s71
    v_perm_b32 v27, v247, v243, s72
    v_dot2_f32_bf16 v14, v26, s90, v14
    v_dot2_f32_bf16 v15, v27, s90, v15
    v_perm_b32 v26, v252, v248, s71
    v_perm_b32 v27, v252, v248, s72
    v_dot2_f32_bf16 v8, v26, s91, v8
    v_dot2_f32_bf16 v9, v27, s91, v9
    v_perm_b32 v26, v253, v249, s71
    v_perm_b32 v27, v253, v249, s72
    v_dot2_f32_bf16 v10, v26, s91, v10
    v_dot2_f32_bf16 v11, v27, s91, v11
    v_perm_b32 v26, v254, v250, s71
    v_perm_b32 v27, v254, v250, s72
    v_dot2_f32_bf16 v12, v26, s91, v12
    v_dot2_f32_bf16 v13, v27, s91, v13
    v_perm_b32 v26, v255, v251, s71
    v_perm_b32 v27, v255, v251, s72
    v_dot2_f32_bf16 v14, v26, s91, v14
    v_dot2_f32_bf16 v15, v27, s91, v15
    s_nop 3
    v_lshlrev_b32 v26, 5, v1
    s_lshl_b32 s11, s7, 11
    v_add_u32 v26, s11, v26
    ds_write_b128 v26, v[8:11] offset:20480
    ds_write_b128 v26, v[12:15] offset:20496
    s_waitcnt lgkmcnt(0)
    s_barrier
    v_lshlrev_b32 v26, 3, v0
    ds_read_b64 v[56:57], v26 offset:20480
    ds_read_b64 v[58:59], v26 offset:22528
    ds_read_b64 v[60:61], v26 offset:24576
    ds_read_b64 v[62:63], v26 offset:26624
    s_waitcnt lgkmcnt(0)
    v_add_f32 v56, v56, v58
    v_add_f32 v60, v60, v62
    v_add_f32 v57, v57, v59
    v_add_f32 v61, v61, v63
    v_add_f32 v56, v56, v60
    v_add_f32 v57, v57, v61
    s_lshl_b32 s11, s5, 5
    s_add_u32 s11, s11, s4
    s_lshl_b32 s11, s11, 2
    s_add_u32 s11, s11, s6
    s_lshl_b32 s12, s11, 11
    s_add_u32 s12, s12, 0x0
    buffer_store_dwordx2 v[56:57], v26, s[64:67], s12 offen sc1
    s_lshl_b32 s12, s11, 3
    s_add_u32 s12, s12, 0x80000
    v_mov_b32 v27, 0
    v_cmp_eq_u32 vcc, 0, v0
    s_and_saveexec_b64 s[14:15], vcc
    buffer_store_dwordx2 v[112:113], v27, s[64:67], s12 offen sc1
    s_mov_b64 exec, s[14:15]
    s_waitcnt vmcnt(0)
    s_branch FIN
ROLE_B:
    s_mov_b32 s3, s2
    v_and_b32 v1, 63, v0
    v_lshrrev_b32 v2, 4, v1
    v_and_b32 v3, 15, v1
    v_lshlrev_b32 v4, 4, v1
    v_readfirstlane_b32 s7, v0
    s_nop 3
    s_lshr_b32 s7, s7, 6
    s_mov_b32 s68, 0x3db504f3
    s_mov_b32 s69, 0x3fb8aa3b
    s_mov_b32 s70, 0xbfb8aa3b
    s_mov_b32 s71, 0x05040100
    s_mov_b32 s72, 0x07060302
    s_mov_b32 s44, s26
    s_and_b32 s45, s27, 0xffff
    s_mov_b32 s46, 0x800
    s_mov_b32 s47, 0x00020000
    s_mov_b32 s48, s30
    s_and_b32 s49, s31, 0xffff
    s_mov_b32 s50, 0x400000
    s_mov_b32 s51, 0x00020000
    s_mov_b32 s52, s32
    s_and_b32 s53, s33, 0xffff
    s_mov_b32 s54, 0x400000
    s_mov_b32 s55, 0x00020000
    s_mov_b32 s56, s28
    s_and_b32 s57, s29, 0xffff
    s_mov_b32 s58, 0x800000
    s_mov_b32 s59, 0x00020000
    s_mov_b32 s60, s34
    s_and_b32 s61, s35, 0xffff
    s_mov_b32 s62, 0x400000
    s_mov_b32 s63, 0x00020000
    s_mov_b32 s64, s42
    s_and_b32 s65, s43, 0xffff
    s_mov_b32 s66, 0x10000000
    s_mov_b32 s67, 0x00020000
    s_mov_b32 s80, s36
    s_and_b32 s81, s37, 0xffff
    s_mov_b32 s82, 0x400000
    s_mov_b32 s83, 0x00020000
    s_mov_b32 s84, s40
    s_and_b32 s85, s41, 0xffff
    s_mov_b32 s86, 0x100
    s_mov_b32 s87, 0x00020000
    s_lshr_b32 s4, s3, 1
    s_and_b32 s6, s3, 1
    v_lshlrev_b32 v5, 6, v2
    s_lshl_b32 s11, s7, 8
    s_add_u32 s12, s11, 1024
    buffer_load_dwordx4 v[192:195], v5, s[44:47], s11 offen offset:0
    buffer_load_dwordx4 v[196:199], v5, s[44:47], s11 offen offset:16
    buffer_load_dwordx4 v[200:203], v5, s[44:47], s11 offen offset:32
    buffer_load_dwordx4 v[204:207], v5, s[44:47], s11 offen offset:48
    buffer_load_dwordx4 v[208:211], v5, s[44:47], s12 offen offset:0
    buffer_load_dwordx4 v[212:215], v5, s[44:47], s12 offen offset:16
    buffer_load_dwordx4 v[216:219], v5, s[44:47], s12 offen offset:32
    buffer_load_dwordx4 v[220:223], v5, s[44:47], s12 offen offset:48
    v_lshlrev_b32 v6, 18, v2
    v_lshl_add_u32 v6, v3, 4, v6
    s_lshl_b32 s11, s7, 20
    s_lshl_b32 s12, s4, 8
    s_add_u32 s88, s11, s12
    buffer_load_dwordx4 v[64:67], v6, s[48:51], s88 offen
    s_add_u32 s88, s88, 8192
    buffer_load_dwordx4 v[68:71], v6, s[48:51], s88 offen
    s_add_u32 s88, s88, 8192
    buffer_load_dwordx4 v[72:75], v6, s[48:51], s88 offen
    s_add_u32 s88, s88, 8192
    buffer_load_dwordx4 v[76:79], v6, s[48:51], s88 offen
    s_add_u32 s88, s88, 8192
    buffer_load_dwordx4 v[80:83], v6, s[48:51], s88 offen
    s_add_u32 s88, s88, 8192
    buffer_load_dwordx4 v[84:87], v6, s[48:51], s88 offen
    s_add_u32 s88, s88, 8192
    buffer_load_dwordx4 v[88:91], v6, s[48:51], s88 offen
    s_add_u32 s88, s88, 8192
    buffer_load_dwordx4 v[92:95], v6, s[48:51], s88 offen
    s_add_u32 s88, s88, 8192
    buffer_load_dwordx4 v[96:99], v6, s[48:51], s88 offen
    s_add_u32 s88, s88, 8192
    buffer_load_dwordx4 v[100:103], v6, s[48:51], s88 offen
    s_add_u32 s88, s88, 8192
    buffer_load_dwordx4 v[104:107], v6, s[48:51], s88 offen
    s_add_u32 s88, s88, 8192
    buffer_load_dwordx4 v[108:111], v6, s[48:51], s88 offen
    s_add_u32 s88, s88, 8192
    buffer_load_dwordx4 v[112:115], v6, s[48:51], s88 offen
    s_add_u32 s88, s88, 8192
    buffer_load_dwordx4 v[116:119], v6, s[48:51], s88 offen
    s_add_u32 s88, s88, 8192
    buffer_load_dwordx4 v[120:123], v6, s[48:51], s88 offen
    s_add_u32 s88, s88, 8192
    buffer_load_dwordx4 v[124:127], v6, s[48:51], s88 offen
    s_add_u32 s88, s88, 8192
    buffer_load_dwordx4 v[128:131], v6, s[48:51], s88 offen
    s_add_u32 s88, s88, 8192
    buffer_load_dwordx4 v[132:135], v6, s[48:51], s88 offen
    s_add_u32 s88, s88, 8192
    buffer_load_dwordx4 v[136:139], v6, s[48:51], s88 offen
    s_add_u32 s88, s88, 8192
    buffer_load_dwordx4 v[140:143], v6, s[48:51], s88 offen
    s_add_u32 s88, s88, 8192
    buffer_load_dwordx4 v[144:147], v6, s[48:51], s88 offen
    s_add_u32 s88, s88, 8192
    buffer_load_dwordx4 v[148:151], v6, s[48:51], s88 offen
    s_add_u32 s88, s88, 8192
    buffer_load_dwordx4 v[152:155], v6, s[48:51], s88 offen
    s_add_u32 s88, s88, 8192
    buffer_load_dwordx4 v[156:159], v6, s[48:51], s88 offen
    s_add_u32 s88, s88, 8192
    buffer_load_dwordx4 v[160:163], v6, s[48:51], s88 offen
    s_add_u32 s88, s88, 8192
    buffer_load_dwordx4 v[164:167], v6, s[48:51], s88 offen
    s_add_u32 s88, s88, 8192
    buffer_load_dwordx4 v[168:171], v6, s[48:51], s88 offen
    s_add_u32 s88, s88, 8192
    buffer_load_dwordx4 v[172:175], v6, s[48:51], s88 offen
    s_add_u32 s88, s88, 8192
    buffer_load_dwordx4 v[176:179], v6, s[48:51], s88 offen
    s_add_u32 s88, s88, 8192
    buffer_load_dwordx4 v[180:183], v6, s[48:51], s88 offen
    s_add_u32 s88, s88, 8192
    buffer_load_dwordx4 v[184:187], v6, s[48:51], s88 offen
    s_add_u32 s88, s88, 8192
    buffer_load_dwordx4 v[188:191], v6, s[48:51], s88 offen
    s_add_u32 s88, s88, 8192
    v_mov_b32 v8, 0
    v_mov_b32 v16, 0
    v_mov_b32 v9, 0
    v_mov_b32 v17, 0
    v_mov_b32 v10, 0
    v_mov_b32 v18, 0
    v_mov_b32 v11, 0
    v_mov_b32 v19, 0
    v_mov_b32 v12, 0
    v_mov_b32 v20, 0
    v_mov_b32 v13, 0
    v_mov_b32 v21, 0
    v_mov_b32 v14, 0
    v_mov_b32 v22, 0
    v_mov_b32 v15, 0
    v_mov_b32 v23, 0
    v_lshlrev_b32 v7, 13, v2
    v_lshl_add_u32 v7, v3, 4, v7
    s_lshl_b32 s11, s6, 21
    s_lshl_b32 s12, s7, 19
    s_add_u32 s11, s11, s12
    s_lshl_b32 s12, s4, 8
    s_add_u32 s89, s11, s12
    s_waitcnt vmcnt(32)
    s_waitcnt vmcnt(24)
    v_perm_b32 v24, v68, v64, s71
    v_perm_b32 v25, v68, v64, s72
    v_dot2_f32_bf16 v8, v24, v192, v8
    v_dot2_f32_bf16 v9, v25, v192, v9
    v_dot2_f32_bf16 v16, v24, v208, v16
    v_dot2_f32_bf16 v17, v25, v208, v17
    v_perm_b32 v24, v69, v65, s71
    v_perm_b32 v25, v69, v65, s72
    v_dot2_f32_bf16 v10, v24, v192, v10
    v_dot2_f32_bf16 v11, v25, v192, v11
    v_dot2_f32_bf16 v18, v24, v208, v18
    v_dot2_f32_bf16 v19, v25, v208, v19
    v_perm_b32 v24, v70, v66, s71
    v_perm_b32 v25, v70, v66, s72
    v_dot2_f32_bf16 v12, v24, v192, v12
    v_dot2_f32_bf16 v13, v25, v192, v13
    v_dot2_f32_bf16 v20, v24, v208, v20
    v_dot2_f32_bf16 v21, v25, v208, v21
    v_perm_b32 v24, v71, v67, s71
    v_perm_b32 v25, v71, v67, s72
    v_dot2_f32_bf16 v14, v24, v192, v14
    v_dot2_f32_bf16 v15, v25, v192, v15
    v_dot2_f32_bf16 v22, v24, v208, v22
    v_dot2_f32_bf16 v23, v25, v208, v23
    v_perm_b32 v24, v76, v72, s71
    v_perm_b32 v25, v76, v72, s72
    v_dot2_f32_bf16 v8, v24, v193, v8
    v_dot2_f32_bf16 v9, v25, v193, v9
    v_dot2_f32_bf16 v16, v24, v209, v16
    v_dot2_f32_bf16 v17, v25, v209, v17
    v_perm_b32 v24, v77, v73, s71
    v_perm_b32 v25, v77, v73, s72
    v_dot2_f32_bf16 v10, v24, v193, v10
    v_dot2_f32_bf16 v11, v25, v193, v11
    v_dot2_f32_bf16 v18, v24, v209, v18
    v_dot2_f32_bf16 v19, v25, v209, v19
    v_perm_b32 v24, v78, v74, s71
    v_perm_b32 v25, v78, v74, s72
    v_dot2_f32_bf16 v12, v24, v193, v12
    v_dot2_f32_bf16 v13, v25, v193, v13
    v_dot2_f32_bf16 v20, v24, v209, v20
    v_dot2_f32_bf16 v21, v25, v209, v21
    v_perm_b32 v24, v79, v75, s71
    v_perm_b32 v25, v79, v75, s72
    v_dot2_f32_bf16 v14, v24, v193, v14
    v_dot2_f32_bf16 v15, v25, v193, v15
    v_dot2_f32_bf16 v22, v24, v209, v22
    v_dot2_f32_bf16 v23, v25, v209, v23
    v_perm_b32 v24, v84, v80, s71
    v_perm_b32 v25, v84, v80, s72
    v_dot2_f32_bf16 v8, v24, v194, v8
    v_dot2_f32_bf16 v9, v25, v194, v9
    v_dot2_f32_bf16 v16, v24, v210, v16
    v_dot2_f32_bf16 v17, v25, v210, v17
    v_perm_b32 v24, v85, v81, s71
    v_perm_b32 v25, v85, v81, s72
    v_dot2_f32_bf16 v10, v24, v194, v10
    v_dot2_f32_bf16 v11, v25, v194, v11
    v_dot2_f32_bf16 v18, v24, v210, v18
    v_dot2_f32_bf16 v19, v25, v210, v19
    v_perm_b32 v24, v86, v82, s71
    v_perm_b32 v25, v86, v82, s72
    v_dot2_f32_bf16 v12, v24, v194, v12
    v_dot2_f32_bf16 v13, v25, v194, v13
    v_dot2_f32_bf16 v20, v24, v210, v20
    v_dot2_f32_bf16 v21, v25, v210, v21
    v_perm_b32 v24, v87, v83, s71
    v_perm_b32 v25, v87, v83, s72
    v_dot2_f32_bf16 v14, v24, v194, v14
    v_dot2_f32_bf16 v15, v25, v194, v15
    v_dot2_f32_bf16 v22, v24, v210, v22
    v_dot2_f32_bf16 v23, v25, v210, v23
    v_perm_b32 v24, v92, v88, s71
    v_perm_b32 v25, v92, v88, s72
    v_dot2_f32_bf16 v8, v24, v195, v8
    v_dot2_f32_bf16 v9, v25, v195, v9
    v_dot2_f32_bf16 v16, v24, v211, v16
    v_dot2_f32_bf16 v17, v25, v211, v17
    v_perm_b32 v24, v93, v89, s71
    v_perm_b32 v25, v93, v89, s72
    v_dot2_f32_bf16 v10, v24, v195, v10
    v_dot2_f32_bf16 v11, v25, v195, v11
    v_dot2_f32_bf16 v18, v24, v211, v18
    v_dot2_f32_bf16 v19, v25, v211, v19
    v_perm_b32 v24, v94, v90, s71
    v_perm_b32 v25, v94, v90, s72
    v_dot2_f32_bf16 v12, v24, v195, v12
    v_dot2_f32_bf16 v13, v25, v195, v13
    v_dot2_f32_bf16 v20, v24, v211, v20
    v_dot2_f32_bf16 v21, v25, v211, v21
    v_perm_b32 v24, v95, v91, s71
    v_perm_b32 v25, v95, v91, s72
    v_dot2_f32_bf16 v14, v24, v195, v14
    v_dot2_f32_bf16 v15, v25, v195, v15
    v_dot2_f32_bf16 v22, v24, v211, v22
    v_dot2_f32_bf16 v23, v25, v211, v23
    buffer_load_dwordx4 v[64:67], v7, s[52:55], s89 offen
    s_add_u32 s89, s89, 32768
    buffer_load_dwordx4 v[68:71], v7, s[52:55], s89 offen
    s_add_u32 s89, s89, 32768
    buffer_load_dwordx4 v[72:75], v7, s[52:55], s89 offen
    s_add_u32 s89, s89, 32768
    buffer_load_dwordx4 v[76:79], v7, s[52:55], s89 offen
    s_add_u32 s89, s89, 32768
    buffer_load_dwordx4 v[80:83], v7, s[52:55], s89 offen
    s_add_u32 s89, s89, 32768
    buffer_load_dwordx4 v[84:87], v7, s[52:55], s89 offen
    s_add_u32 s89, s89, 32768
    buffer_load_dwordx4 v[88:91], v7, s[52:55], s89 offen
    s_add_u32 s89, s89, 32768
    buffer_load_dwordx4 v[92:95], v7, s[52:55], s89 offen
    s_add_u32 s89, s89, 32768
    s_waitcnt vmcnt(24)
    v_perm_b32 v24, v100, v96, s71
    v_perm_b32 v25, v100, v96, s72
    v_dot2_f32_bf16 v8, v24, v196, v8
    v_dot2_f32_bf16 v9, v25, v196, v9
    v_dot2_f32_bf16 v16, v24, v212, v16
    v_dot2_f32_bf16 v17, v25, v212, v17
    v_perm_b32 v24, v101, v97, s71
    v_perm_b32 v25, v101, v97, s72
    v_dot2_f32_bf16 v10, v24, v196, v10
    v_dot2_f32_bf16 v11, v25, v196, v11
    v_dot2_f32_bf16 v18, v24, v212, v18
    v_dot2_f32_bf16 v19, v25, v212, v19
    v_perm_b32 v24, v102, v98, s71
    v_perm_b32 v25, v102, v98, s72
    v_dot2_f32_bf16 v12, v24, v196, v12
    v_dot2_f32_bf16 v13, v25, v196, v13
    v_dot2_f32_bf16 v20, v24, v212, v20
    v_dot2_f32_bf16 v21, v25, v212, v21
    v_perm_b32 v24, v103, v99, s71
    v_perm_b32 v25, v103, v99, s72
    v_dot2_f32_bf16 v14, v24, v196, v14
    v_dot2_f32_bf16 v15, v25, v196, v15
    v_dot2_f32_bf16 v22, v24, v212, v22
    v_dot2_f32_bf16 v23, v25, v212, v23
    v_perm_b32 v24, v108, v104, s71
    v_perm_b32 v25, v108, v104, s72
    v_dot2_f32_bf16 v8, v24, v197, v8
    v_dot2_f32_bf16 v9, v25, v197, v9
    v_dot2_f32_bf16 v16, v24, v213, v16
    v_dot2_f32_bf16 v17, v25, v213, v17
    v_perm_b32 v24, v109, v105, s71
    v_perm_b32 v25, v109, v105, s72
    v_dot2_f32_bf16 v10, v24, v197, v10
    v_dot2_f32_bf16 v11, v25, v197, v11
    v_dot2_f32_bf16 v18, v24, v213, v18
    v_dot2_f32_bf16 v19, v25, v213, v19
    v_perm_b32 v24, v110, v106, s71
    v_perm_b32 v25, v110, v106, s72
    v_dot2_f32_bf16 v12, v24, v197, v12
    v_dot2_f32_bf16 v13, v25, v197, v13
    v_dot2_f32_bf16 v20, v24, v213, v20
    v_dot2_f32_bf16 v21, v25, v213, v21
    v_perm_b32 v24, v111, v107, s71
    v_perm_b32 v25, v111, v107, s72
    v_dot2_f32_bf16 v14, v24, v197, v14
    v_dot2_f32_bf16 v15, v25, v197, v15
    v_dot2_f32_bf16 v22, v24, v213, v22
    v_dot2_f32_bf16 v23, v25, v213, v23
    v_perm_b32 v24, v116, v112, s71
    v_perm_b32 v25, v116, v112, s72
    v_dot2_f32_bf16 v8, v24, v198, v8
    v_dot2_f32_bf16 v9, v25, v198, v9
    v_dot2_f32_bf16 v16, v24, v214, v16
    v_dot2_f32_bf16 v17, v25, v214, v17
    v_perm_b32 v24, v117, v113, s71
    v_perm_b32 v25, v117, v113, s72
    v_dot2_f32_bf16 v10, v24, v198, v10
    v_dot2_f32_bf16 v11, v25, v198, v11
    v_dot2_f32_bf16 v18, v24, v214, v18
    v_dot2_f32_bf16 v19, v25, v214, v19
    v_perm_b32 v24, v118, v114, s71
    v_perm_b32 v25, v118, v114, s72
    v_dot2_f32_bf16 v12, v24, v198, v12
    v_dot2_f32_bf16 v13, v25, v198, v13
    v_dot2_f32_bf16 v20, v24, v214, v20
    v_dot2_f32_bf16 v21, v25, v214, v21
    v_perm_b32 v24, v119, v115, s71
    v_perm_b32 v25, v119, v115, s72
    v_dot2_f32_bf16 v14, v24, v198, v14
    v_dot2_f32_bf16 v15, v25, v198, v15
    v_dot2_f32_bf16 v22, v24, v214, v22
    v_dot2_f32_bf16 v23, v25, v214, v23
    v_perm_b32 v24, v124, v120, s71
    v_perm_b32 v25, v124, v120, s72
    v_dot2_f32_bf16 v8, v24, v199, v8
    v_dot2_f32_bf16 v9, v25, v199, v9
    v_dot2_f32_bf16 v16, v24, v215, v16
    v_dot2_f32_bf16 v17, v25, v215, v17
    v_perm_b32 v24, v125, v121, s71
    v_perm_b32 v25, v125, v121, s72
    v_dot2_f32_bf16 v10, v24, v199, v10
    v_dot2_f32_bf16 v11, v25, v199, v11
    v_dot2_f32_bf16 v18, v24, v215, v18
    v_dot2_f32_bf16 v19, v25, v215, v19
    v_perm_b32 v24, v126, v122, s71
    v_perm_b32 v25, v126, v122, s72
    v_dot2_f32_bf16 v12, v24, v199, v12
    v_dot2_f32_bf16 v13, v25, v199, v13
    v_dot2_f32_bf16 v20, v24, v215, v20
    v_dot2_f32_bf16 v21, v25, v215, v21
    v_perm_b32 v24, v127, v123, s71
    v_perm_b32 v25, v127, v123, s72
    v_dot2_f32_bf16 v14, v24, v199, v14
    v_dot2_f32_bf16 v15, v25, v199, v15
    v_dot2_f32_bf16 v22, v24, v215, v22
    v_dot2_f32_bf16 v23, v25, v215, v23
    buffer_load_dwordx4 v[96:99], v7, s[52:55], s89 offen
    s_add_u32 s89, s89, 32768
    buffer_load_dwordx4 v[100:103], v7, s[52:55], s89 offen
    s_add_u32 s89, s89, 32768
    buffer_load_dwordx4 v[104:107], v7, s[52:55], s89 offen
    s_add_u32 s89, s89, 32768
    buffer_load_dwordx4 v[108:111], v7, s[52:55], s89 offen
    s_add_u32 s89, s89, 32768
    buffer_load_dwordx4 v[112:115], v7, s[52:55], s89 offen
    s_add_u32 s89, s89, 32768
    buffer_load_dwordx4 v[116:119], v7, s[52:55], s89 offen
    s_add_u32 s89, s89, 32768
    buffer_load_dwordx4 v[120:123], v7, s[52:55], s89 offen
    s_add_u32 s89, s89, 32768
    buffer_load_dwordx4 v[124:127], v7, s[52:55], s89 offen
    s_add_u32 s89, s89, 32768
    s_waitcnt vmcnt(24)
    v_perm_b32 v24, v132, v128, s71
    v_perm_b32 v25, v132, v128, s72
    v_dot2_f32_bf16 v8, v24, v200, v8
    v_dot2_f32_bf16 v9, v25, v200, v9
    v_dot2_f32_bf16 v16, v24, v216, v16
    v_dot2_f32_bf16 v17, v25, v216, v17
    v_perm_b32 v24, v133, v129, s71
    v_perm_b32 v25, v133, v129, s72
    v_dot2_f32_bf16 v10, v24, v200, v10
    v_dot2_f32_bf16 v11, v25, v200, v11
    v_dot2_f32_bf16 v18, v24, v216, v18
    v_dot2_f32_bf16 v19, v25, v216, v19
    v_perm_b32 v24, v134, v130, s71
    v_perm_b32 v25, v134, v130, s72
    v_dot2_f32_bf16 v12, v24, v200, v12
    v_dot2_f32_bf16 v13, v25, v200, v13
    v_dot2_f32_bf16 v20, v24, v216, v20
    v_dot2_f32_bf16 v21, v25, v216, v21
    v_perm_b32 v24, v135, v131, s71
    v_perm_b32 v25, v135, v131, s72
    v_dot2_f32_bf16 v14, v24, v200, v14
    v_dot2_f32_bf16 v15, v25, v200, v15
    v_dot2_f32_bf16 v22, v24, v216, v22
    v_dot2_f32_bf16 v23, v25, v216, v23
    v_perm_b32 v24, v140, v136, s71
    v_perm_b32 v25, v140, v136, s72
    v_dot2_f32_bf16 v8, v24, v201, v8
    v_dot2_f32_bf16 v9, v25, v201, v9
    v_dot2_f32_bf16 v16, v24, v217, v16
    v_dot2_f32_bf16 v17, v25, v217, v17
    v_perm_b32 v24, v141, v137, s71
    v_perm_b32 v25, v141, v137, s72
    v_dot2_f32_bf16 v10, v24, v201, v10
    v_dot2_f32_bf16 v11, v25, v201, v11
    v_dot2_f32_bf16 v18, v24, v217, v18
    v_dot2_f32_bf16 v19, v25, v217, v19
    v_perm_b32 v24, v142, v138, s71
    v_perm_b32 v25, v142, v138, s72
    v_dot2_f32_bf16 v12, v24, v201, v12
    v_dot2_f32_bf16 v13, v25, v201, v13
    v_dot2_f32_bf16 v20, v24, v217, v20
    v_dot2_f32_bf16 v21, v25, v217, v21
    v_perm_b32 v24, v143, v139, s71
    v_perm_b32 v25, v143, v139, s72
    v_dot2_f32_bf16 v14, v24, v201, v14
    v_dot2_f32_bf16 v15, v25, v201, v15
    v_dot2_f32_bf16 v22, v24, v217, v22
    v_dot2_f32_bf16 v23, v25, v217, v23
    v_perm_b32 v24, v148, v144, s71
    v_perm_b32 v25, v148, v144, s72
    v_dot2_f32_bf16 v8, v24, v202, v8
    v_dot2_f32_bf16 v9, v25, v202, v9
    v_dot2_f32_bf16 v16, v24, v218, v16
    v_dot2_f32_bf16 v17, v25, v218, v17
    v_perm_b32 v24, v149, v145, s71
    v_perm_b32 v25, v149, v145, s72
    v_dot2_f32_bf16 v10, v24, v202, v10
    v_dot2_f32_bf16 v11, v25, v202, v11
    v_dot2_f32_bf16 v18, v24, v218, v18
    v_dot2_f32_bf16 v19, v25, v218, v19
    v_perm_b32 v24, v150, v146, s71
    v_perm_b32 v25, v150, v146, s72
    v_dot2_f32_bf16 v12, v24, v202, v12
    v_dot2_f32_bf16 v13, v25, v202, v13
    v_dot2_f32_bf16 v20, v24, v218, v20
    v_dot2_f32_bf16 v21, v25, v218, v21
    v_perm_b32 v24, v151, v147, s71
    v_perm_b32 v25, v151, v147, s72
    v_dot2_f32_bf16 v14, v24, v202, v14
    v_dot2_f32_bf16 v15, v25, v202, v15
    v_dot2_f32_bf16 v22, v24, v218, v22
    v_dot2_f32_bf16 v23, v25, v218, v23
    v_perm_b32 v24, v156, v152, s71
    v_perm_b32 v25, v156, v152, s72
    v_dot2_f32_bf16 v8, v24, v203, v8
    v_dot2_f32_bf16 v9, v25, v203, v9
    v_dot2_f32_bf16 v16, v24, v219, v16
    v_dot2_f32_bf16 v17, v25, v219, v17
    v_perm_b32 v24, v157, v153, s71
    v_perm_b32 v25, v157, v153, s72
    v_dot2_f32_bf16 v10, v24, v203, v10
    v_dot2_f32_bf16 v11, v25, v203, v11
    v_dot2_f32_bf16 v18, v24, v219, v18
    v_dot2_f32_bf16 v19, v25, v219, v19
    v_perm_b32 v24, v158, v154, s71
    v_perm_b32 v25, v158, v154, s72
    v_dot2_f32_bf16 v12, v24, v203, v12
    v_dot2_f32_bf16 v13, v25, v203, v13
    v_dot2_f32_bf16 v20, v24, v219, v20
    v_dot2_f32_bf16 v21, v25, v219, v21
    v_perm_b32 v24, v159, v155, s71
    v_perm_b32 v25, v159, v155, s72
    v_dot2_f32_bf16 v14, v24, v203, v14
    v_dot2_f32_bf16 v15, v25, v203, v15
    v_dot2_f32_bf16 v22, v24, v219, v22
    v_dot2_f32_bf16 v23, v25, v219, v23
    s_waitcnt vmcnt(16)
    v_perm_b32 v24, v164, v160, s71
    v_perm_b32 v25, v164, v160, s72
    v_dot2_f32_bf16 v8, v24, v204, v8
    v_dot2_f32_bf16 v9, v25, v204, v9
    v_dot2_f32_bf16 v16, v24, v220, v16
    v_dot2_f32_bf16 v17, v25, v220, v17
    v_perm_b32 v24, v165, v161, s71
    v_perm_b32 v25, v165, v161, s72
    v_dot2_f32_bf16 v10, v24, v204, v10
    v_dot2_f32_bf16 v11, v25, v204, v11
    v_dot2_f32_bf16 v18, v24, v220, v18
    v_dot2_f32_bf16 v19, v25, v220, v19
    v_perm_b32 v24, v166, v162, s71
    v_perm_b32 v25, v166, v162, s72
    v_dot2_f32_bf16 v12, v24, v204, v12
    v_dot2_f32_bf16 v13, v25, v204, v13
    v_dot2_f32_bf16 v20, v24, v220, v20
    v_dot2_f32_bf16 v21, v25, v220, v21
    v_perm_b32 v24, v167, v163, s71
    v_perm_b32 v25, v167, v163, s72
    v_dot2_f32_bf16 v14, v24, v204, v14
    v_dot2_f32_bf16 v15, v25, v204, v15
    v_dot2_f32_bf16 v22, v24, v220, v22
    v_dot2_f32_bf16 v23, v25, v220, v23
    v_perm_b32 v24, v172, v168, s71
    v_perm_b32 v25, v172, v168, s72
    v_dot2_f32_bf16 v8, v24, v205, v8
    v_dot2_f32_bf16 v9, v25, v205, v9
    v_dot2_f32_bf16 v16, v24, v221, v16
    v_dot2_f32_bf16 v17, v25, v221, v17
    v_perm_b32 v24, v173, v169, s71
    v_perm_b32 v25, v173, v169, s72
    v_dot2_f32_bf16 v10, v24, v205, v10
    v_dot2_f32_bf16 v11, v25, v205, v11
    v_dot2_f32_bf16 v18, v24, v221, v18
    v_dot2_f32_bf16 v19, v25, v221, v19
    v_perm_b32 v24, v174, v170, s71
    v_perm_b32 v25, v174, v170, s72
    v_dot2_f32_bf16 v12, v24, v205, v12
    v_dot2_f32_bf16 v13, v25, v205, v13
    v_dot2_f32_bf16 v20, v24, v221, v20
    v_dot2_f32_bf16 v21, v25, v221, v21
    v_perm_b32 v24, v175, v171, s71
    v_perm_b32 v25, v175, v171, s72
    v_dot2_f32_bf16 v14, v24, v205, v14
    v_dot2_f32_bf16 v15, v25, v205, v15
    v_dot2_f32_bf16 v22, v24, v221, v22
    v_dot2_f32_bf16 v23, v25, v221, v23
    v_perm_b32 v24, v180, v176, s71
    v_perm_b32 v25, v180, v176, s72
    v_dot2_f32_bf16 v8, v24, v206, v8
    v_dot2_f32_bf16 v9, v25, v206, v9
    v_dot2_f32_bf16 v16, v24, v222, v16
    v_dot2_f32_bf16 v17, v25, v222, v17
    v_perm_b32 v24, v181, v177, s71
    v_perm_b32 v25, v181, v177, s72
    v_dot2_f32_bf16 v10, v24, v206, v10
    v_dot2_f32_bf16 v11, v25, v206, v11
    v_dot2_f32_bf16 v18, v24, v222, v18
    v_dot2_f32_bf16 v19, v25, v222, v19
    v_perm_b32 v24, v182, v178, s71
    v_perm_b32 v25, v182, v178, s72
    v_dot2_f32_bf16 v12, v24, v206, v12
    v_dot2_f32_bf16 v13, v25, v206, v13
    v_dot2_f32_bf16 v20, v24, v222, v20
    v_dot2_f32_bf16 v21, v25, v222, v21
    v_perm_b32 v24, v183, v179, s71
    v_perm_b32 v25, v183, v179, s72
    v_dot2_f32_bf16 v14, v24, v206, v14
    v_dot2_f32_bf16 v15, v25, v206, v15
    v_dot2_f32_bf16 v22, v24, v222, v22
    v_dot2_f32_bf16 v23, v25, v222, v23
    v_perm_b32 v24, v188, v184, s71
    v_perm_b32 v25, v188, v184, s72
    v_dot2_f32_bf16 v8, v24, v207, v8
    v_dot2_f32_bf16 v9, v25, v207, v9
    v_dot2_f32_bf16 v16, v24, v223, v16
    v_dot2_f32_bf16 v17, v25, v223, v17
    v_perm_b32 v24, v189, v185, s71
    v_perm_b32 v25, v189, v185, s72
    v_dot2_f32_bf16 v10, v24, v207, v10
    v_dot2_f32_bf16 v11, v25, v207, v11
    v_dot2_f32_bf16 v18, v24, v223, v18
    v_dot2_f32_bf16 v19, v25, v223, v19
    v_perm_b32 v24, v190, v186, s71
    v_perm_b32 v25, v190, v186, s72
    v_dot2_f32_bf16 v12, v24, v207, v12
    v_dot2_f32_bf16 v13, v25, v207, v13
    v_dot2_f32_bf16 v20, v24, v223, v20
    v_dot2_f32_bf16 v21, v25, v223, v21
    v_perm_b32 v24, v191, v187, s71
    v_perm_b32 v25, v191, v187, s72
    v_dot2_f32_bf16 v14, v24, v207, v14
    v_dot2_f32_bf16 v15, v25, v207, v15
    v_dot2_f32_bf16 v22, v24, v223, v22
    v_dot2_f32_bf16 v23, v25, v223, v23
    s_nop 3
    v_lshlrev_b32 v24, 2, v2
    s_lshl_b32 s11, s7, 4
    v_add_u32 v24, s11, v24
    v_lshlrev_b32 v24, 7, v24
    v_lshl_add_u32 v24, v3, 5, v24
    ds_write_b128 v24, v[8:11] offset:0
    ds_write_b128 v24, v[12:15] offset:16
    ds_write_b128 v24, v[16:19] offset:8192
    ds_write_b128 v24, v[20:23] offset:8208
    s_waitcnt lgkmcnt(0)
    s_barrier
    v_and_b32 v24, 127, v0
    v_lshrrev_b32 v25, 7, v0
    v_lshlrev_b32 v26, 13, v25
    v_lshl_add_u32 v26, v24, 2, v26
    ds_read_b32 v224, v26 offset:0
    ds_read_b32 v225, v26 offset:512
    ds_read_b32 v226, v26 offset:1024
    ds_read_b32 v227, v26 offset:1536
    ds_read_b32 v228, v26 offset:2048
    ds_read_b32 v229, v26 offset:2560
    ds_read_b32 v230, v26 offset:3072
    ds_read_b32 v231, v26 offset:3584
    ds_read_b32 v232, v26 offset:4096
    ds_read_b32 v233, v26 offset:4608
    ds_read_b32 v234, v26 offset:5120
    ds_read_b32 v235, v26 offset:5632
    ds_read_b32 v236, v26 offset:6144
    ds_read_b32 v237, v26 offset:6656
    ds_read_b32 v238, v26 offset:7168
    ds_read_b32 v239, v26 offset:7680
    s_waitcnt lgkmcnt(0)
    v_add_f32 v27, v224, v225
    v_add_f32 v27, v27, v226
    v_add_f32 v27, v27, v227
    v_add_f32 v27, v27, v228
    v_add_f32 v27, v27, v229
    v_add_f32 v27, v27, v230
    v_add_f32 v27, v27, v231
    v_add_f32 v27, v27, v232
    v_add_f32 v27, v27, v233
    v_add_f32 v27, v27, v234
    v_add_f32 v27, v27, v235
    v_add_f32 v27, v27, v236
    v_add_f32 v27, v27, v237
    v_add_f32 v27, v27, v238
    v_add_f32 v27, v27, v239
    v_cvt_pk_bf16_f32 v27, v27, v27
    v_lshlrev_b32 v25, 8, v25
    v_lshl_add_u32 v25, v24, 1, v25
    ds_write_b16 v25, v27 offset:16384
    s_waitcnt lgkmcnt(0)
    s_barrier
    v_lshlrev_b32 v24, 4, v3
    ds_read_b128 v[40:43], v24 offset:16384
    ds_read_b128 v[44:47], v24 offset:16640
    s_waitcnt lgkmcnt(0)
    s_lshr_b32 s11, s4, 4
    s_lshl_b32 s11, s11, 14
    s_lshl_b32 s12, s6, 3
    s_lshl_b32 s13, s7, 1
    s_add_u32 s12, s12, s13
    s_lshl_b32 s12, s12, 10
    s_add_u32 s11, s11, s12
    s_and_b32 s12, s4, 15
    s_lshl_b32 s12, s12, 4
    s_add_u32 s11, s11, s12
    s_add_u32 s90, s11, 0x100000
    s_add_u32 s91, s11, 0x108000
    s_add_u32 s92, s11, 0x110000
    s_add_u32 s93, s11, 0x118000
    v_lshlrev_b32 v5, 1, v2
    s_waitcnt vmcnt(8)
    v_dot2_f32_bf16 v48, v64, v40, 0
    v_dot2_f32_bf16 v49, v64, v44, 0
    v_dot2_f32_bf16 v50, v68, v40, 0
    v_dot2_f32_bf16 v51, v68, v44, 0
    v_dot2_f32_bf16 v48, v65, v41, v48
    v_dot2_f32_bf16 v49, v65, v45, v49
    v_dot2_f32_bf16 v50, v69, v41, v50
    v_dot2_f32_bf16 v51, v69, v45, v51
    v_dot2_f32_bf16 v48, v66, v42, v48
    v_dot2_f32_bf16 v49, v66, v46, v49
    v_dot2_f32_bf16 v50, v70, v42, v50
    v_dot2_f32_bf16 v51, v70, v46, v51
    v_dot2_f32_bf16 v48, v67, v43, v48
    v_dot2_f32_bf16 v49, v67, v47, v49
    v_dot2_f32_bf16 v50, v71, v43, v50
    v_dot2_f32_bf16 v51, v71, v47, v51
    v_add_f32_dpp v48, v48, v48 row_ror:8 row_mask:0xf bank_mask:0xf
    v_add_f32_dpp v49, v49, v49 row_ror:8 row_mask:0xf bank_mask:0xf
    v_add_f32_dpp v50, v50, v50 row_ror:8 row_mask:0xf bank_mask:0xf
    v_add_f32_dpp v51, v51, v51 row_ror:8 row_mask:0xf bank_mask:0xf
    v_add_f32_dpp v48, v48, v48 row_ror:4 row_mask:0xf bank_mask:0xf
    v_add_f32_dpp v49, v49, v49 row_ror:4 row_mask:0xf bank_mask:0xf
    v_add_f32_dpp v50, v50, v50 row_ror:4 row_mask:0xf bank_mask:0xf
    v_add_f32_dpp v51, v51, v51 row_ror:4 row_mask:0xf bank_mask:0xf
    v_add_f32_dpp v48, v48, v48 row_ror:2 row_mask:0xf bank_mask:0xf
    v_add_f32_dpp v49, v49, v49 row_ror:2 row_mask:0xf bank_mask:0xf
    v_add_f32_dpp v50, v50, v50 row_ror:2 row_mask:0xf bank_mask:0xf
    v_add_f32_dpp v51, v51, v51 row_ror:2 row_mask:0xf bank_mask:0xf
    v_add_f32_dpp v48, v48, v48 row_ror:1 row_mask:0xf bank_mask:0xf
    v_add_f32_dpp v49, v49, v49 row_ror:1 row_mask:0xf bank_mask:0xf
    v_add_f32_dpp v50, v50, v50 row_ror:1 row_mask:0xf bank_mask:0xf
    v_add_f32_dpp v51, v51, v51 row_ror:1 row_mask:0xf bank_mask:0xf
    v_dot2_f32_bf16 v52, v72, v40, 0
    v_dot2_f32_bf16 v53, v72, v44, 0
    v_dot2_f32_bf16 v54, v76, v40, 0
    v_dot2_f32_bf16 v55, v76, v44, 0
    v_dot2_f32_bf16 v52, v73, v41, v52
    v_dot2_f32_bf16 v53, v73, v45, v53
    v_dot2_f32_bf16 v54, v77, v41, v54
    v_dot2_f32_bf16 v55, v77, v45, v55
    v_dot2_f32_bf16 v52, v74, v42, v52
    v_dot2_f32_bf16 v53, v74, v46, v53
    v_dot2_f32_bf16 v54, v78, v42, v54
    v_dot2_f32_bf16 v55, v78, v46, v55
    v_dot2_f32_bf16 v52, v75, v43, v52
    v_dot2_f32_bf16 v53, v75, v47, v53
    v_dot2_f32_bf16 v54, v79, v43, v54
    v_dot2_f32_bf16 v55, v79, v47, v55
    v_add_f32_dpp v52, v52, v52 row_ror:8 row_mask:0xf bank_mask:0xf
    v_add_f32_dpp v53, v53, v53 row_ror:8 row_mask:0xf bank_mask:0xf
    v_add_f32_dpp v54, v54, v54 row_ror:8 row_mask:0xf bank_mask:0xf
    v_add_f32_dpp v55, v55, v55 row_ror:8 row_mask:0xf bank_mask:0xf
    v_add_f32_dpp v52, v52, v52 row_ror:4 row_mask:0xf bank_mask:0xf
    v_add_f32_dpp v53, v53, v53 row_ror:4 row_mask:0xf bank_mask:0xf
    v_add_f32_dpp v54, v54, v54 row_ror:4 row_mask:0xf bank_mask:0xf
    v_add_f32_dpp v55, v55, v55 row_ror:4 row_mask:0xf bank_mask:0xf
    v_add_f32_dpp v52, v52, v52 row_ror:2 row_mask:0xf bank_mask:0xf
    v_add_f32_dpp v53, v53, v53 row_ror:2 row_mask:0xf bank_mask:0xf
    v_add_f32_dpp v54, v54, v54 row_ror:2 row_mask:0xf bank_mask:0xf
    v_add_f32_dpp v55, v55, v55 row_ror:2 row_mask:0xf bank_mask:0xf
    v_add_f32_dpp v52, v52, v52 row_ror:1 row_mask:0xf bank_mask:0xf
    v_add_f32_dpp v53, v53, v53 row_ror:1 row_mask:0xf bank_mask:0xf
    v_add_f32_dpp v54, v54, v54 row_ror:1 row_mask:0xf bank_mask:0xf
    v_add_f32_dpp v55, v55, v55 row_ror:1 row_mask:0xf bank_mask:0xf
    v_dot2_f32_bf16 v56, v80, v40, 0
    v_dot2_f32_bf16 v57, v80, v44, 0
    v_dot2_f32_bf16 v58, v84, v40, 0
    v_dot2_f32_bf16 v59, v84, v44, 0
    v_dot2_f32_bf16 v56, v81, v41, v56
    v_dot2_f32_bf16 v57, v81, v45, v57
    v_dot2_f32_bf16 v58, v85, v41, v58
    v_dot2_f32_bf16 v59, v85, v45, v59
    v_dot2_f32_bf16 v56, v82, v42, v56
    v_dot2_f32_bf16 v57, v82, v46, v57
    v_dot2_f32_bf16 v58, v86, v42, v58
    v_dot2_f32_bf16 v59, v86, v46, v59
    v_dot2_f32_bf16 v56, v83, v43, v56
    v_dot2_f32_bf16 v57, v83, v47, v57
    v_dot2_f32_bf16 v58, v87, v43, v58
    v_dot2_f32_bf16 v59, v87, v47, v59
    v_add_f32_dpp v56, v56, v56 row_ror:8 row_mask:0xf bank_mask:0xf
    v_add_f32_dpp v57, v57, v57 row_ror:8 row_mask:0xf bank_mask:0xf
    v_add_f32_dpp v58, v58, v58 row_ror:8 row_mask:0xf bank_mask:0xf
    v_add_f32_dpp v59, v59, v59 row_ror:8 row_mask:0xf bank_mask:0xf
    v_add_f32_dpp v56, v56, v56 row_ror:4 row_mask:0xf bank_mask:0xf
    v_add_f32_dpp v57, v57, v57 row_ror:4 row_mask:0xf bank_mask:0xf
    v_add_f32_dpp v58, v58, v58 row_ror:4 row_mask:0xf bank_mask:0xf
    v_add_f32_dpp v59, v59, v59 row_ror:4 row_mask:0xf bank_mask:0xf
    v_add_f32_dpp v56, v56, v56 row_ror:2 row_mask:0xf bank_mask:0xf
    v_add_f32_dpp v57, v57, v57 row_ror:2 row_mask:0xf bank_mask:0xf
    v_add_f32_dpp v58, v58, v58 row_ror:2 row_mask:0xf bank_mask:0xf
    v_add_f32_dpp v59, v59, v59 row_ror:2 row_mask:0xf bank_mask:0xf
    v_add_f32_dpp v56, v56, v56 row_ror:1 row_mask:0xf bank_mask:0xf
    v_add_f32_dpp v57, v57, v57 row_ror:1 row_mask:0xf bank_mask:0xf
    v_add_f32_dpp v58, v58, v58 row_ror:1 row_mask:0xf bank_mask:0xf
    v_add_f32_dpp v59, v59, v59 row_ror:1 row_mask:0xf bank_mask:0xf
    v_dot2_f32_bf16 v60, v88, v40, 0
    v_dot2_f32_bf16 v61, v88, v44, 0
    v_dot2_f32_bf16 v62, v92, v40, 0
    v_dot2_f32_bf16 v63, v92, v44, 0
    v_dot2_f32_bf16 v60, v89, v41, v60
    v_dot2_f32_bf16 v61, v89, v45, v61
    v_dot2_f32_bf16 v62, v93, v41, v62
    v_dot2_f32_bf16 v63, v93, v45, v63
    v_dot2_f32_bf16 v60, v90, v42, v60
    v_dot2_f32_bf16 v61, v90, v46, v61
    v_dot2_f32_bf16 v62, v94, v42, v62
    v_dot2_f32_bf16 v63, v94, v46, v63
    v_dot2_f32_bf16 v60, v91, v43, v60
    v_dot2_f32_bf16 v61, v91, v47, v61
    v_dot2_f32_bf16 v62, v95, v43, v62
    v_dot2_f32_bf16 v63, v95, v47, v63
    v_add_f32_dpp v60, v60, v60 row_ror:8 row_mask:0xf bank_mask:0xf
    v_add_f32_dpp v61, v61, v61 row_ror:8 row_mask:0xf bank_mask:0xf
    v_add_f32_dpp v62, v62, v62 row_ror:8 row_mask:0xf bank_mask:0xf
    v_add_f32_dpp v63, v63, v63 row_ror:8 row_mask:0xf bank_mask:0xf
    v_add_f32_dpp v60, v60, v60 row_ror:4 row_mask:0xf bank_mask:0xf
    v_add_f32_dpp v61, v61, v61 row_ror:4 row_mask:0xf bank_mask:0xf
    v_add_f32_dpp v62, v62, v62 row_ror:4 row_mask:0xf bank_mask:0xf
    v_add_f32_dpp v63, v63, v63 row_ror:4 row_mask:0xf bank_mask:0xf
    v_add_f32_dpp v60, v60, v60 row_ror:2 row_mask:0xf bank_mask:0xf
    v_add_f32_dpp v61, v61, v61 row_ror:2 row_mask:0xf bank_mask:0xf
    v_add_f32_dpp v62, v62, v62 row_ror:2 row_mask:0xf bank_mask:0xf
    v_add_f32_dpp v63, v63, v63 row_ror:2 row_mask:0xf bank_mask:0xf
    v_add_f32_dpp v60, v60, v60 row_ror:1 row_mask:0xf bank_mask:0xf
    v_add_f32_dpp v61, v61, v61 row_ror:1 row_mask:0xf bank_mask:0xf
    v_add_f32_dpp v62, v62, v62 row_ror:1 row_mask:0xf bank_mask:0xf
    v_add_f32_dpp v63, v63, v63 row_ror:1 row_mask:0xf bank_mask:0xf
    v_cmp_eq_u32 vcc, 0, v3
    s_and_saveexec_b64 s[14:15], vcc
    v_cvt_pk_bf16_f32 v24, v48, v48
    v_lshlrev_b32 v25, 16, v24
    v_sub_f32 v25, v48, v25
    v_cvt_pk_bf16_f32 v25, v25, v25
    buffer_store_short v24, v5, s[64:67], s90 offen offset:0 sc1
    buffer_store_short v25, v5, s[64:67], s91 offen offset:0 sc1
    s_nop 0
    v_cvt_pk_bf16_f32 v24, v49, v49
    v_lshlrev_b32 v25, 16, v24
    v_sub_f32 v25, v49, v25
    v_cvt_pk_bf16_f32 v25, v25, v25
    buffer_store_short v24, v5, s[64:67], s92 offen offset:0 sc1
    buffer_store_short v25, v5, s[64:67], s93 offen offset:0 sc1
    s_nop 0
    v_cvt_pk_bf16_f32 v24, v50, v50
    v_lshlrev_b32 v25, 16, v24
    v_sub_f32 v25, v50, v25
    v_cvt_pk_bf16_f32 v25, v25, v25
    buffer_store_short v24, v5, s[64:67], s90 offen offset:8 sc1
    buffer_store_short v25, v5, s[64:67], s91 offen offset:8 sc1
    s_nop 0
    v_cvt_pk_bf16_f32 v24, v51, v51
    v_lshlrev_b32 v25, 16, v24
    v_sub_f32 v25, v51, v25
    v_cvt_pk_bf16_f32 v25, v25, v25
    buffer_store_short v24, v5, s[64:67], s92 offen offset:8 sc1
    buffer_store_short v25, v5, s[64:67], s93 offen offset:8 sc1
    s_nop 0
    v_cvt_pk_bf16_f32 v24, v52, v52
    v_lshlrev_b32 v25, 16, v24
    v_sub_f32 v25, v52, v25
    v_cvt_pk_bf16_f32 v25, v25, v25
    buffer_store_short v24, v5, s[64:67], s90 offen offset:256 sc1
    buffer_store_short v25, v5, s[64:67], s91 offen offset:256 sc1
    s_nop 0
    v_cvt_pk_bf16_f32 v24, v53, v53
    v_lshlrev_b32 v25, 16, v24
    v_sub_f32 v25, v53, v25
    v_cvt_pk_bf16_f32 v25, v25, v25
    buffer_store_short v24, v5, s[64:67], s92 offen offset:256 sc1
    buffer_store_short v25, v5, s[64:67], s93 offen offset:256 sc1
    s_nop 0
    v_cvt_pk_bf16_f32 v24, v54, v54
    v_lshlrev_b32 v25, 16, v24
    v_sub_f32 v25, v54, v25
    v_cvt_pk_bf16_f32 v25, v25, v25
    buffer_store_short v24, v5, s[64:67], s90 offen offset:264 sc1
    buffer_store_short v25, v5, s[64:67], s91 offen offset:264 sc1
    s_nop 0
    v_cvt_pk_bf16_f32 v24, v55, v55
    v_lshlrev_b32 v25, 16, v24
    v_sub_f32 v25, v55, v25
    v_cvt_pk_bf16_f32 v25, v25, v25
    buffer_store_short v24, v5, s[64:67], s92 offen offset:264 sc1
    buffer_store_short v25, v5, s[64:67], s93 offen offset:264 sc1
    s_nop 0
    v_cvt_pk_bf16_f32 v24, v56, v56
    v_lshlrev_b32 v25, 16, v24
    v_sub_f32 v25, v56, v25
    v_cvt_pk_bf16_f32 v25, v25, v25
    buffer_store_short v24, v5, s[64:67], s90 offen offset:512 sc1
    buffer_store_short v25, v5, s[64:67], s91 offen offset:512 sc1
    s_nop 0
    v_cvt_pk_bf16_f32 v24, v57, v57
    v_lshlrev_b32 v25, 16, v24
    v_sub_f32 v25, v57, v25
    v_cvt_pk_bf16_f32 v25, v25, v25
    buffer_store_short v24, v5, s[64:67], s92 offen offset:512 sc1
    buffer_store_short v25, v5, s[64:67], s93 offen offset:512 sc1
    s_nop 0
    v_cvt_pk_bf16_f32 v24, v58, v58
    v_lshlrev_b32 v25, 16, v24
    v_sub_f32 v25, v58, v25
    v_cvt_pk_bf16_f32 v25, v25, v25
    buffer_store_short v24, v5, s[64:67], s90 offen offset:520 sc1
    buffer_store_short v25, v5, s[64:67], s91 offen offset:520 sc1
    s_nop 0
    v_cvt_pk_bf16_f32 v24, v59, v59
    v_lshlrev_b32 v25, 16, v24
    v_sub_f32 v25, v59, v25
    v_cvt_pk_bf16_f32 v25, v25, v25
    buffer_store_short v24, v5, s[64:67], s92 offen offset:520 sc1
    buffer_store_short v25, v5, s[64:67], s93 offen offset:520 sc1
    s_nop 0
    v_cvt_pk_bf16_f32 v24, v60, v60
    v_lshlrev_b32 v25, 16, v24
    v_sub_f32 v25, v60, v25
    v_cvt_pk_bf16_f32 v25, v25, v25
    buffer_store_short v24, v5, s[64:67], s90 offen offset:768 sc1
    buffer_store_short v25, v5, s[64:67], s91 offen offset:768 sc1
    s_nop 0
    v_cvt_pk_bf16_f32 v24, v61, v61
    v_lshlrev_b32 v25, 16, v24
    v_sub_f32 v25, v61, v25
    v_cvt_pk_bf16_f32 v25, v25, v25
    buffer_store_short v24, v5, s[64:67], s92 offen offset:768 sc1
    buffer_store_short v25, v5, s[64:67], s93 offen offset:768 sc1
    s_nop 0
    v_cvt_pk_bf16_f32 v24, v62, v62
    v_lshlrev_b32 v25, 16, v24
    v_sub_f32 v25, v62, v25
    v_cvt_pk_bf16_f32 v25, v25, v25
    buffer_store_short v24, v5, s[64:67], s90 offen offset:776 sc1
    buffer_store_short v25, v5, s[64:67], s91 offen offset:776 sc1
    s_nop 0
    v_cvt_pk_bf16_f32 v24, v63, v63
    v_lshlrev_b32 v25, 16, v24
    v_sub_f32 v25, v63, v25
    v_cvt_pk_bf16_f32 v25, v25, v25
    buffer_store_short v24, v5, s[64:67], s92 offen offset:776 sc1
    buffer_store_short v25, v5, s[64:67], s93 offen offset:776 sc1
    s_nop 0
    s_mov_b64 exec, s[14:15]
    s_nop 3
    s_waitcnt vmcnt(32)
    v_dot2_f32_bf16 v48, v96, v40, 0
    v_dot2_f32_bf16 v49, v96, v44, 0
    v_dot2_f32_bf16 v50, v100, v40, 0
    v_dot2_f32_bf16 v51, v100, v44, 0
    v_dot2_f32_bf16 v48, v97, v41, v48
    v_dot2_f32_bf16 v49, v97, v45, v49
    v_dot2_f32_bf16 v50, v101, v41, v50
    v_dot2_f32_bf16 v51, v101, v45, v51
    v_dot2_f32_bf16 v48, v98, v42, v48
    v_dot2_f32_bf16 v49, v98, v46, v49
    v_dot2_f32_bf16 v50, v102, v42, v50
    v_dot2_f32_bf16 v51, v102, v46, v51
    v_dot2_f32_bf16 v48, v99, v43, v48
    v_dot2_f32_bf16 v49, v99, v47, v49
    v_dot2_f32_bf16 v50, v103, v43, v50
    v_dot2_f32_bf16 v51, v103, v47, v51
    v_add_f32_dpp v48, v48, v48 row_ror:8 row_mask:0xf bank_mask:0xf
    v_add_f32_dpp v49, v49, v49 row_ror:8 row_mask:0xf bank_mask:0xf
    v_add_f32_dpp v50, v50, v50 row_ror:8 row_mask:0xf bank_mask:0xf
    v_add_f32_dpp v51, v51, v51 row_ror:8 row_mask:0xf bank_mask:0xf
    v_add_f32_dpp v48, v48, v48 row_ror:4 row_mask:0xf bank_mask:0xf
    v_add_f32_dpp v49, v49, v49 row_ror:4 row_mask:0xf bank_mask:0xf
    v_add_f32_dpp v50, v50, v50 row_ror:4 row_mask:0xf bank_mask:0xf
    v_add_f32_dpp v51, v51, v51 row_ror:4 row_mask:0xf bank_mask:0xf
    v_add_f32_dpp v48, v48, v48 row_ror:2 row_mask:0xf bank_mask:0xf
    v_add_f32_dpp v49, v49, v49 row_ror:2 row_mask:0xf bank_mask:0xf
    v_add_f32_dpp v50, v50, v50 row_ror:2 row_mask:0xf bank_mask:0xf
    v_add_f32_dpp v51, v51, v51 row_ror:2 row_mask:0xf bank_mask:0xf
    v_add_f32_dpp v48, v48, v48 row_ror:1 row_mask:0xf bank_mask:0xf
    v_add_f32_dpp v49, v49, v49 row_ror:1 row_mask:0xf bank_mask:0xf
    v_add_f32_dpp v50, v50, v50 row_ror:1 row_mask:0xf bank_mask:0xf
    v_add_f32_dpp v51, v51, v51 row_ror:1 row_mask:0xf bank_mask:0xf
    v_dot2_f32_bf16 v52, v104, v40, 0
    v_dot2_f32_bf16 v53, v104, v44, 0
    v_dot2_f32_bf16 v54, v108, v40, 0
    v_dot2_f32_bf16 v55, v108, v44, 0
    v_dot2_f32_bf16 v52, v105, v41, v52
    v_dot2_f32_bf16 v53, v105, v45, v53
    v_dot2_f32_bf16 v54, v109, v41, v54
    v_dot2_f32_bf16 v55, v109, v45, v55
    v_dot2_f32_bf16 v52, v106, v42, v52
    v_dot2_f32_bf16 v53, v106, v46, v53
    v_dot2_f32_bf16 v54, v110, v42, v54
    v_dot2_f32_bf16 v55, v110, v46, v55
    v_dot2_f32_bf16 v52, v107, v43, v52
    v_dot2_f32_bf16 v53, v107, v47, v53
    v_dot2_f32_bf16 v54, v111, v43, v54
    v_dot2_f32_bf16 v55, v111, v47, v55
    v_add_f32_dpp v52, v52, v52 row_ror:8 row_mask:0xf bank_mask:0xf
    v_add_f32_dpp v53, v53, v53 row_ror:8 row_mask:0xf bank_mask:0xf
    v_add_f32_dpp v54, v54, v54 row_ror:8 row_mask:0xf bank_mask:0xf
    v_add_f32_dpp v55, v55, v55 row_ror:8 row_mask:0xf bank_mask:0xf
    v_add_f32_dpp v52, v52, v52 row_ror:4 row_mask:0xf bank_mask:0xf
    v_add_f32_dpp v53, v53, v53 row_ror:4 row_mask:0xf bank_mask:0xf
    v_add_f32_dpp v54, v54, v54 row_ror:4 row_mask:0xf bank_mask:0xf
    v_add_f32_dpp v55, v55, v55 row_ror:4 row_mask:0xf bank_mask:0xf
    v_add_f32_dpp v52, v52, v52 row_ror:2 row_mask:0xf bank_mask:0xf
    v_add_f32_dpp v53, v53, v53 row_ror:2 row_mask:0xf bank_mask:0xf
    v_add_f32_dpp v54, v54, v54 row_ror:2 row_mask:0xf bank_mask:0xf
    v_add_f32_dpp v55, v55, v55 row_ror:2 row_mask:0xf bank_mask:0xf
    v_add_f32_dpp v52, v52, v52 row_ror:1 row_mask:0xf bank_mask:0xf
    v_add_f32_dpp v53, v53, v53 row_ror:1 row_mask:0xf bank_mask:0xf
    v_add_f32_dpp v54, v54, v54 row_ror:1 row_mask:0xf bank_mask:0xf
    v_add_f32_dpp v55, v55, v55 row_ror:1 row_mask:0xf bank_mask:0xf
    v_dot2_f32_bf16 v56, v112, v40, 0
    v_dot2_f32_bf16 v57, v112, v44, 0
    v_dot2_f32_bf16 v58, v116, v40, 0
    v_dot2_f32_bf16 v59, v116, v44, 0
    v_dot2_f32_bf16 v56, v113, v41, v56
    v_dot2_f32_bf16 v57, v113, v45, v57
    v_dot2_f32_bf16 v58, v117, v41, v58
    v_dot2_f32_bf16 v59, v117, v45, v59
    v_dot2_f32_bf16 v56, v114, v42, v56
    v_dot2_f32_bf16 v57, v114, v46, v57
    v_dot2_f32_bf16 v58, v118, v42, v58
    v_dot2_f32_bf16 v59, v118, v46, v59
    v_dot2_f32_bf16 v56, v115, v43, v56
    v_dot2_f32_bf16 v57, v115, v47, v57
    v_dot2_f32_bf16 v58, v119, v43, v58
    v_dot2_f32_bf16 v59, v119, v47, v59
    v_add_f32_dpp v56, v56, v56 row_ror:8 row_mask:0xf bank_mask:0xf
    v_add_f32_dpp v57, v57, v57 row_ror:8 row_mask:0xf bank_mask:0xf
    v_add_f32_dpp v58, v58, v58 row_ror:8 row_mask:0xf bank_mask:0xf
    v_add_f32_dpp v59, v59, v59 row_ror:8 row_mask:0xf bank_mask:0xf
    v_add_f32_dpp v56, v56, v56 row_ror:4 row_mask:0xf bank_mask:0xf
    v_add_f32_dpp v57, v57, v57 row_ror:4 row_mask:0xf bank_mask:0xf
    v_add_f32_dpp v58, v58, v58 row_ror:4 row_mask:0xf bank_mask:0xf
    v_add_f32_dpp v59, v59, v59 row_ror:4 row_mask:0xf bank_mask:0xf
    v_add_f32_dpp v56, v56, v56 row_ror:2 row_mask:0xf bank_mask:0xf
    v_add_f32_dpp v57, v57, v57 row_ror:2 row_mask:0xf bank_mask:0xf
    v_add_f32_dpp v58, v58, v58 row_ror:2 row_mask:0xf bank_mask:0xf
    v_add_f32_dpp v59, v59, v59 row_ror:2 row_mask:0xf bank_mask:0xf
    v_add_f32_dpp v56, v56, v56 row_ror:1 row_mask:0xf bank_mask:0xf
    v_add_f32_dpp v57, v57, v57 row_ror:1 row_mask:0xf bank_mask:0xf
    v_add_f32_dpp v58, v58, v58 row_ror:1 row_mask:0xf bank_mask:0xf
    v_add_f32_dpp v59, v59, v59 row_ror:1 row_mask:0xf bank_mask:0xf
    v_dot2_f32_bf16 v60, v120, v40, 0
    v_dot2_f32_bf16 v61, v120, v44, 0
    v_dot2_f32_bf16 v62, v124, v40, 0
    v_dot2_f32_bf16 v63, v124, v44, 0
    v_dot2_f32_bf16 v60, v121, v41, v60
    v_dot2_f32_bf16 v61, v121, v45, v61
    v_dot2_f32_bf16 v62, v125, v41, v62
    v_dot2_f32_bf16 v63, v125, v45, v63
    v_dot2_f32_bf16 v60, v122, v42, v60
    v_dot2_f32_bf16 v61, v122, v46, v61
    v_dot2_f32_bf16 v62, v126, v42, v62
    v_dot2_f32_bf16 v63, v126, v46, v63
    v_dot2_f32_bf16 v60, v123, v43, v60
    v_dot2_f32_bf16 v61, v123, v47, v61
    v_dot2_f32_bf16 v62, v127, v43, v62
    v_dot2_f32_bf16 v63, v127, v47, v63
    v_add_f32_dpp v60, v60, v60 row_ror:8 row_mask:0xf bank_mask:0xf
    v_add_f32_dpp v61, v61, v61 row_ror:8 row_mask:0xf bank_mask:0xf
    v_add_f32_dpp v62, v62, v62 row_ror:8 row_mask:0xf bank_mask:0xf
    v_add_f32_dpp v63, v63, v63 row_ror:8 row_mask:0xf bank_mask:0xf
    v_add_f32_dpp v60, v60, v60 row_ror:4 row_mask:0xf bank_mask:0xf
    v_add_f32_dpp v61, v61, v61 row_ror:4 row_mask:0xf bank_mask:0xf
    v_add_f32_dpp v62, v62, v62 row_ror:4 row_mask:0xf bank_mask:0xf
    v_add_f32_dpp v63, v63, v63 row_ror:4 row_mask:0xf bank_mask:0xf
    v_add_f32_dpp v60, v60, v60 row_ror:2 row_mask:0xf bank_mask:0xf
    v_add_f32_dpp v61, v61, v61 row_ror:2 row_mask:0xf bank_mask:0xf
    v_add_f32_dpp v62, v62, v62 row_ror:2 row_mask:0xf bank_mask:0xf
    v_add_f32_dpp v63, v63, v63 row_ror:2 row_mask:0xf bank_mask:0xf
    v_add_f32_dpp v60, v60, v60 row_ror:1 row_mask:0xf bank_mask:0xf
    v_add_f32_dpp v61, v61, v61 row_ror:1 row_mask:0xf bank_mask:0xf
    v_add_f32_dpp v62, v62, v62 row_ror:1 row_mask:0xf bank_mask:0xf
    v_add_f32_dpp v63, v63, v63 row_ror:1 row_mask:0xf bank_mask:0xf
    v_cmp_eq_u32 vcc, 0, v3
    s_and_saveexec_b64 s[14:15], vcc
    v_cvt_pk_bf16_f32 v24, v48, v48
    v_lshlrev_b32 v25, 16, v24
    v_sub_f32 v25, v48, v25
    v_cvt_pk_bf16_f32 v25, v25, v25
    buffer_store_short v24, v5, s[64:67], s90 offen offset:1024 sc1
    buffer_store_short v25, v5, s[64:67], s91 offen offset:1024 sc1
    s_nop 0
    v_cvt_pk_bf16_f32 v24, v49, v49
    v_lshlrev_b32 v25, 16, v24
    v_sub_f32 v25, v49, v25
    v_cvt_pk_bf16_f32 v25, v25, v25
    buffer_store_short v24, v5, s[64:67], s92 offen offset:1024 sc1
    buffer_store_short v25, v5, s[64:67], s93 offen offset:1024 sc1
    s_nop 0
    v_cvt_pk_bf16_f32 v24, v50, v50
    v_lshlrev_b32 v25, 16, v24
    v_sub_f32 v25, v50, v25
    v_cvt_pk_bf16_f32 v25, v25, v25
    buffer_store_short v24, v5, s[64:67], s90 offen offset:1032 sc1
    buffer_store_short v25, v5, s[64:67], s91 offen offset:1032 sc1
    s_nop 0
    v_cvt_pk_bf16_f32 v24, v51, v51
    v_lshlrev_b32 v25, 16, v24
    v_sub_f32 v25, v51, v25
    v_cvt_pk_bf16_f32 v25, v25, v25
    buffer_store_short v24, v5, s[64:67], s92 offen offset:1032 sc1
    buffer_store_short v25, v5, s[64:67], s93 offen offset:1032 sc1
    s_nop 0
    v_cvt_pk_bf16_f32 v24, v52, v52
    v_lshlrev_b32 v25, 16, v24
    v_sub_f32 v25, v52, v25
    v_cvt_pk_bf16_f32 v25, v25, v25
    buffer_store_short v24, v5, s[64:67], s90 offen offset:1280 sc1
    buffer_store_short v25, v5, s[64:67], s91 offen offset:1280 sc1
    s_nop 0
    v_cvt_pk_bf16_f32 v24, v53, v53
    v_lshlrev_b32 v25, 16, v24
    v_sub_f32 v25, v53, v25
    v_cvt_pk_bf16_f32 v25, v25, v25
    buffer_store_short v24, v5, s[64:67], s92 offen offset:1280 sc1
    buffer_store_short v25, v5, s[64:67], s93 offen offset:1280 sc1
    s_nop 0
    v_cvt_pk_bf16_f32 v24, v54, v54
    v_lshlrev_b32 v25, 16, v24
    v_sub_f32 v25, v54, v25
    v_cvt_pk_bf16_f32 v25, v25, v25
    buffer_store_short v24, v5, s[64:67], s90 offen offset:1288 sc1
    buffer_store_short v25, v5, s[64:67], s91 offen offset:1288 sc1
    s_nop 0
    v_cvt_pk_bf16_f32 v24, v55, v55
    v_lshlrev_b32 v25, 16, v24
    v_sub_f32 v25, v55, v25
    v_cvt_pk_bf16_f32 v25, v25, v25
    buffer_store_short v24, v5, s[64:67], s92 offen offset:1288 sc1
    buffer_store_short v25, v5, s[64:67], s93 offen offset:1288 sc1
    s_nop 0
    v_cvt_pk_bf16_f32 v24, v56, v56
    v_lshlrev_b32 v25, 16, v24
    v_sub_f32 v25, v56, v25
    v_cvt_pk_bf16_f32 v25, v25, v25
    buffer_store_short v24, v5, s[64:67], s90 offen offset:1536 sc1
    buffer_store_short v25, v5, s[64:67], s91 offen offset:1536 sc1
    s_nop 0
    v_cvt_pk_bf16_f32 v24, v57, v57
    v_lshlrev_b32 v25, 16, v24
    v_sub_f32 v25, v57, v25
    v_cvt_pk_bf16_f32 v25, v25, v25
    buffer_store_short v24, v5, s[64:67], s92 offen offset:1536 sc1
    buffer_store_short v25, v5, s[64:67], s93 offen offset:1536 sc1
    s_nop 0
    v_cvt_pk_bf16_f32 v24, v58, v58
    v_lshlrev_b32 v25, 16, v24
    v_sub_f32 v25, v58, v25
    v_cvt_pk_bf16_f32 v25, v25, v25
    buffer_store_short v24, v5, s[64:67], s90 offen offset:1544 sc1
    buffer_store_short v25, v5, s[64:67], s91 offen offset:1544 sc1
    s_nop 0
    v_cvt_pk_bf16_f32 v24, v59, v59
    v_lshlrev_b32 v25, 16, v24
    v_sub_f32 v25, v59, v25
    v_cvt_pk_bf16_f32 v25, v25, v25
    buffer_store_short v24, v5, s[64:67], s92 offen offset:1544 sc1
    buffer_store_short v25, v5, s[64:67], s93 offen offset:1544 sc1
    s_nop 0
    v_cvt_pk_bf16_f32 v24, v60, v60
    v_lshlrev_b32 v25, 16, v24
    v_sub_f32 v25, v60, v25
    v_cvt_pk_bf16_f32 v25, v25, v25
    buffer_store_short v24, v5, s[64:67], s90 offen offset:1792 sc1
    buffer_store_short v25, v5, s[64:67], s91 offen offset:1792 sc1
    s_nop 0
    v_cvt_pk_bf16_f32 v24, v61, v61
    v_lshlrev_b32 v25, 16, v24
    v_sub_f32 v25, v61, v25
    v_cvt_pk_bf16_f32 v25, v25, v25
    buffer_store_short v24, v5, s[64:67], s92 offen offset:1792 sc1
    buffer_store_short v25, v5, s[64:67], s93 offen offset:1792 sc1
    s_nop 0
    v_cvt_pk_bf16_f32 v24, v62, v62
    v_lshlrev_b32 v25, 16, v24
    v_sub_f32 v25, v62, v25
    v_cvt_pk_bf16_f32 v25, v25, v25
    buffer_store_short v24, v5, s[64:67], s90 offen offset:1800 sc1
    buffer_store_short v25, v5, s[64:67], s91 offen offset:1800 sc1
    s_nop 0
    v_cvt_pk_bf16_f32 v24, v63, v63
    v_lshlrev_b32 v25, 16, v24
    v_sub_f32 v25, v63, v25
    v_cvt_pk_bf16_f32 v25, v25, v25
    buffer_store_short v24, v5, s[64:67], s92 offen offset:1800 sc1
    buffer_store_short v25, v5, s[64:67], s93 offen offset:1800 sc1
    s_nop 0
    s_mov_b64 exec, s[14:15]
    s_nop 3
    s_waitcnt vmcnt(0)
    s_barrier
    s_cmp_eq_u32 s7, 0
    s_cbranch_scc0 BAR_arr0
    v_mov_b32 v24, 1
    v_mov_b32 v25, 0
    s_mov_b64 exec, 1
    buffer_atomic_add v24, v25, s[84:87], 0 offen sc1
    s_mov_b64 exec, -1
BAR_arr0:
    s_lshr_b32 s5, s3, 5
    s_and_b32 s6, s3, 31
    s_lshl_b32 s11, s5, 12
    s_lshl_b32 s12, s6, 7
    s_add_u32 s11, s11, s12
    s_lshl_b32 s12, s7, 5
    s_add_u32 s11, s11, s12
    s_lshl_b32 s88, s11, 10
    s_mul_i32 s11, s7, 33280
    v_add_u32 v5, s11, v4
    buffer_load_dwordx4 v[64:67], v4, s[56:59], s88 offen offset:0
    buffer_load_dwordx4 v[68:71], v4, s[56:59], s88 offen offset:1024
    buffer_load_dwordx4 v[72:75], v4, s[56:59], s88 offen offset:2048
    buffer_load_dwordx4 v[76:79], v4, s[56:59], s88 offen offset:3072
    s_add_u32 s88, s88, 4096
    buffer_load_dwordx4 v[80:83], v4, s[56:59], s88 offen offset:0
    buffer_load_dwordx4 v[84:87], v4, s[56:59], s88 offen offset:1024
    buffer_load_dwordx4 v[88:91], v4, s[56:59], s88 offen offset:2048
    buffer_load_dwordx4 v[92:95], v4, s[56:59], s88 offen offset:3072
    s_add_u32 s88, s88, 4096
    buffer_load_dwordx4 v[96:99], v4, s[56:59], s88 offen offset:0
    buffer_load_dwordx4 v[100:103], v4, s[56:59], s88 offen offset:1024
    buffer_load_dwordx4 v[104:107], v4, s[56:59], s88 offen offset:2048
    buffer_load_dwordx4 v[108:111], v4, s[56:59], s88 offen offset:3072
    s_add_u32 s88, s88, 4096
    buffer_load_dwordx4 v[112:115], v4, s[56:59], s88 offen offset:0
    buffer_load_dwordx4 v[116:119], v4, s[56:59], s88 offen offset:1024
    buffer_load_dwordx4 v[120:123], v4, s[56:59], s88 offen offset:2048
    buffer_load_dwordx4 v[124:127], v4, s[56:59], s88 offen offset:3072
    s_add_u32 s88, s88, 4096
    buffer_load_dwordx4 v[128:131], v4, s[56:59], s88 offen offset:0
    buffer_load_dwordx4 v[132:135], v4, s[56:59], s88 offen offset:1024
    buffer_load_dwordx4 v[136:139], v4, s[56:59], s88 offen offset:2048
    buffer_load_dwordx4 v[140:143], v4, s[56:59], s88 offen offset:3072
    s_add_u32 s88, s88, 4096
    buffer_load_dwordx4 v[144:147], v4, s[56:59], s88 offen offset:0
    buffer_load_dwordx4 v[148:151], v4, s[56:59], s88 offen offset:1024
    buffer_load_dwordx4 v[152:155], v4, s[56:59], s88 offen offset:2048
    buffer_load_dwordx4 v[156:159], v4, s[56:59], s88 offen offset:3072
    s_add_u32 s88, s88, 4096
    buffer_load_dwordx4 v[160:163], v4, s[56:59], s88 offen offset:0
    buffer_load_dwordx4 v[164:167], v4, s[56:59], s88 offen offset:1024
    buffer_load_dwordx4 v[168:171], v4, s[56:59], s88 offen offset:2048
    buffer_load_dwordx4 v[172:175], v4, s[56:59], s88 offen offset:3072
    s_add_u32 s88, s88, 4096
    buffer_load_dwordx4 v[176:179], v4, s[56:59], s88 offen offset:0
    buffer_load_dwordx4 v[180:183], v4, s[56:59], s88 offen offset:1024
    buffer_load_dwordx4 v[184:187], v4, s[56:59], s88 offen offset:2048
    buffer_load_dwordx4 v[188:191], v4, s[56:59], s88 offen offset:3072
    s_add_u32 s88, s88, 4096
    s_waitcnt vmcnt(16)
    ds_write_b128 v5, v[64:67] offset:12800
    ds_write_b128 v5, v[68:71] offset:13840
    ds_write_b128 v5, v[72:75] offset:14880
    ds_write_b128 v5, v[76:79] offset:15920
    ds_write_b128 v5, v[80:83] offset:16960
    ds_write_b128 v5, v[84:87] offset:18000
    ds_write_b128 v5, v[88:91] offset:19040
    ds_write_b128 v5, v[92:95] offset:20080
    ds_write_b128 v5, v[96:99] offset:21120
    ds_write_b128 v5, v[100:103] offset:22160
    ds_write_b128 v5, v[104:107] offset:23200
    ds_write_b128 v5, v[108:111] offset:24240
    ds_write_b128 v5, v[112:115] offset:25280
    ds_write_b128 v5, v[116:119] offset:26320
    ds_write_b128 v5, v[120:123] offset:27360
    ds_write_b128 v5, v[124:127] offset:28400
    s_waitcnt vmcnt(0)
    ds_write_b128 v5, v[128:131] offset:29440
    ds_write_b128 v5, v[132:135] offset:30480
    ds_write_b128 v5, v[136:139] offset:31520
    ds_write_b128 v5, v[140:143] offset:32560
    ds_write_b128 v5, v[144:147] offset:33600
    ds_write_b128 v5, v[148:151] offset:34640
    ds_write_b128 v5, v[152:155] offset:35680
    ds_write_b128 v5, v[156:159] offset:36720
    ds_write_b128 v5, v[160:163] offset:37760
    ds_write_b128 v5, v[164:167] offset:38800
    ds_write_b128 v5, v[168:171] offset:39840
    ds_write_b128 v5, v[172:175] offset:40880
    ds_write_b128 v5, v[176:179] offset:41920
    ds_write_b128 v5, v[180:183] offset:42960
    ds_write_b128 v5, v[184:187] offset:44000
    ds_write_b128 v5, v[188:191] offset:45040
    s_waitcnt lgkmcnt(0)
    s_cmp_eq_u32 s7, 0
    s_cbranch_scc0 BAR_done0
    v_mov_b32 v25, 0
    s_mov_b32 s13, 0
BAR_poll0:
    buffer_load_dword v24, v25, s[84:87], 0 offen sc1
    s_waitcnt vmcnt(0)
    v_readfirstlane_b32 s11, v24
    s_nop 3
    s_cmp_ge_u32 s11, 64
    s_cbranch_scc1 BAR_done0
    s_sleep 1
    s_add_u32 s13, s13, 1
    s_cmp_lt_u32 s13, 0x40000
    s_cbranch_scc1 BAR_poll0
BAR_done0:
    s_barrier
    s_lshl_b32 s11, s5, 16
    s_add_u32 s89, s11, 0x100000
    s_add_u32 s90, s11, 0x104000
    s_add_u32 s91, s11, 0x108000
    s_add_u32 s92, s11, 0x10c000
    buffer_load_dwordx4 v[64:67], v4, s[64:67], s89 offen offset:0 sc1
    buffer_load_dwordx4 v[68:71], v4, s[64:67], s90 offen offset:0 sc1
    buffer_load_dwordx4 v[72:75], v4, s[64:67], s91 offen offset:0 sc1
    buffer_load_dwordx4 v[76:79], v4, s[64:67], s92 offen offset:0 sc1
    buffer_load_dwordx4 v[80:83], v4, s[64:67], s89 offen offset:1024 sc1
    buffer_load_dwordx4 v[84:87], v4, s[64:67], s90 offen offset:1024 sc1
    buffer_load_dwordx4 v[88:91], v4, s[64:67], s91 offen offset:1024 sc1
    buffer_load_dwordx4 v[92:95], v4, s[64:67], s92 offen offset:1024 sc1
    s_add_u32 s89, s89, 2048
    s_add_u32 s90, s90, 2048
    s_add_u32 s91, s91, 2048
    s_add_u32 s92, s92, 2048
    buffer_load_dwordx4 v[96:99], v4, s[64:67], s89 offen offset:0 sc1
    buffer_load_dwordx4 v[100:103], v4, s[64:67], s90 offen offset:0 sc1
    buffer_load_dwordx4 v[104:107], v4, s[64:67], s91 offen offset:0 sc1
    buffer_load_dwordx4 v[108:111], v4, s[64:67], s92 offen offset:0 sc1
    buffer_load_dwordx4 v[112:115], v4, s[64:67], s89 offen offset:1024 sc1
    buffer_load_dwordx4 v[116:119], v4, s[64:67], s90 offen offset:1024 sc1
    buffer_load_dwordx4 v[120:123], v4, s[64:67], s91 offen offset:1024 sc1
    buffer_load_dwordx4 v[124:127], v4, s[64:67], s92 offen offset:1024 sc1
    s_add_u32 s89, s89, 2048
    s_add_u32 s90, s90, 2048
    s_add_u32 s91, s91, 2048
    s_add_u32 s92, s92, 2048
    buffer_load_dwordx4 v[128:131], v4, s[64:67], s89 offen offset:0 sc1
    buffer_load_dwordx4 v[132:135], v4, s[64:67], s90 offen offset:0 sc1
    buffer_load_dwordx4 v[136:139], v4, s[64:67], s91 offen offset:0 sc1
    buffer_load_dwordx4 v[140:143], v4, s[64:67], s92 offen offset:0 sc1
    buffer_load_dwordx4 v[144:147], v4, s[64:67], s89 offen offset:1024 sc1
    buffer_load_dwordx4 v[148:151], v4, s[64:67], s90 offen offset:1024 sc1
    buffer_load_dwordx4 v[152:155], v4, s[64:67], s91 offen offset:1024 sc1
    buffer_load_dwordx4 v[156:159], v4, s[64:67], s92 offen offset:1024 sc1
    s_add_u32 s89, s89, 2048
    s_add_u32 s90, s90, 2048
    s_add_u32 s91, s91, 2048
    s_add_u32 s92, s92, 2048
    buffer_load_dwordx4 v[160:163], v4, s[64:67], s89 offen offset:0 sc1
    buffer_load_dwordx4 v[164:167], v4, s[64:67], s90 offen offset:0 sc1
    buffer_load_dwordx4 v[168:171], v4, s[64:67], s91 offen offset:0 sc1
    buffer_load_dwordx4 v[172:175], v4, s[64:67], s92 offen offset:0 sc1
    buffer_load_dwordx4 v[176:179], v4, s[64:67], s89 offen offset:1024 sc1
    buffer_load_dwordx4 v[180:183], v4, s[64:67], s90 offen offset:1024 sc1
    buffer_load_dwordx4 v[184:187], v4, s[64:67], s91 offen offset:1024 sc1
    buffer_load_dwordx4 v[188:191], v4, s[64:67], s92 offen offset:1024 sc1
    s_add_u32 s89, s89, 2048
    s_add_u32 s90, s90, 2048
    s_add_u32 s91, s91, 2048
    s_add_u32 s92, s92, 2048
    s_waitcnt lgkmcnt(0)
    s_barrier
    v_mul_u32_u24 v6, 1040, v3
    v_lshl_add_u32 v6, v2, 4, v6
    s_mul_i32 s11, s7, 33280
    v_add_u32 v6, s11, v6
    v_mov_b32 v48, 0
    v_mov_b32 v49, 0
    v_mov_b32 v50, 0
    v_mov_b32 v51, 0
    v_mov_b32 v52, 0
    v_mov_b32 v53, 0
    v_mov_b32 v54, 0
    v_mov_b32 v55, 0
    v_mov_b32 v56, 0
    v_mov_b32 v57, 0
    v_mov_b32 v58, 0
    v_mov_b32 v59, 0
    v_mov_b32 v60, 0
    v_mov_b32 v61, 0
    v_mov_b32 v62, 0
    v_mov_b32 v63, 0
    ds_read_b128 v[192:195], v6 offset:12800
    ds_read_b128 v[196:199], v6 offset:29440
    ds_read_b128 v[200:203], v6 offset:12864
    ds_read_b128 v[204:207], v6 offset:29504
    s_waitcnt vmcnt(24)
    s_waitcnt lgkmcnt(0)
    v_mfma_f32_16x16x32_bf16 v[48:51], v[192:195], v[64:67], v[48:51]
    v_mfma_f32_16x16x32_bf16 v[56:59], v[196:199], v[64:67], v[56:59]
    v_mfma_f32_16x16x32_bf16 v[52:55], v[192:195], v[68:71], v[52:55]
    v_mfma_f32_16x16x32_bf16 v[60:63], v[196:199], v[68:71], v[60:63]
    v_mfma_f32_16x16x32_bf16 v[48:51], v[192:195], v[72:75], v[48:51]
    v_mfma_f32_16x16x32_bf16 v[56:59], v[196:199], v[72:75], v[56:59]
    v_mfma_f32_16x16x32_bf16 v[52:55], v[192:195], v[76:79], v[52:55]
    v_mfma_f32_16x16x32_bf16 v[60:63], v[196:199], v[76:79], v[60:63]
    v_mfma_f32_16x16x32_bf16 v[48:51], v[200:203], v[80:83], v[48:51]
    v_mfma_f32_16x16x32_bf16 v[56:59], v[204:207], v[80:83], v[56:59]
    v_mfma_f32_16x16x32_bf16 v[52:55], v[200:203], v[84:87], v[52:55]
    v_mfma_f32_16x16x32_bf16 v[60:63], v[204:207], v[84:87], v[60:63]
    v_mfma_f32_16x16x32_bf16 v[48:51], v[200:203], v[88:91], v[48:51]
    v_mfma_f32_16x16x32_bf16 v[56:59], v[204:207], v[88:91], v[56:59]
    v_mfma_f32_16x16x32_bf16 v[52:55], v[200:203], v[92:95], v[52:55]
    v_mfma_f32_16x16x32_bf16 v[60:63], v[204:207], v[92:95], v[60:63]
    buffer_load_dwordx4 v[64:67], v4, s[64:67], s89 offen offset:0 sc1
    buffer_load_dwordx4 v[68:71], v4, s[64:67], s90 offen offset:0 sc1
    buffer_load_dwordx4 v[72:75], v4, s[64:67], s91 offen offset:0 sc1
    buffer_load_dwordx4 v[76:79], v4, s[64:67], s92 offen offset:0 sc1
    buffer_load_dwordx4 v[80:83], v4, s[64:67], s89 offen offset:1024 sc1
    buffer_load_dwordx4 v[84:87], v4, s[64:67], s90 offen offset:1024 sc1
    buffer_load_dwordx4 v[88:91], v4, s[64:67], s91 offen offset:1024 sc1
    buffer_load_dwordx4 v[92:95], v4, s[64:67], s92 offen offset:1024 sc1
    s_add_u32 s89, s89, 2048
    s_add_u32 s90, s90, 2048
    s_add_u32 s91, s91, 2048
    s_add_u32 s92, s92, 2048
    ds_read_b128 v[192:195], v6 offset:12928
    ds_read_b128 v[196:199], v6 offset:29568
    ds_read_b128 v[200:203], v6 offset:12992
    ds_read_b128 v[204:207], v6 offset:29632
    s_waitcnt vmcnt(24)
    s_waitcnt lgkmcnt(0)
    v_mfma_f32_16x16x32_bf16 v[48:51], v[192:195], v[96:99], v[48:51]
    v_mfma_f32_16x16x32_bf16 v[56:59], v[196:199], v[96:99], v[56:59]
    v_mfma_f32_16x16x32_bf16 v[52:55], v[192:195], v[100:103], v[52:55]
    v_mfma_f32_16x16x32_bf16 v[60:63], v[196:199], v[100:103], v[60:63]
    v_mfma_f32_16x16x32_bf16 v[48:51], v[192:195], v[104:107], v[48:51]
    v_mfma_f32_16x16x32_bf16 v[56:59], v[196:199], v[104:107], v[56:59]
    v_mfma_f32_16x16x32_bf16 v[52:55], v[192:195], v[108:111], v[52:55]
    v_mfma_f32_16x16x32_bf16 v[60:63], v[196:199], v[108:111], v[60:63]
    v_mfma_f32_16x16x32_bf16 v[48:51], v[200:203], v[112:115], v[48:51]
    v_mfma_f32_16x16x32_bf16 v[56:59], v[204:207], v[112:115], v[56:59]
    v_mfma_f32_16x16x32_bf16 v[52:55], v[200:203], v[116:119], v[52:55]
    v_mfma_f32_16x16x32_bf16 v[60:63], v[204:207], v[116:119], v[60:63]
    v_mfma_f32_16x16x32_bf16 v[48:51], v[200:203], v[120:123], v[48:51]
    v_mfma_f32_16x16x32_bf16 v[56:59], v[204:207], v[120:123], v[56:59]
    v_mfma_f32_16x16x32_bf16 v[52:55], v[200:203], v[124:127], v[52:55]
    v_mfma_f32_16x16x32_bf16 v[60:63], v[204:207], v[124:127], v[60:63]
    buffer_load_dwordx4 v[96:99], v4, s[64:67], s89 offen offset:0 sc1
    buffer_load_dwordx4 v[100:103], v4, s[64:67], s90 offen offset:0 sc1
    buffer_load_dwordx4 v[104:107], v4, s[64:67], s91 offen offset:0 sc1
    buffer_load_dwordx4 v[108:111], v4, s[64:67], s92 offen offset:0 sc1
    buffer_load_dwordx4 v[112:115], v4, s[64:67], s89 offen offset:1024 sc1
    buffer_load_dwordx4 v[116:119], v4, s[64:67], s90 offen offset:1024 sc1
    buffer_load_dwordx4 v[120:123], v4, s[64:67], s91 offen offset:1024 sc1
    buffer_load_dwordx4 v[124:127], v4, s[64:67], s92 offen offset:1024 sc1
    s_add_u32 s89, s89, 2048
    s_add_u32 s90, s90, 2048
    s_add_u32 s91, s91, 2048
    s_add_u32 s92, s92, 2048
    ds_read_b128 v[192:195], v6 offset:13056
    ds_read_b128 v[196:199], v6 offset:29696
    ds_read_b128 v[200:203], v6 offset:13120
    ds_read_b128 v[204:207], v6 offset:29760
    s_waitcnt vmcnt(24)
    s_waitcnt lgkmcnt(0)
    v_mfma_f32_16x16x32_bf16 v[48:51], v[192:195], v[128:131], v[48:51]
    v_mfma_f32_16x16x32_bf16 v[56:59], v[196:199], v[128:131], v[56:59]
    v_mfma_f32_16x16x32_bf16 v[52:55], v[192:195], v[132:135], v[52:55]
    v_mfma_f32_16x16x32_bf16 v[60:63], v[196:199], v[132:135], v[60:63]
    v_mfma_f32_16x16x32_bf16 v[48:51], v[192:195], v[136:139], v[48:51]
    v_mfma_f32_16x16x32_bf16 v[56:59], v[196:199], v[136:139], v[56:59]
    v_mfma_f32_16x16x32_bf16 v[52:55], v[192:195], v[140:143], v[52:55]
    v_mfma_f32_16x16x32_bf16 v[60:63], v[196:199], v[140:143], v[60:63]
    v_mfma_f32_16x16x32_bf16 v[48:51], v[200:203], v[144:147], v[48:51]
    v_mfma_f32_16x16x32_bf16 v[56:59], v[204:207], v[144:147], v[56:59]
    v_mfma_f32_16x16x32_bf16 v[52:55], v[200:203], v[148:151], v[52:55]
    v_mfma_f32_16x16x32_bf16 v[60:63], v[204:207], v[148:151], v[60:63]
    v_mfma_f32_16x16x32_bf16 v[48:51], v[200:203], v[152:155], v[48:51]
    v_mfma_f32_16x16x32_bf16 v[56:59], v[204:207], v[152:155], v[56:59]
    v_mfma_f32_16x16x32_bf16 v[52:55], v[200:203], v[156:159], v[52:55]
    v_mfma_f32_16x16x32_bf16 v[60:63], v[204:207], v[156:159], v[60:63]
    buffer_load_dwordx4 v[128:131], v4, s[64:67], s89 offen offset:0 sc1
    buffer_load_dwordx4 v[132:135], v4, s[64:67], s90 offen offset:0 sc1
    buffer_load_dwordx4 v[136:139], v4, s[64:67], s91 offen offset:0 sc1
    buffer_load_dwordx4 v[140:143], v4, s[64:67], s92 offen offset:0 sc1
    buffer_load_dwordx4 v[144:147], v4, s[64:67], s89 offen offset:1024 sc1
    buffer_load_dwordx4 v[148:151], v4, s[64:67], s90 offen offset:1024 sc1
    buffer_load_dwordx4 v[152:155], v4, s[64:67], s91 offen offset:1024 sc1
    buffer_load_dwordx4 v[156:159], v4, s[64:67], s92 offen offset:1024 sc1
    s_add_u32 s89, s89, 2048
    s_add_u32 s90, s90, 2048
    s_add_u32 s91, s91, 2048
    s_add_u32 s92, s92, 2048
    ds_read_b128 v[192:195], v6 offset:13184
    ds_read_b128 v[196:199], v6 offset:29824
    ds_read_b128 v[200:203], v6 offset:13248
    ds_read_b128 v[204:207], v6 offset:29888
    s_waitcnt vmcnt(24)
    s_waitcnt lgkmcnt(0)
    v_mfma_f32_16x16x32_bf16 v[48:51], v[192:195], v[160:163], v[48:51]
    v_mfma_f32_16x16x32_bf16 v[56:59], v[196:199], v[160:163], v[56:59]
    v_mfma_f32_16x16x32_bf16 v[52:55], v[192:195], v[164:167], v[52:55]
    v_mfma_f32_16x16x32_bf16 v[60:63], v[196:199], v[164:167], v[60:63]
    v_mfma_f32_16x16x32_bf16 v[48:51], v[192:195], v[168:171], v[48:51]
    v_mfma_f32_16x16x32_bf16 v[56:59], v[196:199], v[168:171], v[56:59]
    v_mfma_f32_16x16x32_bf16 v[52:55], v[192:195], v[172:175], v[52:55]
    v_mfma_f32_16x16x32_bf16 v[60:63], v[196:199], v[172:175], v[60:63]
    v_mfma_f32_16x16x32_bf16 v[48:51], v[200:203], v[176:179], v[48:51]
    v_mfma_f32_16x16x32_bf16 v[56:59], v[204:207], v[176:179], v[56:59]
    v_mfma_f32_16x16x32_bf16 v[52:55], v[200:203], v[180:183], v[52:55]
    v_mfma_f32_16x16x32_bf16 v[60:63], v[204:207], v[180:183], v[60:63]
    v_mfma_f32_16x16x32_bf16 v[48:51], v[200:203], v[184:187], v[48:51]
    v_mfma_f32_16x16x32_bf16 v[56:59], v[204:207], v[184:187], v[56:59]
    v_mfma_f32_16x16x32_bf16 v[52:55], v[200:203], v[188:191], v[52:55]
    v_mfma_f32_16x16x32_bf16 v[60:63], v[204:207], v[188:191], v[60:63]
    buffer_load_dwordx4 v[160:163], v4, s[64:67], s89 offen offset:0 sc1
    buffer_load_dwordx4 v[164:167], v4, s[64:67], s90 offen offset:0 sc1
    buffer_load_dwordx4 v[168:171], v4, s[64:67], s91 offen offset:0 sc1
    buffer_load_dwordx4 v[172:175], v4, s[64:67], s92 offen offset:0 sc1
    buffer_load_dwordx4 v[176:179], v4, s[64:67], s89 offen offset:1024 sc1
    buffer_load_dwordx4 v[180:183], v4, s[64:67], s90 offen offset:1024 sc1
    buffer_load_dwordx4 v[184:187], v4, s[64:67], s91 offen offset:1024 sc1
    buffer_load_dwordx4 v[188:191], v4, s[64:67], s92 offen offset:1024 sc1
    s_add_u32 s89, s89, 2048
    s_add_u32 s90, s90, 2048
    s_add_u32 s91, s91, 2048
    s_add_u32 s92, s92, 2048
    ds_read_b128 v[192:195], v6 offset:13312
    ds_read_b128 v[196:199], v6 offset:29952
    ds_read_b128 v[200:203], v6 offset:13376
    ds_read_b128 v[204:207], v6 offset:30016
    s_waitcnt vmcnt(24)
    s_waitcnt lgkmcnt(0)
    v_mfma_f32_16x16x32_bf16 v[48:51], v[192:195], v[64:67], v[48:51]
    v_mfma_f32_16x16x32_bf16 v[56:59], v[196:199], v[64:67], v[56:59]
    v_mfma_f32_16x16x32_bf16 v[52:55], v[192:195], v[68:71], v[52:55]
    v_mfma_f32_16x16x32_bf16 v[60:63], v[196:199], v[68:71], v[60:63]
    v_mfma_f32_16x16x32_bf16 v[48:51], v[192:195], v[72:75], v[48:51]
    v_mfma_f32_16x16x32_bf16 v[56:59], v[196:199], v[72:75], v[56:59]
    v_mfma_f32_16x16x32_bf16 v[52:55], v[192:195], v[76:79], v[52:55]
    v_mfma_f32_16x16x32_bf16 v[60:63], v[196:199], v[76:79], v[60:63]
    v_mfma_f32_16x16x32_bf16 v[48:51], v[200:203], v[80:83], v[48:51]
    v_mfma_f32_16x16x32_bf16 v[56:59], v[204:207], v[80:83], v[56:59]
    v_mfma_f32_16x16x32_bf16 v[52:55], v[200:203], v[84:87], v[52:55]
    v_mfma_f32_16x16x32_bf16 v[60:63], v[204:207], v[84:87], v[60:63]
    v_mfma_f32_16x16x32_bf16 v[48:51], v[200:203], v[88:91], v[48:51]
    v_mfma_f32_16x16x32_bf16 v[56:59], v[204:207], v[88:91], v[56:59]
    v_mfma_f32_16x16x32_bf16 v[52:55], v[200:203], v[92:95], v[52:55]
    v_mfma_f32_16x16x32_bf16 v[60:63], v[204:207], v[92:95], v[60:63]
    ds_read_b128 v[192:195], v6 offset:13440
    ds_read_b128 v[196:199], v6 offset:30080
    ds_read_b128 v[200:203], v6 offset:13504
    ds_read_b128 v[204:207], v6 offset:30144
    s_waitcnt vmcnt(16)
    s_waitcnt lgkmcnt(0)
    v_mfma_f32_16x16x32_bf16 v[48:51], v[192:195], v[96:99], v[48:51]
    v_mfma_f32_16x16x32_bf16 v[56:59], v[196:199], v[96:99], v[56:59]
    v_mfma_f32_16x16x32_bf16 v[52:55], v[192:195], v[100:103], v[52:55]
    v_mfma_f32_16x16x32_bf16 v[60:63], v[196:199], v[100:103], v[60:63]
    v_mfma_f32_16x16x32_bf16 v[48:51], v[192:195], v[104:107], v[48:51]
    v_mfma_f32_16x16x32_bf16 v[56:59], v[196:199], v[104:107], v[56:59]
    v_mfma_f32_16x16x32_bf16 v[52:55], v[192:195], v[108:111], v[52:55]
    v_mfma_f32_16x16x32_bf16 v[60:63], v[196:199], v[108:111], v[60:63]
    v_mfma_f32_16x16x32_bf16 v[48:51], v[200:203], v[112:115], v[48:51]
    v_mfma_f32_16x16x32_bf16 v[56:59], v[204:207], v[112:115], v[56:59]
    v_mfma_f32_16x16x32_bf16 v[52:55], v[200:203], v[116:119], v[52:55]
    v_mfma_f32_16x16x32_bf16 v[60:63], v[204:207], v[116:119], v[60:63]
    v_mfma_f32_16x16x32_bf16 v[48:51], v[200:203], v[120:123], v[48:51]
    v_mfma_f32_16x16x32_bf16 v[56:59], v[204:207], v[120:123], v[56:59]
    v_mfma_f32_16x16x32_bf16 v[52:55], v[200:203], v[124:127], v[52:55]
    v_mfma_f32_16x16x32_bf16 v[60:63], v[204:207], v[124:127], v[60:63]
    ds_read_b128 v[192:195], v6 offset:13568
    ds_read_b128 v[196:199], v6 offset:30208
    ds_read_b128 v[200:203], v6 offset:13632
    ds_read_b128 v[204:207], v6 offset:30272
    s_waitcnt vmcnt(8)
    s_waitcnt lgkmcnt(0)
    v_mfma_f32_16x16x32_bf16 v[48:51], v[192:195], v[128:131], v[48:51]
    v_mfma_f32_16x16x32_bf16 v[56:59], v[196:199], v[128:131], v[56:59]
    v_mfma_f32_16x16x32_bf16 v[52:55], v[192:195], v[132:135], v[52:55]
    v_mfma_f32_16x16x32_bf16 v[60:63], v[196:199], v[132:135], v[60:63]
    v_mfma_f32_16x16x32_bf16 v[48:51], v[192:195], v[136:139], v[48:51]
    v_mfma_f32_16x16x32_bf16 v[56:59], v[196:199], v[136:139], v[56:59]
    v_mfma_f32_16x16x32_bf16 v[52:55], v[192:195], v[140:143], v[52:55]
    v_mfma_f32_16x16x32_bf16 v[60:63], v[196:199], v[140:143], v[60:63]
    v_mfma_f32_16x16x32_bf16 v[48:51], v[200:203], v[144:147], v[48:51]
    v_mfma_f32_16x16x32_bf16 v[56:59], v[204:207], v[144:147], v[56:59]
    v_mfma_f32_16x16x32_bf16 v[52:55], v[200:203], v[148:151], v[52:55]
    v_mfma_f32_16x16x32_bf16 v[60:63], v[204:207], v[148:151], v[60:63]
    v_mfma_f32_16x16x32_bf16 v[48:51], v[200:203], v[152:155], v[48:51]
    v_mfma_f32_16x16x32_bf16 v[56:59], v[204:207], v[152:155], v[56:59]
    v_mfma_f32_16x16x32_bf16 v[52:55], v[200:203], v[156:159], v[52:55]
    v_mfma_f32_16x16x32_bf16 v[60:63], v[204:207], v[156:159], v[60:63]
    ds_read_b128 v[192:195], v6 offset:13696
    ds_read_b128 v[196:199], v6 offset:30336
    ds_read_b128 v[200:203], v6 offset:13760
    ds_read_b128 v[204:207], v6 offset:30400
    s_waitcnt vmcnt(0)
    s_waitcnt lgkmcnt(0)
    v_mfma_f32_16x16x32_bf16 v[48:51], v[192:195], v[160:163], v[48:51]
    v_mfma_f32_16x16x32_bf16 v[56:59], v[196:199], v[160:163], v[56:59]
    v_mfma_f32_16x16x32_bf16 v[52:55], v[192:195], v[164:167], v[52:55]
    v_mfma_f32_16x16x32_bf16 v[60:63], v[196:199], v[164:167], v[60:63]
    v_mfma_f32_16x16x32_bf16 v[48:51], v[192:195], v[168:171], v[48:51]
    v_mfma_f32_16x16x32_bf16 v[56:59], v[196:199], v[168:171], v[56:59]
    v_mfma_f32_16x16x32_bf16 v[52:55], v[192:195], v[172:175], v[52:55]
    v_mfma_f32_16x16x32_bf16 v[60:63], v[196:199], v[172:175], v[60:63]
    v_mfma_f32_16x16x32_bf16 v[48:51], v[200:203], v[176:179], v[48:51]
    v_mfma_f32_16x16x32_bf16 v[56:59], v[204:207], v[176:179], v[56:59]
    v_mfma_f32_16x16x32_bf16 v[52:55], v[200:203], v[180:183], v[52:55]
    v_mfma_f32_16x16x32_bf16 v[60:63], v[204:207], v[180:183], v[60:63]
    v_mfma_f32_16x16x32_bf16 v[48:51], v[200:203], v[184:187], v[48:51]
    v_mfma_f32_16x16x32_bf16 v[56:59], v[204:207], v[184:187], v[56:59]
    v_mfma_f32_16x16x32_bf16 v[52:55], v[200:203], v[188:191], v[52:55]
    v_mfma_f32_16x16x32_bf16 v[60:63], v[204:207], v[188:191], v[60:63]
    s_nop 9
    v_cvt_pk_bf16_f32 v24, v48, v49
    v_cvt_pk_bf16_f32 v25, v50, v51
    v_lshlrev_b32 v208, 16, v24
    v_and_b32 v209, 0xffff0000, v24
    v_lshlrev_b32 v210, 16, v25
    v_and_b32 v211, 0xffff0000, v25
    v_mul_f32 v208, s68, v208
    v_mul_f32 v209, s68, v209
    v_mul_f32 v210, s68, v210
    v_mul_f32 v211, s68, v211
    v_cvt_pk_bf16_f32 v24, v208, v209
    v_cvt_pk_bf16_f32 v25, v210, v211
    v_lshlrev_b32 v208, 16, v24
    v_and_b32 v209, 0xffff0000, v24
    v_lshlrev_b32 v210, 16, v25
    v_and_b32 v211, 0xffff0000, v25
    v_cvt_pk_bf16_f32 v24, v52, v53
    v_cvt_pk_bf16_f32 v25, v54, v55
    v_lshlrev_b32 v212, 16, v24
    v_and_b32 v213, 0xffff0000, v24
    v_lshlrev_b32 v214, 16, v25
    v_and_b32 v215, 0xffff0000, v25
    v_mul_f32 v212, s68, v212
    v_mul_f32 v213, s68, v213
    v_mul_f32 v214, s68, v214
    v_mul_f32 v215, s68, v215
    v_cvt_pk_bf16_f32 v24, v212, v213
    v_cvt_pk_bf16_f32 v25, v214, v215
    v_lshlrev_b32 v212, 16, v24
    v_and_b32 v213, 0xffff0000, v24
    v_lshlrev_b32 v214, 16, v25
    v_and_b32 v215, 0xffff0000, v25
    v_cvt_pk_bf16_f32 v24, v56, v57
    v_cvt_pk_bf16_f32 v25, v58, v59
    v_lshlrev_b32 v216, 16, v24
    v_and_b32 v217, 0xffff0000, v24
    v_lshlrev_b32 v218, 16, v25
    v_and_b32 v219, 0xffff0000, v25
    v_mul_f32 v216, s68, v216
    v_mul_f32 v217, s68, v217
    v_mul_f32 v218, s68, v218
    v_mul_f32 v219, s68, v219
    v_cvt_pk_bf16_f32 v24, v216, v217
    v_cvt_pk_bf16_f32 v25, v218, v219
    v_lshlrev_b32 v216, 16, v24
    v_and_b32 v217, 0xffff0000, v24
    v_lshlrev_b32 v218, 16, v25
    v_and_b32 v219, 0xffff0000, v25
    v_cvt_pk_bf16_f32 v24, v60, v61
    v_cvt_pk_bf16_f32 v25, v62, v63
    v_lshlrev_b32 v220, 16, v24
    v_and_b32 v221, 0xffff0000, v24
    v_lshlrev_b32 v222, 16, v25
    v_and_b32 v223, 0xffff0000, v25
    v_mul_f32 v220, s68, v220
    v_mul_f32 v221, s68, v221
    v_mul_f32 v222, s68, v222
    v_mul_f32 v223, s68, v223
    v_cvt_pk_bf16_f32 v24, v220, v221
    v_cvt_pk_bf16_f32 v25, v222, v223
    v_lshlrev_b32 v220, 16, v24
    v_and_b32 v221, 0xffff0000, v24
    v_lshlrev_b32 v222, 16, v25
    v_and_b32 v223, 0xffff0000, v25
    v_lshlrev_b32 v5, 6, v3
    v_lshl_add_u32 v7, v2, 2, v5
    s_lshl_b32 s11, s7, 4
    v_add_u32 v7, s11, v7
    v_max3_f32 v24, v208, v209, v210
    v_max3_f32 v24, v24, v211, v216
    v_max3_f32 v24, v24, v217, v218
    v_max_f32 v24, v24, v219
    v_max3_f32 v25, v212, v213, v214
    v_max3_f32 v25, v25, v215, v220
    v_max3_f32 v25, v25, v221, v222
    v_max_f32 v25, v25, v223
    ds_write_b32 v7, v24 offset:8704
    ds_write_b32 v7, v25 offset:9728
    s_waitcnt lgkmcnt(0)
    s_barrier
    ds_read_b128 v[224:227], v5 offset:8704
    ds_read_b128 v[228:231], v5 offset:8720
    ds_read_b128 v[232:235], v5 offset:8736
    ds_read_b128 v[236:239], v5 offset:8752
    ds_read_b128 v[240:243], v5 offset:9728
    ds_read_b128 v[244:247], v5 offset:9744
    ds_read_b128 v[248:251], v5 offset:9760
    ds_read_b128 v[252:255], v5 offset:9776
    s_waitcnt lgkmcnt(0)
    v_max3_f32 v32, v224, v225, v226
    v_max3_f32 v32, v32, v227, v228
    v_max3_f32 v32, v32, v229, v230
    v_max3_f32 v32, v32, v231, v232
    v_max3_f32 v32, v32, v233, v234
    v_max3_f32 v32, v32, v235, v236
    v_max3_f32 v32, v32, v237, v238
    v_max_f32 v32, v32, v239
    v_max3_f32 v33, v240, v241, v242
    v_max3_f32 v33, v33, v243, v244
    v_max3_f32 v33, v33, v245, v246
    v_max3_f32 v33, v33, v247, v248
    v_max3_f32 v33, v33, v249, v250
    v_max3_f32 v33, v33, v251, v252
    v_max3_f32 v33, v33, v253, v254
    v_max_f32 v33, v33, v255
    v_mul_f32 v34, s70, v32
    v_mul_f32 v35, s70, v33
    v_fma_f32 v208, v208, s69, v34
    v_fma_f32 v209, v209, s69, v34
    v_fma_f32 v210, v210, s69, v34
    v_fma_f32 v211, v211, s69, v34
    v_fma_f32 v212, v212, s69, v35
    v_fma_f32 v213, v213, s69, v35
    v_fma_f32 v214, v214, s69, v35
    v_fma_f32 v215, v215, s69, v35
    v_fma_f32 v216, v216, s69, v34
    v_fma_f32 v217, v217, s69, v34
    v_fma_f32 v218, v218, s69, v34
    v_fma_f32 v219, v219, s69, v34
    v_fma_f32 v220, v220, s69, v35
    v_fma_f32 v221, v221, s69, v35
    v_fma_f32 v222, v222, s69, v35
    v_fma_f32 v223, v223, s69, v35
    v_exp_f32 v208, v208
    v_exp_f32 v209, v209
    v_exp_f32 v210, v210
    v_exp_f32 v211, v211
    v_exp_f32 v212, v212
    v_exp_f32 v213, v213
    v_exp_f32 v214, v214
    v_exp_f32 v215, v215
    v_exp_f32 v216, v216
    v_exp_f32 v217, v217
    v_exp_f32 v218, v218
    v_exp_f32 v219, v219
    v_exp_f32 v220, v220
    v_exp_f32 v221, v221
    v_exp_f32 v222, v222
    v_exp_f32 v223, v223
    s_nop 0
    v_add_f32 v24, v208, v209
    v_add_f32 v26, v210, v211
    v_add_f32 v28, v216, v217
    v_add_f32 v30, v218, v219
    v_add_f32 v25, v212, v213
    v_add_f32 v27, v214, v215
    v_add_f32 v29, v220, v221
    v_add_f32 v31, v222, v223
    v_add_f32 v24, v24, v26
    v_add_f32 v28, v28, v30
    v_add_f32 v25, v25, v27
    v_add_f32 v29, v29, v31
    v_add_f32 v24, v24, v28
    v_add_f32 v25, v25, v29
    ds_write_b32 v7, v24 offset:10752
    ds_write_b32 v7, v25 offset:11776
    v_mul_u32_u24 v7, 272, v3
    v_lshl_add_u32 v28, v2, 3, v7
    s_lshl_b32 s11, s7, 6
    v_add_u32 v28, s11, v28
    v_cvt_pk_bf16_f32 v30, v208, v209
    v_cvt_pk_bf16_f32 v31, v210, v211
    ds_write_b64 v28, v[30:31] offset:0
    v_cvt_pk_bf16_f32 v30, v212, v213
    v_cvt_pk_bf16_f32 v31, v214, v215
    ds_write_b64 v28, v[30:31] offset:4352
    v_cvt_pk_bf16_f32 v30, v216, v217
    v_cvt_pk_bf16_f32 v31, v218, v219
    ds_write_b64 v28, v[30:31] offset:32
    v_cvt_pk_bf16_f32 v30, v220, v221
    v_cvt_pk_bf16_f32 v31, v222, v223
    ds_write_b64 v28, v[30:31] offset:4384
    s_waitcnt lgkmcnt(0)
    s_barrier
    s_cmp_eq_u32 s7, 0
    s_cbranch_scc0 B2_nostats
    v_and_b32 v24, 31, v1
    v_lshlrev_b32 v25, 6, v24
    ds_read_b128 v[224:227], v25 offset:8704
    ds_read_b128 v[240:243], v25 offset:10752
    ds_read_b128 v[228:231], v25 offset:8720
    ds_read_b128 v[244:247], v25 offset:10768
    ds_read_b128 v[232:235], v25 offset:8736
    ds_read_b128 v[248:251], v25 offset:10784
    ds_read_b128 v[236:239], v25 offset:8752
    ds_read_b128 v[252:255], v25 offset:10800
    s_waitcnt lgkmcnt(0)
    v_max3_f32 v26, v224, v225, v226
    v_max3_f32 v26, v26, v227, v228
    v_max3_f32 v26, v26, v229, v230
    v_max3_f32 v26, v26, v231, v232
    v_max3_f32 v26, v26, v233, v234
    v_max3_f32 v26, v26, v235, v236
    v_max3_f32 v26, v26, v237, v238
    v_max_f32 v26, v26, v239
    v_add_f32 v27, v240, v241
    v_add_f32 v27, v27, v242
    v_add_f32 v27, v27, v243
    v_add_f32 v27, v27, v244
    v_add_f32 v27, v27, v245
    v_add_f32 v27, v27, v246
    v_add_f32 v27, v27, v247
    v_add_f32 v27, v27, v248
    v_add_f32 v27, v27, v249
    v_add_f32 v27, v27, v250
    v_add_f32 v27, v27, v251
    v_add_f32 v27, v27, v252
    v_add_f32 v27, v27, v253
    v_add_f32 v27, v27, v254
    v_add_f32 v27, v27, v255
    s_lshl_b32 s11, s5, 5
    s_add_u32 s11, s11, s6
    s_lshl_b32 s11, s11, 8
    s_add_u32 s11, s11, 0x200000
    v_lshlrev_b32 v25, 3, v24
    buffer_store_dwordx2 v[26:27], v25, s[64:67], s11 offen sc1
B2_nostats:
    v_mul_u32_u24 v7, 272, v3
    v_lshl_add_u32 v7, v2, 4, v7
    ds_read_b128 v[192:195], v7 offset:0
    ds_read_b128 v[196:199], v7 offset:64
    ds_read_b128 v[200:203], v7 offset:128
    ds_read_b128 v[204:207], v7 offset:192
    ds_read_b128 v[208:211], v7 offset:4352
    ds_read_b128 v[212:215], v7 offset:4416
    ds_read_b128 v[216:219], v7 offset:4480
    ds_read_b128 v[220:223], v7 offset:4544
    v_lshrrev_b32 v24, 2, v3
    v_lshl_add_u32 v24, v2, 3, v24
    v_mul_u32_u24 v24, 1040, v24
    v_and_b32 v25, 3, v3
    v_lshl_add_u32 v24, v25, 3, v24
    s_lshl_b32 s11, s7, 8
    v_add_u32 v7, s11, v24
    v_add_u32 v6, 66560, v7
    v_mov_b32 v64, 0
    v_mov_b32 v65, 0
    v_mov_b32 v66, 0
    v_mov_b32 v67, 0
    v_mov_b32 v68, 0
    v_mov_b32 v69, 0
    v_mov_b32 v70, 0
    v_mov_b32 v71, 0
    v_mov_b32 v72, 0
    v_mov_b32 v73, 0
    v_mov_b32 v74, 0
    v_mov_b32 v75, 0
    v_mov_b32 v76, 0
    v_mov_b32 v77, 0
    v_mov_b32 v78, 0
    v_mov_b32 v79, 0
    v_mov_b32 v80, 0
    v_mov_b32 v81, 0
    v_mov_b32 v82, 0
    v_mov_b32 v83, 0
    v_mov_b32 v84, 0
    v_mov_b32 v85, 0
    v_mov_b32 v86, 0
    v_mov_b32 v87, 0
    v_mov_b32 v88, 0
    v_mov_b32 v89, 0
    v_mov_b32 v90, 0
    v_mov_b32 v91, 0
    v_mov_b32 v92, 0
    v_mov_b32 v93, 0
    v_mov_b32 v94, 0
    v_mov_b32 v95, 0
    v_mov_b32 v96, 0
    v_mov_b32 v97, 0
    v_mov_b32 v98, 0
    v_mov_b32 v99, 0
    v_mov_b32 v100, 0
    v_mov_b32 v101, 0
    v_mov_b32 v102, 0
    v_mov_b32 v103, 0
    v_mov_b32 v104, 0
    v_mov_b32 v105, 0
    v_mov_b32 v106, 0
    v_mov_b32 v107, 0
    v_mov_b32 v108, 0
    v_mov_b32 v109, 0
    v_mov_b32 v110, 0
    v_mov_b32 v111, 0
    v_mov_b32 v112, 0
    v_mov_b32 v113, 0
    v_mov_b32 v114, 0
    v_mov_b32 v115, 0
    v_mov_b32 v116, 0
    v_mov_b32 v117, 0
    v_mov_b32 v118, 0
    v_mov_b32 v119, 0
    v_mov_b32 v120, 0
    v_mov_b32 v121, 0
    v_mov_b32 v122, 0
    v_mov_b32 v123, 0
    v_mov_b32 v124, 0
    v_mov_b32 v125, 0
    v_mov_b32 v126, 0
    v_mov_b32 v127, 0
    ds_read_b64_tr_b16 v[128:129], v7 offset:12800
    ds_read_b64_tr_b16 v[130:131], v7 offset:16960
    ds_read_b64_tr_b16 v[132:133], v7 offset:12832
    ds_read_b64_tr_b16 v[134:135], v7 offset:16992
    ds_read_b64_tr_b16 v[136:137], v7 offset:12864
    ds_read_b64_tr_b16 v[138:139], v7 offset:17024
    ds_read_b64_tr_b16 v[140:141], v7 offset:12896
    ds_read_b64_tr_b16 v[142:143], v7 offset:17056
    ds_read_b64_tr_b16 v[144:145], v7 offset:12928
    ds_read_b64_tr_b16 v[146:147], v7 offset:17088
    ds_read_b64_tr_b16 v[148:149], v7 offset:12960
    ds_read_b64_tr_b16 v[150:151], v7 offset:17120
    ds_read_b64_tr_b16 v[152:153], v7 offset:12992
    ds_read_b64_tr_b16 v[154:155], v7 offset:17152
    ds_read_b64_tr_b16 v[156:157], v7 offset:13024
    ds_read_b64_tr_b16 v[158:159], v7 offset:17184
    s_waitcnt lgkmcnt(0)
    v_mfma_f32_16x16x32_bf16 v[64:67], v[192:195], v[128:131], v[64:67]
    v_mfma_f32_16x16x32_bf16 v[68:71], v[208:211], v[128:131], v[68:71]
    v_mfma_f32_16x16x32_bf16 v[72:75], v[192:195], v[132:135], v[72:75]
    v_mfma_f32_16x16x32_bf16 v[76:79], v[208:211], v[132:135], v[76:79]
    v_mfma_f32_16x16x32_bf16 v[80:83], v[192:195], v[136:139], v[80:83]
    v_mfma_f32_16x16x32_bf16 v[84:87], v[208:211], v[136:139], v[84:87]
    v_mfma_f32_16x16x32_bf16 v[88:91], v[192:195], v[140:143], v[88:91]
    v_mfma_f32_16x16x32_bf16 v[92:95], v[208:211], v[140:143], v[92:95]
    v_mfma_f32_16x16x32_bf16 v[96:99], v[192:195], v[144:147], v[96:99]
    v_mfma_f32_16x16x32_bf16 v[100:103], v[208:211], v[144:147], v[100:103]
    v_mfma_f32_16x16x32_bf16 v[104:107], v[192:195], v[148:151], v[104:107]
    v_mfma_f32_16x16x32_bf16 v[108:111], v[208:211], v[148:151], v[108:111]
    v_mfma_f32_16x16x32_bf16 v[112:115], v[192:195], v[152:155], v[112:115]
    v_mfma_f32_16x16x32_bf16 v[116:119], v[208:211], v[152:155], v[116:119]
    v_mfma_f32_16x16x32_bf16 v[120:123], v[192:195], v[156:159], v[120:123]
    v_mfma_f32_16x16x32_bf16 v[124:127], v[208:211], v[156:159], v[124:127]
    s_nop 7
    ds_read_b64_tr_b16 v[128:129], v7 offset:46080
    ds_read_b64_tr_b16 v[130:131], v7 offset:50240
    ds_read_b64_tr_b16 v[132:133], v7 offset:46112
    ds_read_b64_tr_b16 v[134:135], v7 offset:50272
    ds_read_b64_tr_b16 v[136:137], v7 offset:46144
    ds_read_b64_tr_b16 v[138:139], v7 offset:50304
    ds_read_b64_tr_b16 v[140:141], v7 offset:46176
    ds_read_b64_tr_b16 v[142:143], v7 offset:50336
    ds_read_b64_tr_b16 v[144:145], v7 offset:46208
    ds_read_b64_tr_b16 v[146:147], v7 offset:50368
    ds_read_b64_tr_b16 v[148:149], v7 offset:46240
    ds_read_b64_tr_b16 v[150:151], v7 offset:50400
    ds_read_b64_tr_b16 v[152:153], v7 offset:46272
    ds_read_b64_tr_b16 v[154:155], v7 offset:50432
    ds_read_b64_tr_b16 v[156:157], v7 offset:46304
    ds_read_b64_tr_b16 v[158:159], v7 offset:50464
    s_waitcnt lgkmcnt(0)
    v_mfma_f32_16x16x32_bf16 v[64:67], v[196:199], v[128:131], v[64:67]
    v_mfma_f32_16x16x32_bf16 v[68:71], v[212:215], v[128:131], v[68:71]
    v_mfma_f32_16x16x32_bf16 v[72:75], v[196:199], v[132:135], v[72:75]
    v_mfma_f32_16x16x32_bf16 v[76:79], v[212:215], v[132:135], v[76:79]
    v_mfma_f32_16x16x32_bf16 v[80:83], v[196:199], v[136:139], v[80:83]
    v_mfma_f32_16x16x32_bf16 v[84:87], v[212:215], v[136:139], v[84:87]
    v_mfma_f32_16x16x32_bf16 v[88:91], v[196:199], v[140:143], v[88:91]
    v_mfma_f32_16x16x32_bf16 v[92:95], v[212:215], v[140:143], v[92:95]
    v_mfma_f32_16x16x32_bf16 v[96:99], v[196:199], v[144:147], v[96:99]
    v_mfma_f32_16x16x32_bf16 v[100:103], v[212:215], v[144:147], v[100:103]
    v_mfma_f32_16x16x32_bf16 v[104:107], v[196:199], v[148:151], v[104:107]
    v_mfma_f32_16x16x32_bf16 v[108:111], v[212:215], v[148:151], v[108:111]
    v_mfma_f32_16x16x32_bf16 v[112:115], v[196:199], v[152:155], v[112:115]
    v_mfma_f32_16x16x32_bf16 v[116:119], v[212:215], v[152:155], v[116:119]
    v_mfma_f32_16x16x32_bf16 v[120:123], v[196:199], v[156:159], v[120:123]
    v_mfma_f32_16x16x32_bf16 v[124:127], v[212:215], v[156:159], v[124:127]
    s_nop 7
    ds_read_b64_tr_b16 v[128:129], v6 offset:12800
    ds_read_b64_tr_b16 v[130:131], v6 offset:16960
    ds_read_b64_tr_b16 v[132:133], v6 offset:12832
    ds_read_b64_tr_b16 v[134:135], v6 offset:16992
    ds_read_b64_tr_b16 v[136:137], v6 offset:12864
    ds_read_b64_tr_b16 v[138:139], v6 offset:17024
    ds_read_b64_tr_b16 v[140:141], v6 offset:12896
    ds_read_b64_tr_b16 v[142:143], v6 offset:17056
    ds_read_b64_tr_b16 v[144:145], v6 offset:12928
    ds_read_b64_tr_b16 v[146:147], v6 offset:17088
    ds_read_b64_tr_b16 v[148:149], v6 offset:12960
    ds_read_b64_tr_b16 v[150:151], v6 offset:17120
    ds_read_b64_tr_b16 v[152:153], v6 offset:12992
    ds_read_b64_tr_b16 v[154:155], v6 offset:17152
    ds_read_b64_tr_b16 v[156:157], v6 offset:13024
    ds_read_b64_tr_b16 v[158:159], v6 offset:17184
    s_waitcnt lgkmcnt(0)
    v_mfma_f32_16x16x32_bf16 v[64:67], v[200:203], v[128:131], v[64:67]
    v_mfma_f32_16x16x32_bf16 v[68:71], v[216:219], v[128:131], v[68:71]
    v_mfma_f32_16x16x32_bf16 v[72:75], v[200:203], v[132:135], v[72:75]
    v_mfma_f32_16x16x32_bf16 v[76:79], v[216:219], v[132:135], v[76:79]
    v_mfma_f32_16x16x32_bf16 v[80:83], v[200:203], v[136:139], v[80:83]
    v_mfma_f32_16x16x32_bf16 v[84:87], v[216:219], v[136:139], v[84:87]
    v_mfma_f32_16x16x32_bf16 v[88:91], v[200:203], v[140:143], v[88:91]
    v_mfma_f32_16x16x32_bf16 v[92:95], v[216:219], v[140:143], v[92:95]
    v_mfma_f32_16x16x32_bf16 v[96:99], v[200:203], v[144:147], v[96:99]
    v_mfma_f32_16x16x32_bf16 v[100:103], v[216:219], v[144:147], v[100:103]
    v_mfma_f32_16x16x32_bf16 v[104:107], v[200:203], v[148:151], v[104:107]
    v_mfma_f32_16x16x32_bf16 v[108:111], v[216:219], v[148:151], v[108:111]
    v_mfma_f32_16x16x32_bf16 v[112:115], v[200:203], v[152:155], v[112:115]
    v_mfma_f32_16x16x32_bf16 v[116:119], v[216:219], v[152:155], v[116:119]
    v_mfma_f32_16x16x32_bf16 v[120:123], v[200:203], v[156:159], v[120:123]
    v_mfma_f32_16x16x32_bf16 v[124:127], v[216:219], v[156:159], v[124:127]
    s_nop 7
    ds_read_b64_tr_b16 v[128:129], v6 offset:46080
    ds_read_b64_tr_b16 v[130:131], v6 offset:50240
    ds_read_b64_tr_b16 v[132:133], v6 offset:46112
    ds_read_b64_tr_b16 v[134:135], v6 offset:50272
    ds_read_b64_tr_b16 v[136:137], v6 offset:46144
    ds_read_b64_tr_b16 v[138:139], v6 offset:50304
    ds_read_b64_tr_b16 v[140:141], v6 offset:46176
    ds_read_b64_tr_b16 v[142:143], v6 offset:50336
    ds_read_b64_tr_b16 v[144:145], v6 offset:46208
    ds_read_b64_tr_b16 v[146:147], v6 offset:50368
    ds_read_b64_tr_b16 v[148:149], v6 offset:46240
    ds_read_b64_tr_b16 v[150:151], v6 offset:50400
    ds_read_b64_tr_b16 v[152:153], v6 offset:46272
    ds_read_b64_tr_b16 v[154:155], v6 offset:50432
    ds_read_b64_tr_b16 v[156:157], v6 offset:46304
    ds_read_b64_tr_b16 v[158:159], v6 offset:50464
    s_waitcnt lgkmcnt(0)
    v_mfma_f32_16x16x32_bf16 v[64:67], v[204:207], v[128:131], v[64:67]
    v_mfma_f32_16x16x32_bf16 v[68:71], v[220:223], v[128:131], v[68:71]
    v_mfma_f32_16x16x32_bf16 v[72:75], v[204:207], v[132:135], v[72:75]
    v_mfma_f32_16x16x32_bf16 v[76:79], v[220:223], v[132:135], v[76:79]
    v_mfma_f32_16x16x32_bf16 v[80:83], v[204:207], v[136:139], v[80:83]
    v_mfma_f32_16x16x32_bf16 v[84:87], v[220:223], v[136:139], v[84:87]
    v_mfma_f32_16x16x32_bf16 v[88:91], v[204:207], v[140:143], v[88:91]
    v_mfma_f32_16x16x32_bf16 v[92:95], v[220:223], v[140:143], v[92:95]
    v_mfma_f32_16x16x32_bf16 v[96:99], v[204:207], v[144:147], v[96:99]
    v_mfma_f32_16x16x32_bf16 v[100:103], v[220:223], v[144:147], v[100:103]
    v_mfma_f32_16x16x32_bf16 v[104:107], v[204:207], v[148:151], v[104:107]
    v_mfma_f32_16x16x32_bf16 v[108:111], v[220:223], v[148:151], v[108:111]
    v_mfma_f32_16x16x32_bf16 v[112:115], v[204:207], v[152:155], v[112:115]
    v_mfma_f32_16x16x32_bf16 v[116:119], v[220:223], v[152:155], v[116:119]
    v_mfma_f32_16x16x32_bf16 v[120:123], v[204:207], v[156:159], v[120:123]
    v_mfma_f32_16x16x32_bf16 v[124:127], v[220:223], v[156:159], v[124:127]
    s_nop 7
    s_nop 3
    s_waitcnt lgkmcnt(0)
    s_barrier
    v_lshlrev_b32 v5, 11, v2
    v_lshl_add_u32 v5, v3, 2, v5
    s_lshl_b32 s11, s7, 14
    v_add_u32 v5, s11, v5
    ds_write_b32 v5, v64 offset:12800
    ds_write_b32 v5, v65 offset:13312
    ds_write_b32 v5, v66 offset:13824
    ds_write_b32 v5, v67 offset:14336
    ds_write_b32 v5, v68 offset:20992
    ds_write_b32 v5, v69 offset:21504
    ds_write_b32 v5, v70 offset:22016
    ds_write_b32 v5, v71 offset:22528
    ds_write_b32 v5, v72 offset:12864
    ds_write_b32 v5, v73 offset:13376
    ds_write_b32 v5, v74 offset:13888
    ds_write_b32 v5, v75 offset:14400
    ds_write_b32 v5, v76 offset:21056
    ds_write_b32 v5, v77 offset:21568
    ds_write_b32 v5, v78 offset:22080
    ds_write_b32 v5, v79 offset:22592
    ds_write_b32 v5, v80 offset:12928
    ds_write_b32 v5, v81 offset:13440
    ds_write_b32 v5, v82 offset:13952
    ds_write_b32 v5, v83 offset:14464
    ds_write_b32 v5, v84 offset:21120
    ds_write_b32 v5, v85 offset:21632
    ds_write_b32 v5, v86 offset:22144
    ds_write_b32 v5, v87 offset:22656
    ds_write_b32 v5, v88 offset:12992
    ds_write_b32 v5, v89 offset:13504
    ds_write_b32 v5, v90 offset:14016
    ds_write_b32 v5, v91 offset:14528
    ds_write_b32 v5, v92 offset:21184
    ds_write_b32 v5, v93 offset:21696
    ds_write_b32 v5, v94 offset:22208
    ds_write_b32 v5, v95 offset:22720
    ds_write_b32 v5, v96 offset:13056
    ds_write_b32 v5, v97 offset:13568
    ds_write_b32 v5, v98 offset:14080
    ds_write_b32 v5, v99 offset:14592
    ds_write_b32 v5, v100 offset:21248
    ds_write_b32 v5, v101 offset:21760
    ds_write_b32 v5, v102 offset:22272
    ds_write_b32 v5, v103 offset:22784
    ds_write_b32 v5, v104 offset:13120
    ds_write_b32 v5, v105 offset:13632
    ds_write_b32 v5, v106 offset:14144
    ds_write_b32 v5, v107 offset:14656
    ds_write_b32 v5, v108 offset:21312
    ds_write_b32 v5, v109 offset:21824
    ds_write_b32 v5, v110 offset:22336
    ds_write_b32 v5, v111 offset:22848
    ds_write_b32 v5, v112 offset:13184
    ds_write_b32 v5, v113 offset:13696
    ds_write_b32 v5, v114 offset:14208
    ds_write_b32 v5, v115 offset:14720
    ds_write_b32 v5, v116 offset:21376
    ds_write_b32 v5, v117 offset:21888
    ds_write_b32 v5, v118 offset:22400
    ds_write_b32 v5, v119 offset:22912
    ds_write_b32 v5, v120 offset:13248
    ds_write_b32 v5, v121 offset:13760
    ds_write_b32 v5, v122 offset:14272
    ds_write_b32 v5, v123 offset:14784
    ds_write_b32 v5, v124 offset:21440
    ds_write_b32 v5, v125 offset:21952
    ds_write_b32 v5, v126 offset:22464
    ds_write_b32 v5, v127 offset:22976
    s_waitcnt lgkmcnt(0)
    v_lshrrev_b32 v6, 5, v1
    v_lshlrev_b32 v6, 9, v6
    v_and_b32 v24, 31, v1
    v_lshl_add_u32 v6, v24, 4, v6
    v_add_u32 v6, s11, v6
    ds_read_b128 v[128:131], v6 offset:12800
    ds_read_b128 v[132:135], v6 offset:13824
    ds_read_b128 v[136:139], v6 offset:14848
    ds_read_b128 v[140:143], v6 offset:15872
    ds_read_b128 v[144:147], v6 offset:16896
    ds_read_b128 v[148:151], v6 offset:17920
    ds_read_b128 v[152:155], v6 offset:18944
    ds_read_b128 v[156:159], v6 offset:19968
    s_waitcnt lgkmcnt(0)
    v_lshrrev_b32 v7, 5, v1
    v_lshlrev_b32 v7, 11, v7
    v_lshl_add_u32 v7, v24, 4, v7
    s_lshl_b32 s12, s5, 5
    s_add_u32 s12, s12, s6
    s_lshl_b32 s12, s12, 16
    s_add_u32 s12, s12, 0x1000000
    s_lshl_b32 s13, s7, 9
    s_add_u32 s88, s12, s13
    buffer_store_dwordx4 v[128:131], v7, s[64:67], s88 offen sc1
    s_add_u32 s88, s88, 4096
    buffer_store_dwordx4 v[132:135], v7, s[64:67], s88 offen sc1
    s_add_u32 s88, s88, 4096
    buffer_store_dwordx4 v[136:139], v7, s[64:67], s88 offen sc1
    s_add_u32 s88, s88, 4096
    buffer_store_dwordx4 v[140:143], v7, s[64:67], s88 offen sc1
    s_add_u32 s88, s88, 4096
    buffer_store_dwordx4 v[144:147], v7, s[64:67], s88 offen sc1
    s_add_u32 s88, s88, 4096
    buffer_store_dwordx4 v[148:151], v7, s[64:67], s88 offen sc1
    s_add_u32 s88, s88, 4096
    buffer_store_dwordx4 v[152:155], v7, s[64:67], s88 offen sc1
    s_add_u32 s88, s88, 4096
    buffer_store_dwordx4 v[156:159], v7, s[64:67], s88 offen sc1
    s_add_u32 s88, s88, 4096
    s_nop 1
    ds_read_b128 v[128:131], v6 offset:20992
    ds_read_b128 v[132:135], v6 offset:22016
    ds_read_b128 v[136:139], v6 offset:23040
    ds_read_b128 v[140:143], v6 offset:24064
    ds_read_b128 v[144:147], v6 offset:25088
    ds_read_b128 v[148:151], v6 offset:26112
    ds_read_b128 v[152:155], v6 offset:27136
    ds_read_b128 v[156:159], v6 offset:28160
    s_waitcnt lgkmcnt(0)
    buffer_store_dwordx4 v[128:131], v7, s[64:67], s88 offen sc1
    s_add_u32 s88, s88, 4096
    buffer_store_dwordx4 v[132:135], v7, s[64:67], s88 offen sc1
    s_add_u32 s88, s88, 4096
    buffer_store_dwordx4 v[136:139], v7, s[64:67], s88 offen sc1
    s_add_u32 s88, s88, 4096
    buffer_store_dwordx4 v[140:143], v7, s[64:67], s88 offen sc1
    s_add_u32 s88, s88, 4096
    buffer_store_dwordx4 v[144:147], v7, s[64:67], s88 offen sc1
    s_add_u32 s88, s88, 4096
    buffer_store_dwordx4 v[148:151], v7, s[64:67], s88 offen sc1
    s_add_u32 s88, s88, 4096
    buffer_store_dwordx4 v[152:155], v7, s[64:67], s88 offen sc1
    s_add_u32 s88, s88, 4096
    buffer_store_dwordx4 v[156:159], v7, s[64:67], s88 offen sc1
    s_add_u32 s88, s88, 4096
    s_nop 1
    s_waitcnt vmcnt(0)
    s_barrier
    s_cmp_eq_u32 s7, 0
    s_cbranch_scc0 BAR_arr1
    v_mov_b32 v24, 1
    v_mov_b32 v25, 64
    s_mov_b64 exec, 1
    buffer_atomic_add v24, v25, s[84:87], 0 offen sc1
    s_mov_b64 exec, -1
BAR_arr1:
    s_lshr_b32 s4, s3, 1
    s_and_b32 s5, s3, 1
    s_lshl_b32 s11, s4, 17
    s_lshl_b32 s12, s7, 15
    s_add_u32 s88, s11, s12
    v_add_u32 v5, s12, v4
    buffer_load_dwordx4 v[192:195], v4, s[80:83], s88 offen offset:0
    buffer_load_dwordx4 v[196:199], v4, s[80:83], s88 offen offset:1024
    buffer_load_dwordx4 v[200:203], v4, s[80:83], s88 offen offset:2048
    buffer_load_dwordx4 v[204:207], v4, s[80:83], s88 offen offset:3072
    s_add_u32 s88, s88, 4096
    buffer_load_dwordx4 v[208:211], v4, s[80:83], s88 offen offset:0
    buffer_load_dwordx4 v[212:215], v4, s[80:83], s88 offen offset:1024
    buffer_load_dwordx4 v[216:219], v4, s[80:83], s88 offen offset:2048
    buffer_load_dwordx4 v[220:223], v4, s[80:83], s88 offen offset:3072
    s_add_u32 s88, s88, 4096
    buffer_load_dwordx4 v[224:227], v4, s[80:83], s88 offen offset:0
    buffer_load_dwordx4 v[228:231], v4, s[80:83], s88 offen offset:1024
    buffer_load_dwordx4 v[232:235], v4, s[80:83], s88 offen offset:2048
    buffer_load_dwordx4 v[236:239], v4, s[80:83], s88 offen offset:3072
    s_add_u32 s88, s88, 4096
    buffer_load_dwordx4 v[240:243], v4, s[80:83], s88 offen offset:0
    buffer_load_dwordx4 v[244:247], v4, s[80:83], s88 offen offset:1024
    buffer_load_dwordx4 v[248:251], v4, s[80:83], s88 offen offset:2048
    buffer_load_dwordx4 v[252:255], v4, s[80:83], s88 offen offset:3072
    s_add_u32 s88, s88, 4096
    s_waitcnt vmcnt(0)
    ds_write_b128 v5, v[192:195] offset:24576
    ds_write_b128 v5, v[196:199] offset:25600
    ds_write_b128 v5, v[200:203] offset:26624
    ds_write_b128 v5, v[204:207] offset:27648
    ds_write_b128 v5, v[208:211] offset:28672
    ds_write_b128 v5, v[212:215] offset:29696
    ds_write_b128 v5, v[216:219] offset:30720
    ds_write_b128 v5, v[220:223] offset:31744
    ds_write_b128 v5, v[224:227] offset:32768
    ds_write_b128 v5, v[228:231] offset:33792
    ds_write_b128 v5, v[232:235] offset:34816
    ds_write_b128 v5, v[236:239] offset:35840
    ds_write_b128 v5, v[240:243] offset:36864
    ds_write_b128 v5, v[244:247] offset:37888
    ds_write_b128 v5, v[248:251] offset:38912
    ds_write_b128 v5, v[252:255] offset:39936
    s_waitcnt lgkmcnt(0)
    buffer_load_dwordx4 v[192:195], v4, s[80:83], s88 offen offset:0
    buffer_load_dwordx4 v[196:199], v4, s[80:83], s88 offen offset:1024
    buffer_load_dwordx4 v[200:203], v4, s[80:83], s88 offen offset:2048
    buffer_load_dwordx4 v[204:207], v4, s[80:83], s88 offen offset:3072
    s_add_u32 s88, s88, 4096
    buffer_load_dwordx4 v[208:211], v4, s[80:83], s88 offen offset:0
    buffer_load_dwordx4 v[212:215], v4, s[80:83], s88 offen offset:1024
    buffer_load_dwordx4 v[216:219], v4, s[80:83], s88 offen offset:2048
    buffer_load_dwordx4 v[220:223], v4, s[80:83], s88 offen offset:3072
    s_add_u32 s88, s88, 4096
    buffer_load_dwordx4 v[224:227], v4, s[80:83], s88 offen offset:0
    buffer_load_dwordx4 v[228:231], v4, s[80:83], s88 offen offset:1024
    buffer_load_dwordx4 v[232:235], v4, s[80:83], s88 offen offset:2048
    buffer_load_dwordx4 v[236:239], v4, s[80:83], s88 offen offset:3072
    s_add_u32 s88, s88, 4096
    buffer_load_dwordx4 v[240:243], v4, s[80:83], s88 offen offset:0
    buffer_load_dwordx4 v[244:247], v4, s[80:83], s88 offen offset:1024
    buffer_load_dwordx4 v[248:251], v4, s[80:83], s88 offen offset:2048
    buffer_load_dwordx4 v[252:255], v4, s[80:83], s88 offen offset:3072
    s_add_u32 s88, s88, 4096
    s_waitcnt vmcnt(0)
    ds_write_b128 v5, v[192:195] offset:40960
    ds_write_b128 v5, v[196:199] offset:41984
    ds_write_b128 v5, v[200:203] offset:43008
    ds_write_b128 v5, v[204:207] offset:44032
    ds_write_b128 v5, v[208:211] offset:45056
    ds_write_b128 v5, v[212:215] offset:46080
    ds_write_b128 v5, v[216:219] offset:47104
    ds_write_b128 v5, v[220:223] offset:48128
    ds_write_b128 v5, v[224:227] offset:49152
    ds_write_b128 v5, v[228:231] offset:50176
    ds_write_b128 v5, v[232:235] offset:51200
    ds_write_b128 v5, v[236:239] offset:52224
    ds_write_b128 v5, v[240:243] offset:53248
    ds_write_b128 v5, v[244:247] offset:54272
    ds_write_b128 v5, v[248:251] offset:55296
    ds_write_b128 v5, v[252:255] offset:56320
    s_waitcnt lgkmcnt(0)
    v_lshlrev_b32 v7, 18, v2
    v_lshl_add_u32 v7, v3, 4, v7
    s_lshl_b32 s11, s7, 20
    s_lshl_b32 s12, s4, 8
    s_add_u32 s89, s11, s12
    buffer_load_dwordx4 v[64:67], v7, s[60:63], s89 offen
    s_add_u32 s89, s89, 8192
    buffer_load_dwordx4 v[68:71], v7, s[60:63], s89 offen
    s_add_u32 s89, s89, 8192
    buffer_load_dwordx4 v[72:75], v7, s[60:63], s89 offen
    s_add_u32 s89, s89, 8192
    buffer_load_dwordx4 v[76:79], v7, s[60:63], s89 offen
    s_add_u32 s89, s89, 8192
    buffer_load_dwordx4 v[80:83], v7, s[60:63], s89 offen
    s_add_u32 s89, s89, 8192
    buffer_load_dwordx4 v[84:87], v7, s[60:63], s89 offen
    s_add_u32 s89, s89, 8192
    buffer_load_dwordx4 v[88:91], v7, s[60:63], s89 offen
    s_add_u32 s89, s89, 8192
    buffer_load_dwordx4 v[92:95], v7, s[60:63], s89 offen
    s_add_u32 s89, s89, 8192
    buffer_load_dwordx4 v[96:99], v7, s[60:63], s89 offen
    s_add_u32 s89, s89, 8192
    buffer_load_dwordx4 v[100:103], v7, s[60:63], s89 offen
    s_add_u32 s89, s89, 8192
    buffer_load_dwordx4 v[104:107], v7, s[60:63], s89 offen
    s_add_u32 s89, s89, 8192
    buffer_load_dwordx4 v[108:111], v7, s[60:63], s89 offen
    s_add_u32 s89, s89, 8192
    buffer_load_dwordx4 v[112:115], v7, s[60:63], s89 offen
    s_add_u32 s89, s89, 8192
    buffer_load_dwordx4 v[116:119], v7, s[60:63], s89 offen
    s_add_u32 s89, s89, 8192
    buffer_load_dwordx4 v[120:123], v7, s[60:63], s89 offen
    s_add_u32 s89, s89, 8192
    buffer_load_dwordx4 v[124:127], v7, s[60:63], s89 offen
    s_add_u32 s89, s89, 8192
    buffer_load_dwordx4 v[128:131], v7, s[60:63], s89 offen
    s_add_u32 s89, s89, 8192
    buffer_load_dwordx4 v[132:135], v7, s[60:63], s89 offen
    s_add_u32 s89, s89, 8192
    buffer_load_dwordx4 v[136:139], v7, s[60:63], s89 offen
    s_add_u32 s89, s89, 8192
    buffer_load_dwordx4 v[140:143], v7, s[60:63], s89 offen
    s_add_u32 s89, s89, 8192
    buffer_load_dwordx4 v[144:147], v7, s[60:63], s89 offen
    s_add_u32 s89, s89, 8192
    buffer_load_dwordx4 v[148:151], v7, s[60:63], s89 offen
    s_add_u32 s89, s89, 8192
    buffer_load_dwordx4 v[152:155], v7, s[60:63], s89 offen
    s_add_u32 s89, s89, 8192
    buffer_load_dwordx4 v[156:159], v7, s[60:63], s89 offen
    s_add_u32 s89, s89, 8192
    buffer_load_dwordx4 v[160:163], v7, s[60:63], s89 offen
    s_add_u32 s89, s89, 8192
    buffer_load_dwordx4 v[164:167], v7, s[60:63], s89 offen
    s_add_u32 s89, s89, 8192
    buffer_load_dwordx4 v[168:171], v7, s[60:63], s89 offen
    s_add_u32 s89, s89, 8192
    buffer_load_dwordx4 v[172:175], v7, s[60:63], s89 offen
    s_add_u32 s89, s89, 8192
    buffer_load_dwordx4 v[176:179], v7, s[60:63], s89 offen
    s_add_u32 s89, s89, 8192
    buffer_load_dwordx4 v[180:183], v7, s[60:63], s89 offen
    s_add_u32 s89, s89, 8192
    buffer_load_dwordx4 v[184:187], v7, s[60:63], s89 offen
    s_add_u32 s89, s89, 8192
    buffer_load_dwordx4 v[188:191], v7, s[60:63], s89 offen
    s_add_u32 s89, s89, 8192
    s_cmp_eq_u32 s7, 0
    s_cbranch_scc0 BAR_done1
    v_mov_b32 v25, 64
    s_mov_b32 s13, 0
BAR_poll1:
    buffer_load_dword v24, v25, s[84:87], 0 offen sc1
    s_waitcnt vmcnt(0)
    v_readfirstlane_b32 s11, v24
    s_nop 3
    s_cmp_ge_u32 s11, 64
    s_cbranch_scc1 BAR_done1
    s_sleep 1
    s_add_u32 s13, s13, 1
    s_cmp_lt_u32 s13, 0x40000
    s_cbranch_scc1 BAR_poll1
BAR_done1:
    s_barrier
    v_and_b32 v32, 31, v1
    v_lshlrev_b32 v5, 8, v32
    s_lshl_b32 s11, s5, 13
    s_lshl_b32 s12, s4, 3
    s_add_u32 s11, s11, s12
    s_add_u32 s11, s11, 0x200000
    buffer_load_dwordx2 v[24:25], v5, s[64:67], s11 offen sc1
    v_lshlrev_b32 v6, 5, v1
    s_lshl_b32 s11, s5, 21
    s_lshl_b32 s12, s7, 19
    s_add_u32 s11, s11, s12
    s_lshl_b32 s12, s4, 11
    s_add_u32 s11, s11, s12
    s_add_u32 s90, s11, 0x1000000
    buffer_load_dwordx4 v[192:195], v6, s[64:67], s90 offen offset:0 sc1
    buffer_load_dwordx4 v[196:199], v6, s[64:67], s90 offen offset:16 sc1
    s_add_u32 s90, s90, 65536
    buffer_load_dwordx4 v[200:203], v6, s[64:67], s90 offen offset:0 sc1
    buffer_load_dwordx4 v[204:207], v6, s[64:67], s90 offen offset:16 sc1
    s_add_u32 s90, s90, 65536
    buffer_load_dwordx4 v[208:211], v6, s[64:67], s90 offen offset:0 sc1
    buffer_load_dwordx4 v[212:215], v6, s[64:67], s90 offen offset:16 sc1
    s_add_u32 s90, s90, 65536
    buffer_load_dwordx4 v[216:219], v6, s[64:67], s90 offen offset:0 sc1
    buffer_load_dwordx4 v[220:223], v6, s[64:67], s90 offen offset:16 sc1
    s_add_u32 s90, s90, 65536
    buffer_load_dwordx4 v[224:227], v6, s[64:67], s90 offen offset:0 sc1
    buffer_load_dwordx4 v[228:231], v6, s[64:67], s90 offen offset:16 sc1
    s_add_u32 s90, s90, 65536
    buffer_load_dwordx4 v[232:235], v6, s[64:67], s90 offen offset:0 sc1
    buffer_load_dwordx4 v[236:239], v6, s[64:67], s90 offen offset:16 sc1
    s_add_u32 s90, s90, 65536
    buffer_load_dwordx4 v[240:243], v6, s[64:67], s90 offen offset:0 sc1
    buffer_load_dwordx4 v[244:247], v6, s[64:67], s90 offen offset:16 sc1
    s_add_u32 s90, s90, 65536
    buffer_load_dwordx4 v[248:251], v6, s[64:67], s90 offen offset:0 sc1
    buffer_load_dwordx4 v[252:255], v6, s[64:67], s90 offen offset:16 sc1
    s_add_u32 s90, s90, 65536
    s_waitcnt vmcnt(16)
    v_mov_b32 v34, v24
    s_nop 1
    v_max_f32_dpp v34, v34, v34 row_ror:8 row_mask:0xf bank_mask:0xf
    s_nop 1
    v_max_f32_dpp v34, v34, v34 row_ror:4 row_mask:0xf bank_mask:0xf
    s_nop 1
    v_max_f32_dpp v34, v34, v34 row_ror:2 row_mask:0xf bank_mask:0xf
    s_nop 1
    v_max_f32_dpp v34, v34, v34 row_ror:1 row_mask:0xf bank_mask:0xf
    s_nop 1
    v_mov_b32 v35, v34
    s_nop 1
    v_permlane16_swap_b32 v34, v35
    v_max_f32 v34, v34, v35
    v_mov_b32 v35, v34
    s_nop 1
    v_permlane32_swap_b32 v34, v35
    v_max_f32 v34, v34, v35
    v_sub_f32 v34, v24, v34
    v_mul_f32 v34, s69, v34
    v_exp_f32 v28, v34
    s_nop 0
    v_mul_f32 v34, v28, v25
    s_nop 1
    v_add_f32_dpp v34, v34, v34 row_ror:8 row_mask:0xf bank_mask:0xf
    s_nop 1
    v_add_f32_dpp v34, v34, v34 row_ror:4 row_mask:0xf bank_mask:0xf
    s_nop 1
    v_add_f32_dpp v34, v34, v34 row_ror:2 row_mask:0xf bank_mask:0xf
    s_nop 1
    v_add_f32_dpp v34, v34, v34 row_ror:1 row_mask:0xf bank_mask:0xf
    s_nop 1
    v_mov_b32 v35, v34
    s_nop 1
    v_permlane16_swap_b32 v34, v35
    v_add_f32 v34, v34, v35
    v_mov_b32 v35, v34
    s_nop 1
    v_permlane32_swap_b32 v34, v35
    v_add_f32 v34, v34, v35
    v_mul_f32 v34, 0.5, v34
    v_rcp_f32 v34, v34
    s_nop 0
    v_mul_f32 v28, v28, v34
    s_nop 1
    v_mov_b32 v8, 0
    v_mov_b32 v9, 0
    v_mov_b32 v10, 0
    v_mov_b32 v11, 0
    v_mov_b32 v12, 0
    v_mov_b32 v13, 0
    v_mov_b32 v14, 0
    v_mov_b32 v15, 0
    s_lshl_b32 s13, s7, 3
    s_waitcnt vmcnt(0)
    s_add_u32 s11, s13, 0
    v_readlane_b32 s12, v28, s11
    s_nop 1
    v_fmac_f32 v8, s12, v192
    v_fmac_f32 v9, s12, v193
    v_fmac_f32 v10, s12, v194
    v_fmac_f32 v11, s12, v195
    v_fmac_f32 v12, s12, v196
    v_fmac_f32 v13, s12, v197
    v_fmac_f32 v14, s12, v198
    v_fmac_f32 v15, s12, v199
    s_add_u32 s11, s13, 1
    v_readlane_b32 s12, v28, s11
    s_nop 1
    v_fmac_f32 v8, s12, v200
    v_fmac_f32 v9, s12, v201
    v_fmac_f32 v10, s12, v202
    v_fmac_f32 v11, s12, v203
    v_fmac_f32 v12, s12, v204
    v_fmac_f32 v13, s12, v205
    v_fmac_f32 v14, s12, v206
    v_fmac_f32 v15, s12, v207
    s_add_u32 s11, s13, 2
    v_readlane_b32 s12, v28, s11
    s_nop 1
    v_fmac_f32 v8, s12, v208
    v_fmac_f32 v9, s12, v209
    v_fmac_f32 v10, s12, v210
    v_fmac_f32 v11, s12, v211
    v_fmac_f32 v12, s12, v212
    v_fmac_f32 v13, s12, v213
    v_fmac_f32 v14, s12, v214
    v_fmac_f32 v15, s12, v215
    s_add_u32 s11, s13, 3
    v_readlane_b32 s12, v28, s11
    s_nop 1
    v_fmac_f32 v8, s12, v216
    v_fmac_f32 v9, s12, v217
    v_fmac_f32 v10, s12, v218
    v_fmac_f32 v11, s12, v219
    v_fmac_f32 v12, s12, v220
    v_fmac_f32 v13, s12, v221
    v_fmac_f32 v14, s12, v222
    v_fmac_f32 v15, s12, v223
    s_add_u32 s11, s13, 4
    v_readlane_b32 s12, v28, s11
    s_nop 1
    v_fmac_f32 v8, s12, v224
    v_fmac_f32 v9, s12, v225
    v_fmac_f32 v10, s12, v226
    v_fmac_f32 v11, s12, v227
    v_fmac_f32 v12, s12, v228
    v_fmac_f32 v13, s12, v229
    v_fmac_f32 v14, s12, v230
    v_fmac_f32 v15, s12, v231
    s_add_u32 s11, s13, 5
    v_readlane_b32 s12, v28, s11
    s_nop 1
    v_fmac_f32 v8, s12, v232
    v_fmac_f32 v9, s12, v233
    v_fmac_f32 v10, s12, v234
    v_fmac_f32 v11, s12, v235
    v_fmac_f32 v12, s12, v236
    v_fmac_f32 v13, s12, v237
    v_fmac_f32 v14, s12, v238
    v_fmac_f32 v15, s12, v239
    s_add_u32 s11, s13, 6
    v_readlane_b32 s12, v28, s11
    s_nop 1
    v_fmac_f32 v8, s12, v240
    v_fmac_f32 v9, s12, v241
    v_fmac_f32 v10, s12, v242
    v_fmac_f32 v11, s12, v243
    v_fmac_f32 v12, s12, v244
    v_fmac_f32 v13, s12, v245
    v_fmac_f32 v14, s12, v246
    v_fmac_f32 v15, s12, v247
    s_add_u32 s11, s13, 7
    v_readlane_b32 s12, v28, s11
    s_nop 1
    v_fmac_f32 v8, s12, v248
    v_fmac_f32 v9, s12, v249
    v_fmac_f32 v10, s12, v250
    v_fmac_f32 v11, s12, v251
    v_fmac_f32 v12, s12, v252
    v_fmac_f32 v13, s12, v253
    v_fmac_f32 v14, s12, v254
    v_fmac_f32 v15, s12, v255
    s_lshl_b32 s11, s7, 11
    v_add_u32 v5, s11, v6
    ds_write_b128 v5, v[8:11] offset:0
    ds_write_b128 v5, v[12:15] offset:16
    s_waitcnt lgkmcnt(0)
    s_barrier
    v_lshlrev_b32 v5, 7, v2
    s_lshl_b32 s11, s7, 9
    v_add_u32 v5, s11, v5
    ds_read_b128 v[192:195], v5 offset:0
    ds_read_b128 v[196:199], v5 offset:16
    ds_read_b128 v[200:203], v5 offset:32
    ds_read_b128 v[204:207], v5 offset:48
    ds_read_b128 v[208:211], v5 offset:64
    ds_read_b128 v[212:215], v5 offset:80
    ds_read_b128 v[216:219], v5 offset:96
    ds_read_b128 v[220:223], v5 offset:112
    ds_read_b128 v[224:227], v5 offset:2048
    ds_read_b128 v[228:231], v5 offset:2064
    ds_read_b128 v[232:235], v5 offset:2080
    ds_read_b128 v[236:239], v5 offset:2096
    ds_read_b128 v[240:243], v5 offset:2112
    ds_read_b128 v[244:247], v5 offset:2128
    ds_read_b128 v[248:251], v5 offset:2144
    ds_read_b128 v[252:255], v5 offset:2160
    s_waitcnt lgkmcnt(0)
    v_add_f32 v192, v192, v224
    v_add_f32 v193, v193, v225
    v_add_f32 v194, v194, v226
    v_add_f32 v195, v195, v227
    v_add_f32 v196, v196, v228
    v_add_f32 v197, v197, v229
    v_add_f32 v198, v198, v230
    v_add_f32 v199, v199, v231
    v_add_f32 v200, v200, v232
    v_add_f32 v201, v201, v233
    v_add_f32 v202, v202, v234
    v_add_f32 v203, v203, v235
    v_add_f32 v204, v204, v236
    v_add_f32 v205, v205, v237
    v_add_f32 v206, v206, v238
    v_add_f32 v207, v207, v239
    v_add_f32 v208, v208, v240
    v_add_f32 v209, v209, v241
    v_add_f32 v210, v210, v242
    v_add_f32 v211, v211, v243
    v_add_f32 v212, v212, v244
    v_add_f32 v213, v213, v245
    v_add_f32 v214, v214, v246
    v_add_f32 v215, v215, v247
    v_add_f32 v216, v216, v248
    v_add_f32 v217, v217, v249
    v_add_f32 v218, v218, v250
    v_add_f32 v219, v219, v251
    v_add_f32 v220, v220, v252
    v_add_f32 v221, v221, v253
    v_add_f32 v222, v222, v254
    v_add_f32 v223, v223, v255
    ds_read_b128 v[224:227], v5 offset:4096
    ds_read_b128 v[228:231], v5 offset:4112
    ds_read_b128 v[232:235], v5 offset:4128
    ds_read_b128 v[236:239], v5 offset:4144
    ds_read_b128 v[240:243], v5 offset:4160
    ds_read_b128 v[244:247], v5 offset:4176
    ds_read_b128 v[248:251], v5 offset:4192
    ds_read_b128 v[252:255], v5 offset:4208
    s_waitcnt lgkmcnt(0)
    v_add_f32 v192, v192, v224
    v_add_f32 v193, v193, v225
    v_add_f32 v194, v194, v226
    v_add_f32 v195, v195, v227
    v_add_f32 v196, v196, v228
    v_add_f32 v197, v197, v229
    v_add_f32 v198, v198, v230
    v_add_f32 v199, v199, v231
    v_add_f32 v200, v200, v232
    v_add_f32 v201, v201, v233
    v_add_f32 v202, v202, v234
    v_add_f32 v203, v203, v235
    v_add_f32 v204, v204, v236
    v_add_f32 v205, v205, v237
    v_add_f32 v206, v206, v238
    v_add_f32 v207, v207, v239
    v_add_f32 v208, v208, v240
    v_add_f32 v209, v209, v241
    v_add_f32 v210, v210, v242
    v_add_f32 v211, v211, v243
    v_add_f32 v212, v212, v244
    v_add_f32 v213, v213, v245
    v_add_f32 v214, v214, v246
    v_add_f32 v215, v215, v247
    v_add_f32 v216, v216, v248
    v_add_f32 v217, v217, v249
    v_add_f32 v218, v218, v250
    v_add_f32 v219, v219, v251
    v_add_f32 v220, v220, v252
    v_add_f32 v221, v221, v253
    v_add_f32 v222, v222, v254
    v_add_f32 v223, v223, v255
    ds_read_b128 v[224:227], v5 offset:6144
    ds_read_b128 v[228:231], v5 offset:6160
    ds_read_b128 v[232:235], v5 offset:6176
    ds_read_b128 v[236:239], v5 offset:6192
    ds_read_b128 v[240:243], v5 offset:6208
    ds_read_b128 v[244:247], v5 offset:6224
    ds_read_b128 v[248:251], v5 offset:6240
    ds_read_b128 v[252:255], v5 offset:6256
    s_waitcnt lgkmcnt(0)
    v_add_f32 v192, v192, v224
    v_add_f32 v193, v193, v225
    v_add_f32 v194, v194, v226
    v_add_f32 v195, v195, v227
    v_add_f32 v196, v196, v228
    v_add_f32 v197, v197, v229
    v_add_f32 v198, v198, v230
    v_add_f32 v199, v199, v231
    v_add_f32 v200, v200, v232
    v_add_f32 v201, v201, v233
    v_add_f32 v202, v202, v234
    v_add_f32 v203, v203, v235
    v_add_f32 v204, v204, v236
    v_add_f32 v205, v205, v237
    v_add_f32 v206, v206, v238
    v_add_f32 v207, v207, v239
    v_add_f32 v208, v208, v240
    v_add_f32 v209, v209, v241
    v_add_f32 v210, v210, v242
    v_add_f32 v211, v211, v243
    v_add_f32 v212, v212, v244
    v_add_f32 v213, v213, v245
    v_add_f32 v214, v214, v246
    v_add_f32 v215, v215, v247
    v_add_f32 v216, v216, v248
    v_add_f32 v217, v217, v249
    v_add_f32 v218, v218, v250
    v_add_f32 v219, v219, v251
    v_add_f32 v220, v220, v252
    v_add_f32 v221, v221, v253
    v_add_f32 v222, v222, v254
    v_add_f32 v223, v223, v255
    v_mov_b32 v8, 0
    v_mov_b32 v9, 0
    v_mov_b32 v10, 0
    v_mov_b32 v11, 0
    v_mov_b32 v12, 0
    v_mov_b32 v13, 0
    v_mov_b32 v14, 0
    v_mov_b32 v15, 0
    v_lshlrev_b32 v24, 16, v64
    v_and_b32 v28, 0xffff0000, v64
    v_lshlrev_b32 v25, 16, v65
    v_and_b32 v29, 0xffff0000, v65
    v_lshlrev_b32 v26, 16, v66
    v_and_b32 v30, 0xffff0000, v66
    v_lshlrev_b32 v27, 16, v67
    v_and_b32 v31, 0xffff0000, v67
    v_fmac_f32 v8, v192, v24
    v_fmac_f32 v9, v192, v28
    v_fmac_f32 v10, v192, v25
    v_fmac_f32 v11, v192, v29
    v_fmac_f32 v12, v192, v26
    v_fmac_f32 v13, v192, v30
    v_fmac_f32 v14, v192, v27
    v_fmac_f32 v15, v192, v31
    v_lshlrev_b32 v24, 16, v68
    v_and_b32 v28, 0xffff0000, v68
    v_lshlrev_b32 v25, 16, v69
    v_and_b32 v29, 0xffff0000, v69
    v_lshlrev_b32 v26, 16, v70
    v_and_b32 v30, 0xffff0000, v70
    v_lshlrev_b32 v27, 16, v71
    v_and_b32 v31, 0xffff0000, v71
    v_fmac_f32 v8, v193, v24
    v_fmac_f32 v9, v193, v28
    v_fmac_f32 v10, v193, v25
    v_fmac_f32 v11, v193, v29
    v_fmac_f32 v12, v193, v26
    v_fmac_f32 v13, v193, v30
    v_fmac_f32 v14, v193, v27
    v_fmac_f32 v15, v193, v31
    v_lshlrev_b32 v24, 16, v72
    v_and_b32 v28, 0xffff0000, v72
    v_lshlrev_b32 v25, 16, v73
    v_and_b32 v29, 0xffff0000, v73
    v_lshlrev_b32 v26, 16, v74
    v_and_b32 v30, 0xffff0000, v74
    v_lshlrev_b32 v27, 16, v75
    v_and_b32 v31, 0xffff0000, v75
    v_fmac_f32 v8, v194, v24
    v_fmac_f32 v9, v194, v28
    v_fmac_f32 v10, v194, v25
    v_fmac_f32 v11, v194, v29
    v_fmac_f32 v12, v194, v26
    v_fmac_f32 v13, v194, v30
    v_fmac_f32 v14, v194, v27
    v_fmac_f32 v15, v194, v31
    v_lshlrev_b32 v24, 16, v76
    v_and_b32 v28, 0xffff0000, v76
    v_lshlrev_b32 v25, 16, v77
    v_and_b32 v29, 0xffff0000, v77
    v_lshlrev_b32 v26, 16, v78
    v_and_b32 v30, 0xffff0000, v78
    v_lshlrev_b32 v27, 16, v79
    v_and_b32 v31, 0xffff0000, v79
    v_fmac_f32 v8, v195, v24
    v_fmac_f32 v9, v195, v28
    v_fmac_f32 v10, v195, v25
    v_fmac_f32 v11, v195, v29
    v_fmac_f32 v12, v195, v26
    v_fmac_f32 v13, v195, v30
    v_fmac_f32 v14, v195, v27
    v_fmac_f32 v15, v195, v31
    v_lshlrev_b32 v24, 16, v80
    v_and_b32 v28, 0xffff0000, v80
    v_lshlrev_b32 v25, 16, v81
    v_and_b32 v29, 0xffff0000, v81
    v_lshlrev_b32 v26, 16, v82
    v_and_b32 v30, 0xffff0000, v82
    v_lshlrev_b32 v27, 16, v83
    v_and_b32 v31, 0xffff0000, v83
    v_fmac_f32 v8, v196, v24
    v_fmac_f32 v9, v196, v28
    v_fmac_f32 v10, v196, v25
    v_fmac_f32 v11, v196, v29
    v_fmac_f32 v12, v196, v26
    v_fmac_f32 v13, v196, v30
    v_fmac_f32 v14, v196, v27
    v_fmac_f32 v15, v196, v31
    v_lshlrev_b32 v24, 16, v84
    v_and_b32 v28, 0xffff0000, v84
    v_lshlrev_b32 v25, 16, v85
    v_and_b32 v29, 0xffff0000, v85
    v_lshlrev_b32 v26, 16, v86
    v_and_b32 v30, 0xffff0000, v86
    v_lshlrev_b32 v27, 16, v87
    v_and_b32 v31, 0xffff0000, v87
    v_fmac_f32 v8, v197, v24
    v_fmac_f32 v9, v197, v28
    v_fmac_f32 v10, v197, v25
    v_fmac_f32 v11, v197, v29
    v_fmac_f32 v12, v197, v26
    v_fmac_f32 v13, v197, v30
    v_fmac_f32 v14, v197, v27
    v_fmac_f32 v15, v197, v31
    v_lshlrev_b32 v24, 16, v88
    v_and_b32 v28, 0xffff0000, v88
    v_lshlrev_b32 v25, 16, v89
    v_and_b32 v29, 0xffff0000, v89
    v_lshlrev_b32 v26, 16, v90
    v_and_b32 v30, 0xffff0000, v90
    v_lshlrev_b32 v27, 16, v91
    v_and_b32 v31, 0xffff0000, v91
    v_fmac_f32 v8, v198, v24
    v_fmac_f32 v9, v198, v28
    v_fmac_f32 v10, v198, v25
    v_fmac_f32 v11, v198, v29
    v_fmac_f32 v12, v198, v26
    v_fmac_f32 v13, v198, v30
    v_fmac_f32 v14, v198, v27
    v_fmac_f32 v15, v198, v31
    v_lshlrev_b32 v24, 16, v92
    v_and_b32 v28, 0xffff0000, v92
    v_lshlrev_b32 v25, 16, v93
    v_and_b32 v29, 0xffff0000, v93
    v_lshlrev_b32 v26, 16, v94
    v_and_b32 v30, 0xffff0000, v94
    v_lshlrev_b32 v27, 16, v95
    v_and_b32 v31, 0xffff0000, v95
    v_fmac_f32 v8, v199, v24
    v_fmac_f32 v9, v199, v28
    v_fmac_f32 v10, v199, v25
    v_fmac_f32 v11, v199, v29
    v_fmac_f32 v12, v199, v26
    v_fmac_f32 v13, v199, v30
    v_fmac_f32 v14, v199, v27
    v_fmac_f32 v15, v199, v31
    v_lshlrev_b32 v24, 16, v96
    v_and_b32 v28, 0xffff0000, v96
    v_lshlrev_b32 v25, 16, v97
    v_and_b32 v29, 0xffff0000, v97
    v_lshlrev_b32 v26, 16, v98
    v_and_b32 v30, 0xffff0000, v98
    v_lshlrev_b32 v27, 16, v99
    v_and_b32 v31, 0xffff0000, v99
    v_fmac_f32 v8, v200, v24
    v_fmac_f32 v9, v200, v28
    v_fmac_f32 v10, v200, v25
    v_fmac_f32 v11, v200, v29
    v_fmac_f32 v12, v200, v26
    v_fmac_f32 v13, v200, v30
    v_fmac_f32 v14, v200, v27
    v_fmac_f32 v15, v200, v31
    v_lshlrev_b32 v24, 16, v100
    v_and_b32 v28, 0xffff0000, v100
    v_lshlrev_b32 v25, 16, v101
    v_and_b32 v29, 0xffff0000, v101
    v_lshlrev_b32 v26, 16, v102
    v_and_b32 v30, 0xffff0000, v102
    v_lshlrev_b32 v27, 16, v103
    v_and_b32 v31, 0xffff0000, v103
    v_fmac_f32 v8, v201, v24
    v_fmac_f32 v9, v201, v28
    v_fmac_f32 v10, v201, v25
    v_fmac_f32 v11, v201, v29
    v_fmac_f32 v12, v201, v26
    v_fmac_f32 v13, v201, v30
    v_fmac_f32 v14, v201, v27
    v_fmac_f32 v15, v201, v31
    v_lshlrev_b32 v24, 16, v104
    v_and_b32 v28, 0xffff0000, v104
    v_lshlrev_b32 v25, 16, v105
    v_and_b32 v29, 0xffff0000, v105
    v_lshlrev_b32 v26, 16, v106
    v_and_b32 v30, 0xffff0000, v106
    v_lshlrev_b32 v27, 16, v107
    v_and_b32 v31, 0xffff0000, v107
    v_fmac_f32 v8, v202, v24
    v_fmac_f32 v9, v202, v28
    v_fmac_f32 v10, v202, v25
    v_fmac_f32 v11, v202, v29
    v_fmac_f32 v12, v202, v26
    v_fmac_f32 v13, v202, v30
    v_fmac_f32 v14, v202, v27
    v_fmac_f32 v15, v202, v31
    v_lshlrev_b32 v24, 16, v108
    v_and_b32 v28, 0xffff0000, v108
    v_lshlrev_b32 v25, 16, v109
    v_and_b32 v29, 0xffff0000, v109
    v_lshlrev_b32 v26, 16, v110
    v_and_b32 v30, 0xffff0000, v110
    v_lshlrev_b32 v27, 16, v111
    v_and_b32 v31, 0xffff0000, v111
    v_fmac_f32 v8, v203, v24
    v_fmac_f32 v9, v203, v28
    v_fmac_f32 v10, v203, v25
    v_fmac_f32 v11, v203, v29
    v_fmac_f32 v12, v203, v26
    v_fmac_f32 v13, v203, v30
    v_fmac_f32 v14, v203, v27
    v_fmac_f32 v15, v203, v31
    v_lshlrev_b32 v24, 16, v112
    v_and_b32 v28, 0xffff0000, v112
    v_lshlrev_b32 v25, 16, v113
    v_and_b32 v29, 0xffff0000, v113
    v_lshlrev_b32 v26, 16, v114
    v_and_b32 v30, 0xffff0000, v114
    v_lshlrev_b32 v27, 16, v115
    v_and_b32 v31, 0xffff0000, v115
    v_fmac_f32 v8, v204, v24
    v_fmac_f32 v9, v204, v28
    v_fmac_f32 v10, v204, v25
    v_fmac_f32 v11, v204, v29
    v_fmac_f32 v12, v204, v26
    v_fmac_f32 v13, v204, v30
    v_fmac_f32 v14, v204, v27
    v_fmac_f32 v15, v204, v31
    v_lshlrev_b32 v24, 16, v116
    v_and_b32 v28, 0xffff0000, v116
    v_lshlrev_b32 v25, 16, v117
    v_and_b32 v29, 0xffff0000, v117
    v_lshlrev_b32 v26, 16, v118
    v_and_b32 v30, 0xffff0000, v118
    v_lshlrev_b32 v27, 16, v119
    v_and_b32 v31, 0xffff0000, v119
    v_fmac_f32 v8, v205, v24
    v_fmac_f32 v9, v205, v28
    v_fmac_f32 v10, v205, v25
    v_fmac_f32 v11, v205, v29
    v_fmac_f32 v12, v205, v26
    v_fmac_f32 v13, v205, v30
    v_fmac_f32 v14, v205, v27
    v_fmac_f32 v15, v205, v31
    v_lshlrev_b32 v24, 16, v120
    v_and_b32 v28, 0xffff0000, v120
    v_lshlrev_b32 v25, 16, v121
    v_and_b32 v29, 0xffff0000, v121
    v_lshlrev_b32 v26, 16, v122
    v_and_b32 v30, 0xffff0000, v122
    v_lshlrev_b32 v27, 16, v123
    v_and_b32 v31, 0xffff0000, v123
    v_fmac_f32 v8, v206, v24
    v_fmac_f32 v9, v206, v28
    v_fmac_f32 v10, v206, v25
    v_fmac_f32 v11, v206, v29
    v_fmac_f32 v12, v206, v26
    v_fmac_f32 v13, v206, v30
    v_fmac_f32 v14, v206, v27
    v_fmac_f32 v15, v206, v31
    v_lshlrev_b32 v24, 16, v124
    v_and_b32 v28, 0xffff0000, v124
    v_lshlrev_b32 v25, 16, v125
    v_and_b32 v29, 0xffff0000, v125
    v_lshlrev_b32 v26, 16, v126
    v_and_b32 v30, 0xffff0000, v126
    v_lshlrev_b32 v27, 16, v127
    v_and_b32 v31, 0xffff0000, v127
    v_fmac_f32 v8, v207, v24
    v_fmac_f32 v9, v207, v28
    v_fmac_f32 v10, v207, v25
    v_fmac_f32 v11, v207, v29
    v_fmac_f32 v12, v207, v26
    v_fmac_f32 v13, v207, v30
    v_fmac_f32 v14, v207, v27
    v_fmac_f32 v15, v207, v31
    v_lshlrev_b32 v24, 16, v128
    v_and_b32 v28, 0xffff0000, v128
    v_lshlrev_b32 v25, 16, v129
    v_and_b32 v29, 0xffff0000, v129
    v_lshlrev_b32 v26, 16, v130
    v_and_b32 v30, 0xffff0000, v130
    v_lshlrev_b32 v27, 16, v131
    v_and_b32 v31, 0xffff0000, v131
    v_fmac_f32 v8, v208, v24
    v_fmac_f32 v9, v208, v28
    v_fmac_f32 v10, v208, v25
    v_fmac_f32 v11, v208, v29
    v_fmac_f32 v12, v208, v26
    v_fmac_f32 v13, v208, v30
    v_fmac_f32 v14, v208, v27
    v_fmac_f32 v15, v208, v31
    v_lshlrev_b32 v24, 16, v132
    v_and_b32 v28, 0xffff0000, v132
    v_lshlrev_b32 v25, 16, v133
    v_and_b32 v29, 0xffff0000, v133
    v_lshlrev_b32 v26, 16, v134
    v_and_b32 v30, 0xffff0000, v134
    v_lshlrev_b32 v27, 16, v135
    v_and_b32 v31, 0xffff0000, v135
    v_fmac_f32 v8, v209, v24
    v_fmac_f32 v9, v209, v28
    v_fmac_f32 v10, v209, v25
    v_fmac_f32 v11, v209, v29
    v_fmac_f32 v12, v209, v26
    v_fmac_f32 v13, v209, v30
    v_fmac_f32 v14, v209, v27
    v_fmac_f32 v15, v209, v31
    v_lshlrev_b32 v24, 16, v136
    v_and_b32 v28, 0xffff0000, v136
    v_lshlrev_b32 v25, 16, v137
    v_and_b32 v29, 0xffff0000, v137
    v_lshlrev_b32 v26, 16, v138
    v_and_b32 v30, 0xffff0000, v138
    v_lshlrev_b32 v27, 16, v139
    v_and_b32 v31, 0xffff0000, v139
    v_fmac_f32 v8, v210, v24
    v_fmac_f32 v9, v210, v28
    v_fmac_f32 v10, v210, v25
    v_fmac_f32 v11, v210, v29
    v_fmac_f32 v12, v210, v26
    v_fmac_f32 v13, v210, v30
    v_fmac_f32 v14, v210, v27
    v_fmac_f32 v15, v210, v31
    v_lshlrev_b32 v24, 16, v140
    v_and_b32 v28, 0xffff0000, v140
    v_lshlrev_b32 v25, 16, v141
    v_and_b32 v29, 0xffff0000, v141
    v_lshlrev_b32 v26, 16, v142
    v_and_b32 v30, 0xffff0000, v142
    v_lshlrev_b32 v27, 16, v143
    v_and_b32 v31, 0xffff0000, v143
    v_fmac_f32 v8, v211, v24
    v_fmac_f32 v9, v211, v28
    v_fmac_f32 v10, v211, v25
    v_fmac_f32 v11, v211, v29
    v_fmac_f32 v12, v211, v26
    v_fmac_f32 v13, v211, v30
    v_fmac_f32 v14, v211, v27
    v_fmac_f32 v15, v211, v31
    v_lshlrev_b32 v24, 16, v144
    v_and_b32 v28, 0xffff0000, v144
    v_lshlrev_b32 v25, 16, v145
    v_and_b32 v29, 0xffff0000, v145
    v_lshlrev_b32 v26, 16, v146
    v_and_b32 v30, 0xffff0000, v146
    v_lshlrev_b32 v27, 16, v147
    v_and_b32 v31, 0xffff0000, v147
    v_fmac_f32 v8, v212, v24
    v_fmac_f32 v9, v212, v28
    v_fmac_f32 v10, v212, v25
    v_fmac_f32 v11, v212, v29
    v_fmac_f32 v12, v212, v26
    v_fmac_f32 v13, v212, v30
    v_fmac_f32 v14, v212, v27
    v_fmac_f32 v15, v212, v31
    v_lshlrev_b32 v24, 16, v148
    v_and_b32 v28, 0xffff0000, v148
    v_lshlrev_b32 v25, 16, v149
    v_and_b32 v29, 0xffff0000, v149
    v_lshlrev_b32 v26, 16, v150
    v_and_b32 v30, 0xffff0000, v150
    v_lshlrev_b32 v27, 16, v151
    v_and_b32 v31, 0xffff0000, v151
    v_fmac_f32 v8, v213, v24
    v_fmac_f32 v9, v213, v28
    v_fmac_f32 v10, v213, v25
    v_fmac_f32 v11, v213, v29
    v_fmac_f32 v12, v213, v26
    v_fmac_f32 v13, v213, v30
    v_fmac_f32 v14, v213, v27
    v_fmac_f32 v15, v213, v31
    v_lshlrev_b32 v24, 16, v152
    v_and_b32 v28, 0xffff0000, v152
    v_lshlrev_b32 v25, 16, v153
    v_and_b32 v29, 0xffff0000, v153
    v_lshlrev_b32 v26, 16, v154
    v_and_b32 v30, 0xffff0000, v154
    v_lshlrev_b32 v27, 16, v155
    v_and_b32 v31, 0xffff0000, v155
    v_fmac_f32 v8, v214, v24
    v_fmac_f32 v9, v214, v28
    v_fmac_f32 v10, v214, v25
    v_fmac_f32 v11, v214, v29
    v_fmac_f32 v12, v214, v26
    v_fmac_f32 v13, v214, v30
    v_fmac_f32 v14, v214, v27
    v_fmac_f32 v15, v214, v31
    v_lshlrev_b32 v24, 16, v156
    v_and_b32 v28, 0xffff0000, v156
    v_lshlrev_b32 v25, 16, v157
    v_and_b32 v29, 0xffff0000, v157
    v_lshlrev_b32 v26, 16, v158
    v_and_b32 v30, 0xffff0000, v158
    v_lshlrev_b32 v27, 16, v159
    v_and_b32 v31, 0xffff0000, v159
    v_fmac_f32 v8, v215, v24
    v_fmac_f32 v9, v215, v28
    v_fmac_f32 v10, v215, v25
    v_fmac_f32 v11, v215, v29
    v_fmac_f32 v12, v215, v26
    v_fmac_f32 v13, v215, v30
    v_fmac_f32 v14, v215, v27
    v_fmac_f32 v15, v215, v31
    v_lshlrev_b32 v24, 16, v160
    v_and_b32 v28, 0xffff0000, v160
    v_lshlrev_b32 v25, 16, v161
    v_and_b32 v29, 0xffff0000, v161
    v_lshlrev_b32 v26, 16, v162
    v_and_b32 v30, 0xffff0000, v162
    v_lshlrev_b32 v27, 16, v163
    v_and_b32 v31, 0xffff0000, v163
    v_fmac_f32 v8, v216, v24
    v_fmac_f32 v9, v216, v28
    v_fmac_f32 v10, v216, v25
    v_fmac_f32 v11, v216, v29
    v_fmac_f32 v12, v216, v26
    v_fmac_f32 v13, v216, v30
    v_fmac_f32 v14, v216, v27
    v_fmac_f32 v15, v216, v31
    v_lshlrev_b32 v24, 16, v164
    v_and_b32 v28, 0xffff0000, v164
    v_lshlrev_b32 v25, 16, v165
    v_and_b32 v29, 0xffff0000, v165
    v_lshlrev_b32 v26, 16, v166
    v_and_b32 v30, 0xffff0000, v166
    v_lshlrev_b32 v27, 16, v167
    v_and_b32 v31, 0xffff0000, v167
    v_fmac_f32 v8, v217, v24
    v_fmac_f32 v9, v217, v28
    v_fmac_f32 v10, v217, v25
    v_fmac_f32 v11, v217, v29
    v_fmac_f32 v12, v217, v26
    v_fmac_f32 v13, v217, v30
    v_fmac_f32 v14, v217, v27
    v_fmac_f32 v15, v217, v31
    v_lshlrev_b32 v24, 16, v168
    v_and_b32 v28, 0xffff0000, v168
    v_lshlrev_b32 v25, 16, v169
    v_and_b32 v29, 0xffff0000, v169
    v_lshlrev_b32 v26, 16, v170
    v_and_b32 v30, 0xffff0000, v170
    v_lshlrev_b32 v27, 16, v171
    v_and_b32 v31, 0xffff0000, v171
    v_fmac_f32 v8, v218, v24
    v_fmac_f32 v9, v218, v28
    v_fmac_f32 v10, v218, v25
    v_fmac_f32 v11, v218, v29
    v_fmac_f32 v12, v218, v26
    v_fmac_f32 v13, v218, v30
    v_fmac_f32 v14, v218, v27
    v_fmac_f32 v15, v218, v31
    v_lshlrev_b32 v24, 16, v172
    v_and_b32 v28, 0xffff0000, v172
    v_lshlrev_b32 v25, 16, v173
    v_and_b32 v29, 0xffff0000, v173
    v_lshlrev_b32 v26, 16, v174
    v_and_b32 v30, 0xffff0000, v174
    v_lshlrev_b32 v27, 16, v175
    v_and_b32 v31, 0xffff0000, v175
    v_fmac_f32 v8, v219, v24
    v_fmac_f32 v9, v219, v28
    v_fmac_f32 v10, v219, v25
    v_fmac_f32 v11, v219, v29
    v_fmac_f32 v12, v219, v26
    v_fmac_f32 v13, v219, v30
    v_fmac_f32 v14, v219, v27
    v_fmac_f32 v15, v219, v31
    v_lshlrev_b32 v24, 16, v176
    v_and_b32 v28, 0xffff0000, v176
    v_lshlrev_b32 v25, 16, v177
    v_and_b32 v29, 0xffff0000, v177
    v_lshlrev_b32 v26, 16, v178
    v_and_b32 v30, 0xffff0000, v178
    v_lshlrev_b32 v27, 16, v179
    v_and_b32 v31, 0xffff0000, v179
    v_fmac_f32 v8, v220, v24
    v_fmac_f32 v9, v220, v28
    v_fmac_f32 v10, v220, v25
    v_fmac_f32 v11, v220, v29
    v_fmac_f32 v12, v220, v26
    v_fmac_f32 v13, v220, v30
    v_fmac_f32 v14, v220, v27
    v_fmac_f32 v15, v220, v31
    v_lshlrev_b32 v24, 16, v180
    v_and_b32 v28, 0xffff0000, v180
    v_lshlrev_b32 v25, 16, v181
    v_and_b32 v29, 0xffff0000, v181
    v_lshlrev_b32 v26, 16, v182
    v_and_b32 v30, 0xffff0000, v182
    v_lshlrev_b32 v27, 16, v183
    v_and_b32 v31, 0xffff0000, v183
    v_fmac_f32 v8, v221, v24
    v_fmac_f32 v9, v221, v28
    v_fmac_f32 v10, v221, v25
    v_fmac_f32 v11, v221, v29
    v_fmac_f32 v12, v221, v26
    v_fmac_f32 v13, v221, v30
    v_fmac_f32 v14, v221, v27
    v_fmac_f32 v15, v221, v31
    v_lshlrev_b32 v24, 16, v184
    v_and_b32 v28, 0xffff0000, v184
    v_lshlrev_b32 v25, 16, v185
    v_and_b32 v29, 0xffff0000, v185
    v_lshlrev_b32 v26, 16, v186
    v_and_b32 v30, 0xffff0000, v186
    v_lshlrev_b32 v27, 16, v187
    v_and_b32 v31, 0xffff0000, v187
    v_fmac_f32 v8, v222, v24
    v_fmac_f32 v9, v222, v28
    v_fmac_f32 v10, v222, v25
    v_fmac_f32 v11, v222, v29
    v_fmac_f32 v12, v222, v26
    v_fmac_f32 v13, v222, v30
    v_fmac_f32 v14, v222, v27
    v_fmac_f32 v15, v222, v31
    v_lshlrev_b32 v24, 16, v188
    v_and_b32 v28, 0xffff0000, v188
    v_lshlrev_b32 v25, 16, v189
    v_and_b32 v29, 0xffff0000, v189
    v_lshlrev_b32 v26, 16, v190
    v_and_b32 v30, 0xffff0000, v190
    v_lshlrev_b32 v27, 16, v191
    v_and_b32 v31, 0xffff0000, v191
    v_fmac_f32 v8, v223, v24
    v_fmac_f32 v9, v223, v28
    v_fmac_f32 v10, v223, v25
    v_fmac_f32 v11, v223, v29
    v_fmac_f32 v12, v223, v26
    v_fmac_f32 v13, v223, v30
    v_fmac_f32 v14, v223, v27
    v_fmac_f32 v15, v223, v31
    v_lshlrev_b32 v24, 2, v2
    s_lshl_b32 s11, s7, 4
    v_add_u32 v24, s11, v24
    v_lshlrev_b32 v24, 7, v24
    v_lshl_add_u32 v24, v3, 5, v24
    ds_write_b128 v24, v[8:11] offset:8192
    ds_write_b128 v24, v[12:15] offset:8208
    s_waitcnt lgkmcnt(0)
    s_barrier
    v_and_b32 v24, 31, v1
    s_lshl_b32 s11, s7, 5
    v_add_u32 v24, s11, v24
    v_lshlrev_b32 v24, 2, v24
    ds_read_b32 v224, v24 offset:8192
    ds_read_b32 v225, v24 offset:8704
    ds_read_b32 v226, v24 offset:9216
    ds_read_b32 v227, v24 offset:9728
    ds_read_b32 v228, v24 offset:10240
    ds_read_b32 v229, v24 offset:10752
    ds_read_b32 v230, v24 offset:11264
    ds_read_b32 v231, v24 offset:11776
    ds_read_b32 v232, v24 offset:12288
    ds_read_b32 v233, v24 offset:12800
    ds_read_b32 v234, v24 offset:13312
    ds_read_b32 v235, v24 offset:13824
    ds_read_b32 v236, v24 offset:14336
    ds_read_b32 v237, v24 offset:14848
    ds_read_b32 v238, v24 offset:15360
    ds_read_b32 v239, v24 offset:15872
    s_waitcnt lgkmcnt(0)
    v_add_f32 v25, v224, v225
    v_add_f32 v25, v25, v226
    v_add_f32 v25, v25, v227
    v_add_f32 v25, v25, v228
    v_add_f32 v25, v25, v229
    v_add_f32 v25, v25, v230
    v_add_f32 v25, v25, v231
    v_add_f32 v25, v25, v232
    v_add_f32 v25, v25, v233
    v_add_f32 v25, v25, v234
    v_add_f32 v25, v25, v235
    v_add_f32 v25, v25, v236
    v_add_f32 v25, v25, v237
    v_add_f32 v25, v25, v238
    v_add_f32 v25, v25, v239
    s_nop 1
    v_mov_b32_dpp v26, v25 quad_perm:[1,0,3,2] row_mask:0xf bank_mask:0xf
    v_cvt_pk_bf16_f32 v27, v25, v26
    s_nop 1
    v_readlane_b32 s16, v27, 0
    v_readlane_b32 s17, v27, 2
    v_readlane_b32 s18, v27, 4
    v_readlane_b32 s19, v27, 6
    v_readlane_b32 s20, v27, 8
    v_readlane_b32 s21, v27, 10
    v_readlane_b32 s22, v27, 12
    v_readlane_b32 s23, v27, 14
    v_readlane_b32 s24, v27, 16
    v_readlane_b32 s25, v27, 18
    v_readlane_b32 s26, v27, 20
    v_readlane_b32 s27, v27, 22
    v_readlane_b32 s28, v27, 24
    v_readlane_b32 s29, v27, 26
    v_readlane_b32 s30, v27, 28
    v_readlane_b32 s31, v27, 30
    v_mov_b32 v8, 0
    v_mov_b32 v9, 0
    v_mov_b32 v10, 0
    v_mov_b32 v11, 0
    v_mov_b32 v12, 0
    v_mov_b32 v13, 0
    v_mov_b32 v14, 0
    v_mov_b32 v15, 0
    s_lshl_b32 s11, s7, 15
    v_add_u32 v5, s11, v4
    s_nop 1
    ds_read_b128 v[192:195], v5 offset:24576
    ds_read_b128 v[196:199], v5 offset:25600
    ds_read_b128 v[200:203], v5 offset:26624
    ds_read_b128 v[204:207], v5 offset:27648
    ds_read_b128 v[208:211], v5 offset:28672
    ds_read_b128 v[212:215], v5 offset:29696
    ds_read_b128 v[216:219], v5 offset:30720
    ds_read_b128 v[220:223], v5 offset:31744
    s_waitcnt lgkmcnt(0)
    v_perm_b32 v24, v196, v192, s71
    v_perm_b32 v25, v196, v192, s72
    v_dot2_f32_bf16 v8, v24, s16, v8
    v_dot2_f32_bf16 v9, v25, s16, v9
    v_perm_b32 v24, v197, v193, s71
    v_perm_b32 v25, v197, v193, s72
    v_dot2_f32_bf16 v10, v24, s16, v10
    v_dot2_f32_bf16 v11, v25, s16, v11
    v_perm_b32 v24, v198, v194, s71
    v_perm_b32 v25, v198, v194, s72
    v_dot2_f32_bf16 v12, v24, s16, v12
    v_dot2_f32_bf16 v13, v25, s16, v13
    v_perm_b32 v24, v199, v195, s71
    v_perm_b32 v25, v199, v195, s72
    v_dot2_f32_bf16 v14, v24, s16, v14
    v_dot2_f32_bf16 v15, v25, s16, v15
    v_perm_b32 v24, v204, v200, s71
    v_perm_b32 v25, v204, v200, s72
    v_dot2_f32_bf16 v8, v24, s17, v8
    v_dot2_f32_bf16 v9, v25, s17, v9
    v_perm_b32 v24, v205, v201, s71
    v_perm_b32 v25, v205, v201, s72
    v_dot2_f32_bf16 v10, v24, s17, v10
    v_dot2_f32_bf16 v11, v25, s17, v11
    v_perm_b32 v24, v206, v202, s71
    v_perm_b32 v25, v206, v202, s72
    v_dot2_f32_bf16 v12, v24, s17, v12
    v_dot2_f32_bf16 v13, v25, s17, v13
    v_perm_b32 v24, v207, v203, s71
    v_perm_b32 v25, v207, v203, s72
    v_dot2_f32_bf16 v14, v24, s17, v14
    v_dot2_f32_bf16 v15, v25, s17, v15
    v_perm_b32 v24, v212, v208, s71
    v_perm_b32 v25, v212, v208, s72
    v_dot2_f32_bf16 v8, v24, s18, v8
    v_dot2_f32_bf16 v9, v25, s18, v9
    v_perm_b32 v24, v213, v209, s71
    v_perm_b32 v25, v213, v209, s72
    v_dot2_f32_bf16 v10, v24, s18, v10
    v_dot2_f32_bf16 v11, v25, s18, v11
    v_perm_b32 v24, v214, v210, s71
    v_perm_b32 v25, v214, v210, s72
    v_dot2_f32_bf16 v12, v24, s18, v12
    v_dot2_f32_bf16 v13, v25, s18, v13
    v_perm_b32 v24, v215, v211, s71
    v_perm_b32 v25, v215, v211, s72
    v_dot2_f32_bf16 v14, v24, s18, v14
    v_dot2_f32_bf16 v15, v25, s18, v15
    v_perm_b32 v24, v220, v216, s71
    v_perm_b32 v25, v220, v216, s72
    v_dot2_f32_bf16 v8, v24, s19, v8
    v_dot2_f32_bf16 v9, v25, s19, v9
    v_perm_b32 v24, v221, v217, s71
    v_perm_b32 v25, v221, v217, s72
    v_dot2_f32_bf16 v10, v24, s19, v10
    v_dot2_f32_bf16 v11, v25, s19, v11
    v_perm_b32 v24, v222, v218, s71
    v_perm_b32 v25, v222, v218, s72
    v_dot2_f32_bf16 v12, v24, s19, v12
    v_dot2_f32_bf16 v13, v25, s19, v13
    v_perm_b32 v24, v223, v219, s71
    v_perm_b32 v25, v223, v219, s72
    v_dot2_f32_bf16 v14, v24, s19, v14
    v_dot2_f32_bf16 v15, v25, s19, v15
    ds_read_b128 v[192:195], v5 offset:32768
    ds_read_b128 v[196:199], v5 offset:33792
    ds_read_b128 v[200:203], v5 offset:34816
    ds_read_b128 v[204:207], v5 offset:35840
    ds_read_b128 v[208:211], v5 offset:36864
    ds_read_b128 v[212:215], v5 offset:37888
    ds_read_b128 v[216:219], v5 offset:38912
    ds_read_b128 v[220:223], v5 offset:39936
    s_waitcnt lgkmcnt(0)
    v_perm_b32 v24, v196, v192, s71
    v_perm_b32 v25, v196, v192, s72
    v_dot2_f32_bf16 v8, v24, s20, v8
    v_dot2_f32_bf16 v9, v25, s20, v9
    v_perm_b32 v24, v197, v193, s71
    v_perm_b32 v25, v197, v193, s72
    v_dot2_f32_bf16 v10, v24, s20, v10
    v_dot2_f32_bf16 v11, v25, s20, v11
    v_perm_b32 v24, v198, v194, s71
    v_perm_b32 v25, v198, v194, s72
    v_dot2_f32_bf16 v12, v24, s20, v12
    v_dot2_f32_bf16 v13, v25, s20, v13
    v_perm_b32 v24, v199, v195, s71
    v_perm_b32 v25, v199, v195, s72
    v_dot2_f32_bf16 v14, v24, s20, v14
    v_dot2_f32_bf16 v15, v25, s20, v15
    v_perm_b32 v24, v204, v200, s71
    v_perm_b32 v25, v204, v200, s72
    v_dot2_f32_bf16 v8, v24, s21, v8
    v_dot2_f32_bf16 v9, v25, s21, v9
    v_perm_b32 v24, v205, v201, s71
    v_perm_b32 v25, v205, v201, s72
    v_dot2_f32_bf16 v10, v24, s21, v10
    v_dot2_f32_bf16 v11, v25, s21, v11
    v_perm_b32 v24, v206, v202, s71
    v_perm_b32 v25, v206, v202, s72
    v_dot2_f32_bf16 v12, v24, s21, v12
    v_dot2_f32_bf16 v13, v25, s21, v13
    v_perm_b32 v24, v207, v203, s71
    v_perm_b32 v25, v207, v203, s72
    v_dot2_f32_bf16 v14, v24, s21, v14
    v_dot2_f32_bf16 v15, v25, s21, v15
    v_perm_b32 v24, v212, v208, s71
    v_perm_b32 v25, v212, v208, s72
    v_dot2_f32_bf16 v8, v24, s22, v8
    v_dot2_f32_bf16 v9, v25, s22, v9
    v_perm_b32 v24, v213, v209, s71
    v_perm_b32 v25, v213, v209, s72
    v_dot2_f32_bf16 v10, v24, s22, v10
    v_dot2_f32_bf16 v11, v25, s22, v11
    v_perm_b32 v24, v214, v210, s71
    v_perm_b32 v25, v214, v210, s72
    v_dot2_f32_bf16 v12, v24, s22, v12
    v_dot2_f32_bf16 v13, v25, s22, v13
    v_perm_b32 v24, v215, v211, s71
    v_perm_b32 v25, v215, v211, s72
    v_dot2_f32_bf16 v14, v24, s22, v14
    v_dot2_f32_bf16 v15, v25, s22, v15
    v_perm_b32 v24, v220, v216, s71
    v_perm_b32 v25, v220, v216, s72
    v_dot2_f32_bf16 v8, v24, s23, v8
    v_dot2_f32_bf16 v9, v25, s23, v9
    v_perm_b32 v24, v221, v217, s71
    v_perm_b32 v25, v221, v217, s72
    v_dot2_f32_bf16 v10, v24, s23, v10
    v_dot2_f32_bf16 v11, v25, s23, v11
    v_perm_b32 v24, v222, v218, s71
    v_perm_b32 v25, v222, v218, s72
    v_dot2_f32_bf16 v12, v24, s23, v12
    v_dot2_f32_bf16 v13, v25, s23, v13
    v_perm_b32 v24, v223, v219, s71
    v_perm_b32 v25, v223, v219, s72
    v_dot2_f32_bf16 v14, v24, s23, v14
    v_dot2_f32_bf16 v15, v25, s23, v15
    ds_read_b128 v[192:195], v5 offset:40960
    ds_read_b128 v[196:199], v5 offset:41984
    ds_read_b128 v[200:203], v5 offset:43008
    ds_read_b128 v[204:207], v5 offset:44032
    ds_read_b128 v[208:211], v5 offset:45056
    ds_read_b128 v[212:215], v5 offset:46080
    ds_read_b128 v[216:219], v5 offset:47104
    ds_read_b128 v[220:223], v5 offset:48128
    s_waitcnt lgkmcnt(0)
    v_perm_b32 v24, v196, v192, s71
    v_perm_b32 v25, v196, v192, s72
    v_dot2_f32_bf16 v8, v24, s24, v8
    v_dot2_f32_bf16 v9, v25, s24, v9
    v_perm_b32 v24, v197, v193, s71
    v_perm_b32 v25, v197, v193, s72
    v_dot2_f32_bf16 v10, v24, s24, v10
    v_dot2_f32_bf16 v11, v25, s24, v11
    v_perm_b32 v24, v198, v194, s71
    v_perm_b32 v25, v198, v194, s72
    v_dot2_f32_bf16 v12, v24, s24, v12
    v_dot2_f32_bf16 v13, v25, s24, v13
    v_perm_b32 v24, v199, v195, s71
    v_perm_b32 v25, v199, v195, s72
    v_dot2_f32_bf16 v14, v24, s24, v14
    v_dot2_f32_bf16 v15, v25, s24, v15
    v_perm_b32 v24, v204, v200, s71
    v_perm_b32 v25, v204, v200, s72
    v_dot2_f32_bf16 v8, v24, s25, v8
    v_dot2_f32_bf16 v9, v25, s25, v9
    v_perm_b32 v24, v205, v201, s71
    v_perm_b32 v25, v205, v201, s72
    v_dot2_f32_bf16 v10, v24, s25, v10
    v_dot2_f32_bf16 v11, v25, s25, v11
    v_perm_b32 v24, v206, v202, s71
    v_perm_b32 v25, v206, v202, s72
    v_dot2_f32_bf16 v12, v24, s25, v12
    v_dot2_f32_bf16 v13, v25, s25, v13
    v_perm_b32 v24, v207, v203, s71
    v_perm_b32 v25, v207, v203, s72
    v_dot2_f32_bf16 v14, v24, s25, v14
    v_dot2_f32_bf16 v15, v25, s25, v15
    v_perm_b32 v24, v212, v208, s71
    v_perm_b32 v25, v212, v208, s72
    v_dot2_f32_bf16 v8, v24, s26, v8
    v_dot2_f32_bf16 v9, v25, s26, v9
    v_perm_b32 v24, v213, v209, s71
    v_perm_b32 v25, v213, v209, s72
    v_dot2_f32_bf16 v10, v24, s26, v10
    v_dot2_f32_bf16 v11, v25, s26, v11
    v_perm_b32 v24, v214, v210, s71
    v_perm_b32 v25, v214, v210, s72
    v_dot2_f32_bf16 v12, v24, s26, v12
    v_dot2_f32_bf16 v13, v25, s26, v13
    v_perm_b32 v24, v215, v211, s71
    v_perm_b32 v25, v215, v211, s72
    v_dot2_f32_bf16 v14, v24, s26, v14
    v_dot2_f32_bf16 v15, v25, s26, v15
    v_perm_b32 v24, v220, v216, s71
    v_perm_b32 v25, v220, v216, s72
    v_dot2_f32_bf16 v8, v24, s27, v8
    v_dot2_f32_bf16 v9, v25, s27, v9
    v_perm_b32 v24, v221, v217, s71
    v_perm_b32 v25, v221, v217, s72
    v_dot2_f32_bf16 v10, v24, s27, v10
    v_dot2_f32_bf16 v11, v25, s27, v11
    v_perm_b32 v24, v222, v218, s71
    v_perm_b32 v25, v222, v218, s72
    v_dot2_f32_bf16 v12, v24, s27, v12
    v_dot2_f32_bf16 v13, v25, s27, v13
    v_perm_b32 v24, v223, v219, s71
    v_perm_b32 v25, v223, v219, s72
    v_dot2_f32_bf16 v14, v24, s27, v14
    v_dot2_f32_bf16 v15, v25, s27, v15
    ds_read_b128 v[192:195], v5 offset:49152
    ds_read_b128 v[196:199], v5 offset:50176
    ds_read_b128 v[200:203], v5 offset:51200
    ds_read_b128 v[204:207], v5 offset:52224
    ds_read_b128 v[208:211], v5 offset:53248
    ds_read_b128 v[212:215], v5 offset:54272
    ds_read_b128 v[216:219], v5 offset:55296
    ds_read_b128 v[220:223], v5 offset:56320
    s_waitcnt lgkmcnt(0)
    v_perm_b32 v24, v196, v192, s71
    v_perm_b32 v25, v196, v192, s72
    v_dot2_f32_bf16 v8, v24, s28, v8
    v_dot2_f32_bf16 v9, v25, s28, v9
    v_perm_b32 v24, v197, v193, s71
    v_perm_b32 v25, v197, v193, s72
    v_dot2_f32_bf16 v10, v24, s28, v10
    v_dot2_f32_bf16 v11, v25, s28, v11
    v_perm_b32 v24, v198, v194, s71
    v_perm_b32 v25, v198, v194, s72
    v_dot2_f32_bf16 v12, v24, s28, v12
    v_dot2_f32_bf16 v13, v25, s28, v13
    v_perm_b32 v24, v199, v195, s71
    v_perm_b32 v25, v199, v195, s72
    v_dot2_f32_bf16 v14, v24, s28, v14
    v_dot2_f32_bf16 v15, v25, s28, v15
    v_perm_b32 v24, v204, v200, s71
    v_perm_b32 v25, v204, v200, s72
    v_dot2_f32_bf16 v8, v24, s29, v8
    v_dot2_f32_bf16 v9, v25, s29, v9
    v_perm_b32 v24, v205, v201, s71
    v_perm_b32 v25, v205, v201, s72
    v_dot2_f32_bf16 v10, v24, s29, v10
    v_dot2_f32_bf16 v11, v25, s29, v11
    v_perm_b32 v24, v206, v202, s71
    v_perm_b32 v25, v206, v202, s72
    v_dot2_f32_bf16 v12, v24, s29, v12
    v_dot2_f32_bf16 v13, v25, s29, v13
    v_perm_b32 v24, v207, v203, s71
    v_perm_b32 v25, v207, v203, s72
    v_dot2_f32_bf16 v14, v24, s29, v14
    v_dot2_f32_bf16 v15, v25, s29, v15
    v_perm_b32 v24, v212, v208, s71
    v_perm_b32 v25, v212, v208, s72
    v_dot2_f32_bf16 v8, v24, s30, v8
    v_dot2_f32_bf16 v9, v25, s30, v9
    v_perm_b32 v24, v213, v209, s71
    v_perm_b32 v25, v213, v209, s72
    v_dot2_f32_bf16 v10, v24, s30, v10
    v_dot2_f32_bf16 v11, v25, s30, v11
    v_perm_b32 v24, v214, v210, s71
    v_perm_b32 v25, v214, v210, s72
    v_dot2_f32_bf16 v12, v24, s30, v12
    v_dot2_f32_bf16 v13, v25, s30, v13
    v_perm_b32 v24, v215, v211, s71
    v_perm_b32 v25, v215, v211, s72
    v_dot2_f32_bf16 v14, v24, s30, v14
    v_dot2_f32_bf16 v15, v25, s30, v15
    v_perm_b32 v24, v220, v216, s71
    v_perm_b32 v25, v220, v216, s72
    v_dot2_f32_bf16 v8, v24, s31, v8
    v_dot2_f32_bf16 v9, v25, s31, v9
    v_perm_b32 v24, v221, v217, s71
    v_perm_b32 v25, v221, v217, s72
    v_dot2_f32_bf16 v10, v24, s31, v10
    v_dot2_f32_bf16 v11, v25, s31, v11
    v_perm_b32 v24, v222, v218, s71
    v_perm_b32 v25, v222, v218, s72
    v_dot2_f32_bf16 v12, v24, s31, v12
    v_dot2_f32_bf16 v13, v25, s31, v13
    v_perm_b32 v24, v223, v219, s71
    v_perm_b32 v25, v223, v219, s72
    v_dot2_f32_bf16 v14, v24, s31, v14
    v_dot2_f32_bf16 v15, v25, s31, v15
    s_nop 3
    v_lshlrev_b32 v24, 5, v1
    s_lshl_b32 s11, s7, 11
    v_add_u32 v24, s11, v24
    ds_write_b128 v24, v[8:11] offset:16384
    ds_write_b128 v24, v[12:15] offset:16400
    s_waitcnt lgkmcnt(0)
    s_barrier
    v_lshlrev_b32 v24, 3, v0
    ds_read_b64 v[32:33], v24 offset:16384
    ds_read_b64 v[34:35], v24 offset:18432
    ds_read_b64 v[36:37], v24 offset:20480
    ds_read_b64 v[38:39], v24 offset:22528
    s_waitcnt lgkmcnt(0)
    v_add_f32 v32, v32, v34
    v_add_f32 v36, v36, v38
    v_add_f32 v33, v33, v35
    v_add_f32 v37, v37, v39
    v_add_f32 v32, v32, v36
    v_add_f32 v33, v33, v37
    s_lshl_b32 s11, s5, 5
    s_add_u32 s11, s11, s4
    s_lshl_b32 s11, s11, 11
    s_add_u32 s11, s11, 0x400000
    buffer_store_dwordx2 v[32:33], v24, s[64:67], s11 offen sc1
    s_waitcnt vmcnt(0)
FIN:
    s_waitcnt vmcnt(0) lgkmcnt(0)
    s_barrier
    s_mov_b32 s84, s40
    s_and_b32 s85, s41, 0xffff
    s_mov_b32 s86, 0x100
    s_mov_b32 s87, 0x00020000
    s_cmp_eq_u32 s7, 0
    s_cbranch_scc0 FIN_wait
    v_mov_b32 v24, 1
    v_mov_b32 v25, 192
    s_mov_b64 exec, 1
    buffer_atomic_add v24, v25, s[84:87], 0 offen sc0 sc1
    s_waitcnt vmcnt(0)
    s_mov_b64 exec, -1
    v_readfirstlane_b32 s11, v24
    s_nop 3
    v_mov_b32 v24, s11
    v_mov_b32 v25, 0
    ds_write_b32 v25, v24
FIN_wait:
    s_waitcnt lgkmcnt(0)
    s_barrier
    v_mov_b32 v25, 0
    ds_read_b32 v24, v25
    s_waitcnt lgkmcnt(0)
    v_readfirstlane_b32 s11, v24
    s_nop 3
    s_cmp_lt_u32 s11, 224
    s_cbranch_scc1 MAIN_exit
    s_sub_u32 s2, s11, 224
    s_barrier
    s_cmp_eq_u32 s7, 0
    s_cbranch_scc0 FIN_go
    v_mov_b32 v25, 192
    s_mov_b32 s13, 0
FIN_poll:
    buffer_load_dword v24, v25, s[84:87], 0 offen sc1
    s_waitcnt vmcnt(0)
    v_readfirstlane_b32 s11, v24
    s_nop 3
    s_cmp_ge_u32 s11, 256
    s_cbranch_scc1 FIN_go
    s_sleep 1
    s_add_u32 s13, s13, 1
    s_cmp_lt_u32 s13, 0x40000
    s_cbranch_scc1 FIN_poll
FIN_go:
    s_barrier
    s_mov_b32 s44, s42
    s_and_b32 s45, s43, 0xffff
    s_mov_b32 s46, 0x10000000
    s_mov_b32 s47, 0x00020000
    s_mov_b32 s48, s38
    s_and_b32 s49, s39, 0xffff
    s_mov_b32 s50, 0x1000
    s_mov_b32 s51, 0x00020000
    s_lshr_b32 s4, s2, 4
    s_lshr_b32 s5, s2, 3
    s_and_b32 s5, s5, 1
    s_and_b32 s6, s2, 7
    v_readfirstlane_b32 s7, v0
    s_nop 3
    s_lshr_b32 s7, s7, 6
    v_and_b32 v1, 63, v0
    s_mov_b32 s69, 0x3fb8aa3b
    s_mov_b32 s70, 0xbfb8aa3b
    v_mov_b32 v10, 0
    s_cmp_eq_u32 s4, 0
    s_cbranch_scc0 K3_partB
    v_and_b32 v2, 31, v1
    s_lshl_b32 s8, s5, 7
    s_lshl_b32 s9, s7, 5
    s_add_u32 s8, s8, s9
    v_lshlrev_b32 v3, 3, v2
    s_lshl_b32 s9, s8, 3
    s_add_u32 s9, s9, 0x80000
    buffer_load_dwordx2 v[4:5], v3, s[44:47], s9 offen sc1
    v_lshlrev_b32 v3, 2, v1
    s_lshl_b32 s9, s8, 11
    s_lshl_b32 s10, s6, 8
    s_add_u32 s9, s9, s10
    s_add_u32 s9, s9, 0x0
    buffer_load_dword v16, v3, s[44:47], s9 offen sc1
    s_add_u32 s9, s9, 2048
    buffer_load_dword v17, v3, s[44:47], s9 offen sc1
    s_add_u32 s9, s9, 2048
    buffer_load_dword v18, v3, s[44:47], s9 offen sc1
    s_add_u32 s9, s9, 2048
    s_add_u32 s9, s9, 2048
    buffer_load_dword v20, v3, s[44:47], s9 offen sc1
    s_add_u32 s9, s9, 2048
    buffer_load_dword v21, v3, s[44:47], s9 offen sc1
    s_add_u32 s9, s9, 2048
    buffer_load_dword v22, v3, s[44:47], s9 offen sc1
    s_add_u32 s9, s9, 2048
    s_add_u32 s9, s9, 2048
    buffer_load_dword v24, v3, s[44:47], s9 offen sc1
    s_add_u32 s9, s9, 2048
    buffer_load_dword v25, v3, s[44:47], s9 offen sc1
    s_add_u32 s9, s9, 2048
    buffer_load_dword v26, v3, s[44:47], s9 offen sc1
    s_add_u32 s9, s9, 2048
    s_add_u32 s9, s9, 2048
    buffer_load_dword v28, v3, s[44:47], s9 offen sc1
    s_add_u32 s9, s9, 2048
    buffer_load_dword v29, v3, s[44:47], s9 offen sc1
    s_add_u32 s9, s9, 2048
    buffer_load_dword v30, v3, s[44:47], s9 offen sc1
    s_add_u32 s9, s9, 2048
    s_add_u32 s9, s9, 2048
    buffer_load_dword v32, v3, s[44:47], s9 offen sc1
    s_add_u32 s9, s9, 2048
    buffer_load_dword v33, v3, s[44:47], s9 offen sc1
    s_add_u32 s9, s9, 2048
    buffer_load_dword v34, v3, s[44:47], s9 offen sc1
    s_add_u32 s9, s9, 2048
    s_add_u32 s9, s9, 2048
    buffer_load_dword v36, v3, s[44:47], s9 offen sc1
    s_add_u32 s9, s9, 2048
    buffer_load_dword v37, v3, s[44:47], s9 offen sc1
    s_add_u32 s9, s9, 2048
    buffer_load_dword v38, v3, s[44:47], s9 offen sc1
    s_add_u32 s9, s9, 2048
    s_add_u32 s9, s9, 2048
    buffer_load_dword v40, v3, s[44:47], s9 offen sc1
    s_add_u32 s9, s9, 2048
    buffer_load_dword v41, v3, s[44:47], s9 offen sc1
    s_add_u32 s9, s9, 2048
    buffer_load_dword v42, v3, s[44:47], s9 offen sc1
    s_add_u32 s9, s9, 2048
    s_add_u32 s9, s9, 2048
    buffer_load_dword v44, v3, s[44:47], s9 offen sc1
    s_add_u32 s9, s9, 2048
    buffer_load_dword v45, v3, s[44:47], s9 offen sc1
    s_add_u32 s9, s9, 2048
    buffer_load_dword v46, v3, s[44:47], s9 offen sc1
    s_add_u32 s9, s9, 2048
    s_add_u32 s9, s9, 2048
    s_waitcnt vmcnt(24)
    v_and_b32 v6, 3, v1
    v_cmp_eq_u32 vcc, 3, v6
    s_nop 1
    v_mov_b32 v7, 0xff800000
    v_cndmask_b32 v4, v4, v7, vcc
    v_cndmask_b32 v5, v5, v10, vcc
    s_nop 1
    v_mov_b32_dpp v6, v4 quad_perm:[1,0,3,2] row_mask:0xf bank_mask:0xf
    v_max_f32 v6, v6, v4
    s_nop 1
    v_mov_b32_dpp v7, v6 quad_perm:[2,3,0,1] row_mask:0xf bank_mask:0xf
    v_max_f32 v6, v6, v7
    v_sub_f32 v7, v4, v6
    v_mul_f32 v7, s69, v7
    v_exp_f32 v7, v7
    s_nop 0
    v_mul_f32 v8, v7, v5
    s_nop 1
    v_mov_b32_dpp v9, v8 quad_perm:[1,0,3,2] row_mask:0xf bank_mask:0xf
    v_add_f32 v8, v8, v9
    s_nop 1
    v_mov_b32_dpp v9, v8 quad_perm:[2,3,0,1] row_mask:0xf bank_mask:0xf
    v_add_f32 v8, v8, v9
    v_rcp_f32 v8, v8
    s_nop 0
    v_mul_f32 v7, v7, v8
    s_nop 1
    v_readlane_b32 s16, v7, 0
    v_readlane_b32 s17, v7, 1
    v_readlane_b32 s18, v7, 2
    v_readlane_b32 s19, v7, 3
    v_readlane_b32 s20, v7, 4
    v_readlane_b32 s21, v7, 5
    v_readlane_b32 s22, v7, 6
    v_readlane_b32 s23, v7, 7
    v_readlane_b32 s24, v7, 8
    v_readlane_b32 s25, v7, 9
    v_readlane_b32 s26, v7, 10
    v_readlane_b32 s27, v7, 11
    v_readlane_b32 s28, v7, 12
    v_readlane_b32 s29, v7, 13
    v_readlane_b32 s30, v7, 14
    v_readlane_b32 s31, v7, 15
    v_readlane_b32 s32, v7, 16
    v_readlane_b32 s33, v7, 17
    v_readlane_b32 s34, v7, 18
    v_readlane_b32 s35, v7, 19
    v_readlane_b32 s36, v7, 20
    v_readlane_b32 s37, v7, 21
    v_readlane_b32 s38, v7, 22
    v_readlane_b32 s39, v7, 23
    v_readlane_b32 s40, v7, 24
    v_readlane_b32 s41, v7, 25
    v_readlane_b32 s42, v7, 26
    v_readlane_b32 s43, v7, 27
    v_readlane_b32 s44, v7, 28
    v_readlane_b32 s45, v7, 29
    v_readlane_b32 s46, v7, 30
    v_readlane_b32 s47, v7, 31
    s_nop 3
    s_waitcnt vmcnt(0)
    v_fma_f32 v10, s16, v16, v10
    v_fma_f32 v10, s17, v17, v10
    v_fma_f32 v10, s18, v18, v10
    v_fma_f32 v10, s20, v20, v10
    v_fma_f32 v10, s21, v21, v10
    v_fma_f32 v10, s22, v22, v10
    v_fma_f32 v10, s24, v24, v10
    v_fma_f32 v10, s25, v25, v10
    v_fma_f32 v10, s26, v26, v10
    v_fma_f32 v10, s28, v28, v10
    v_fma_f32 v10, s29, v29, v10
    v_fma_f32 v10, s30, v30, v10
    v_fma_f32 v10, s32, v32, v10
    v_fma_f32 v10, s33, v33, v10
    v_fma_f32 v10, s34, v34, v10
    v_fma_f32 v10, s36, v36, v10
    v_fma_f32 v10, s37, v37, v10
    v_fma_f32 v10, s38, v38, v10
    v_fma_f32 v10, s40, v40, v10
    v_fma_f32 v10, s41, v41, v10
    v_fma_f32 v10, s42, v42, v10
    v_fma_f32 v10, s44, v44, v10
    v_fma_f32 v10, s45, v45, v10
    v_fma_f32 v10, s46, v46, v10
    s_branch K3_reduce
K3_partB:
    v_lshlrev_b32 v3, 2, v1
    s_lshl_b32 s8, s5, 5
    s_lshl_b32 s9, s7, 3
    s_add_u32 s8, s8, s9
    s_lshl_b32 s9, s8, 11
    s_lshl_b32 s10, s6, 8
    s_add_u32 s9, s9, s10
    s_add_u32 s9, s9, 0x400000
    buffer_load_dword v16, v3, s[44:47], s9 offen sc1
    s_add_u32 s9, s9, 2048
    buffer_load_dword v17, v3, s[44:47], s9 offen sc1
    s_add_u32 s9, s9, 2048
    buffer_load_dword v18, v3, s[44:47], s9 offen sc1
    s_add_u32 s9, s9, 2048
    buffer_load_dword v19, v3, s[44:47], s9 offen sc1
    s_add_u32 s9, s9, 2048
    buffer_load_dword v20, v3, s[44:47], s9 offen sc1
    s_add_u32 s9, s9, 2048
    buffer_load_dword v21, v3, s[44:47], s9 offen sc1
    s_add_u32 s9, s9, 2048
    buffer_load_dword v22, v3, s[44:47], s9 offen sc1
    s_add_u32 s9, s9, 2048
    buffer_load_dword v23, v3, s[44:47], s9 offen sc1
    s_add_u32 s9, s9, 2048
    s_waitcnt vmcnt(0)
    v_add_f32 v10, v10, v16
    v_add_f32 v10, v10, v17
    v_add_f32 v10, v10, v18
    v_add_f32 v10, v10, v19
    v_add_f32 v10, v10, v20
    v_add_f32 v10, v10, v21
    v_add_f32 v10, v10, v22
    v_add_f32 v10, v10, v23
K3_reduce:
    v_lshlrev_b32 v3, 2, v0
    ds_write_b32 v3, v10
    s_waitcnt lgkmcnt(0)
    s_barrier
    v_lshlrev_b32 v3, 2, v1
    ds_read_b32 v12, v3 offset:0
    ds_read_b32 v13, v3 offset:256
    ds_read_b32 v14, v3 offset:512
    ds_read_b32 v15, v3 offset:768
    s_waitcnt lgkmcnt(0)
    v_add_f32 v12, v12, v13
    v_add_f32 v14, v14, v15
    v_add_f32 v12, v12, v14
    v_cvt_pk_bf16_f32 v12, v12, v12
    s_cmp_eq_u32 s7, 0
    s_cbranch_scc0 K3_done
    s_lshl_b32 s8, s5, 10
    s_lshl_b32 s9, s4, 9
    s_add_u32 s8, s8, s9
    s_lshl_b32 s9, s6, 6
    s_add_u32 s8, s8, s9
    s_lshl_b32 s8, s8, 1
    v_lshlrev_b32 v3, 1, v1
    buffer_store_short v12, v3, s[48:51], s8 offen
    s_waitcnt vmcnt(0)
K3_done:
    s_endpgm
MAIN_exit:
    s_endpgm
.section .rodata,"a"
.p2align 6
.amdhsa_kernel concat_heads__mha_block_cached__compressed_kv_cla__decode_kernel
  .amdhsa_next_free_vgpr 256
  .amdhsa_next_free_sgpr 102
  .amdhsa_accum_offset 256
  .amdhsa_group_segment_fixed_size 0
  .amdhsa_kernarg_size 112
  .amdhsa_user_sgpr_count 2
  .amdhsa_user_sgpr_kernarg_segment_ptr 1
  .amdhsa_system_sgpr_workgroup_id_x 1
.end_amdhsa_kernel
```
